```python
import torch

def _softmax(x, axis=-1):
    return torch.softmax(x, dim=axis)

def _gelu(x):
    return torch.nn.functional.gelu(x, approximate='tanh')

def _silu(x):
    return torch.nn.functional.silu(x)

def _sigmoid(x):
    return torch.sigmoid(x)

def _layernorm(x, axis=-1, eps=1e-05):
    m = x.mean(dim=axis, keepdim=True)
    v = x.var(dim=axis, keepdim=True, unbiased=False)
    return (x - m) / torch.sqrt(v + eps)

def _scatter_add(tgt, idx, src, axis=0):
    return tgt.clone().index_add_(axis, idx, src)

def _segment_sum(src, seg, n):
    out = torch.zeros((n,) + src.shape[1:], dtype=src.dtype)
    return out.index_add_(0, seg, src)

def _pad(x, pw):
    flat = tuple((v for pair in reversed(pw) for v in pair))
    return torch.nn.functional.pad(x, flat)
kernel_name = 'adaLN_cond__ssm_conv_s4__swiglu_ffn__prompt'

def setup_inputs():

    _w = lambda a: (lambda t: t.to(torch.bfloat16) if t.is_floating_point() else t)(torch.as_tensor(a))

    def _A_setup():
        B, L, D, N = (1, 2048, 448, 256)
        A_re = -(lambda _x: torch.exp(torch.as_tensor(_x)))((lambda *s: torch.randn(*s, dtype=torch.bfloat16) * 3.2)(D, N))
        A_im = torch.pi * (lambda *s: torch.randn(*s, dtype=torch.bfloat16) * 0.1)(D, N)
        B_re = (lambda *s: torch.randn(*s, dtype=torch.bfloat16) * 0.1)(D, N)
        B_im = (lambda *s: torch.randn(*s, dtype=torch.bfloat16) * 0.1)(D, N)
        C_re = (lambda *s: torch.randn(*s, dtype=torch.bfloat16) * 0.1)(D, N)
        C_im = (lambda *s: torch.randn(*s, dtype=torch.bfloat16) * 0.1)(D, N)
        log_dt = (lambda *s: torch.randn(*s, dtype=torch.bfloat16) * 0.1)(D) * 0.5 - 4.0
        Dskip = (lambda *s: torch.randn(*s, dtype=torch.bfloat16) * 0.1)(D)
        return {'u': _w((lambda *s: torch.randn(*s, dtype=torch.bfloat16) * 0.05)(B, L, D)), 'A_re': _w(A_re), 'A_im': _w(A_im), 'B_re': _w(B_re), 'B_im': _w(B_im), 'C_re': _w(C_re), 'C_im': _w(C_im), 'log_dt': _w(log_dt), 'Dskip': _w(Dskip)}
    _A_in = _A_setup()

    def _B_setup():
        B, S, D, F = (1, 2048, 448, 1792)
        return {'x': _w((lambda *s: torch.randn(*s, dtype=torch.bfloat16) * 0.05)(B, S, D)), 'w_gate': _w((lambda *s: torch.randn(*s, dtype=torch.bfloat16) * 0.05)(D, F)), 'w_up': _w((lambda *s: torch.randn(*s, dtype=torch.bfloat16) * 0.05)(D, F)), 'w_down': _w((lambda *s: torch.randn(*s, dtype=torch.bfloat16) * 0.05)(F, D))}
    _B_in = _B_setup()
    return {'A_u': _A_in['u'], 'A_A_re': _A_in['A_re'], 'A_A_im': _A_in['A_im'], 'A_B_re': _A_in['B_re'], 'A_B_im': _A_in['B_im'], 'A_C_re': _A_in['C_re'], 'A_C_im': _A_in['C_im'], 'A_log_dt': _A_in['log_dt'], 'A_Dskip': _A_in['Dskip'], 'B_x': _B_in['x'], 'B_w_gate': _B_in['w_gate'], 'B_w_up': _B_in['w_up'], 'B_w_down': _B_in['w_down'], 'c': _w((lambda *s: torch.randn(*s, dtype=torch.bfloat16) * 0.1)(1, 448) * 8.0), 'w_mod': _w((lambda *s: torch.randn(*s, dtype=torch.bfloat16) * 0.1)(448, 6 * 448) * 448 ** (-0.5) * 8.0)}

def reference(A_u, A_A_re, A_A_im, A_B_re, A_B_im, A_C_re, A_C_im, A_log_dt, A_Dskip, B_x, B_w_gate, B_w_up, B_w_down, c, w_mod):

    def _A_ref(u, A_re, A_im, B_re, B_im, C_re, C_im, log_dt, Dskip):
        Bsz, L, D = u.shape
        dt = torch.exp(log_dt)[:, None]
        A = A_re + 1j * A_im
        Bc = B_re + 1j * B_im
        Cc = C_re + 1j * C_im
        logdA = dt * A
        dB = dt * Bc
        l = (lambda x, dt: x.to(dt))(torch.arange(L), A_re.dtype)
        P = torch.exp(logdA[:, :, None] * l[None, None, :])
        K = torch.einsum('dn,dnl,dn->dl', Cc, P, dB).real
        L2 = 2 * L
        Kp = _pad(K, ((0, 0), (0, L)))
        up = (lambda x, *d: x.permute(*d))(u, 0, 2, 1)
        up = _pad(up, ((0, 0), (0, 0), (0, L)))
        Kf = (lambda x, axes=(-2, -1): torch.fft.rfft2(x.float(), dim=axes))(Kp[:, None, :], axes=(-2, -1))
        Uf = (lambda x, axes=(-2, -1): torch.fft.rfft2(x.float(), dim=axes))(up[:, :, None, :], axes=(-2, -1))
        Yf = Uf * Kf[None, :, :, :]
        y = (lambda x, s, axes=(-2, -1): torch.fft.irfft2(x, s=s, dim=axes).to(torch.bfloat16))(Yf, (1, L2), axes=(-2, -1))[:, :, 0, :L]
        y = (lambda x, *d: x.permute(*d))(y, 0, 2, 1) + u * Dskip[None, None, :]
        return y

    def _B_ref(x, w_gate, w_up, w_down):
        g = _silu(x @ w_gate)
        u = x @ w_up
        return g * u @ w_down
    x = A_u
    mod = (_silu(c) @ w_mod).reshape(c.shape[0], 6, 1, -1)
    sa, ca, ga, sb, cb, gb = (mod[:, 0].clone(), mod[:, 1].clone(), mod[:, 2].clone(), mod[:, 3].clone(), mod[:, 4].clone(), mod[:, 5].clone())
    h = _layernorm(x, axis=-1) * (1 + ca) + sa
    x = x + ga * _A_ref(h, A_A_re, A_A_im, A_B_re, A_B_im, A_C_re, A_C_im, A_log_dt, A_Dskip)
    h = _layernorm(x, axis=-1) * (1 + cb) + sb
    x = x + gb * _B_ref(h, B_w_gate, B_w_up, B_w_down)
    return x
```

```asm
; @launch grid=(256,1,1) block=(512,1,1) lds=163840
.amdgcn_target "amdgcn-amd-amdhsa--gfx950"
.text
.globl adaLN_cond__ssm_conv_s4__swiglu_ffn__prompt_kernel
.p2align 12
.p2align 8
.type adaLN_cond__ssm_conv_s4__swiglu_ffn__prompt_kernel,@function
adaLN_cond__ssm_conv_s4__swiglu_ffn__prompt_kernel:
    s_cmp_ge_u32 s2, 256
    s_cbranch_scc1 L_exit
    s_load_dwordx4 s[48:51], s[0:1], 128
    s_load_dwordx16 s[16:31], s[0:1], 0
    s_load_dwordx16 s[32:47], s[0:1], 64
    s_memrealtime s[10:11]
    v_lshrrev_b32 v2, 6, v0
    v_and_b32 v1, 63, v0
    v_readfirstlane_b32 s4, v2
    s_and_b32 s5, s2, 7
    s_lshr_b32 s6, s2, 3
    s_mul_i32 s7, s5, 28
    s_add_u32 s7, s7, s6
    s_and_b32 s3, s4, 3
    v_and_b32 v186, 255, v0
    v_and_b32 v3, 31, v0
    v_lshrrev_b32 v4, 5, v186
    v_mul_u32_u24 v8, 896, v4
    v_lshl_add_u32 v8, v3, 4, v8
    v_mov_b32 v6, 2147418112
    v_cmp_gt_u32 vcc, 28, v3
    s_mul_i32 s12, s2, 7168
    s_nop 0
    v_cndmask_b32 v8, v6, v8, vcc
    v_and_b32 v5, 3, v0
    v_mul_u32_u24 v9, 1792, v5
    v_and_b32 v2, 0xfc, v0
    v_add3_u32 v9, v9, v2, s12
    v_mov_b32 v7, 0
    s_lshl_b32 s13, s7, 10
    v_lshl_add_u32 v10, v186, 2, s13
    s_mov_b32 s58, 1835008
    s_mov_b32 s59, 0x00020000
    s_mov_b32 s54, 20971520
    s_mov_b32 s55, 0x00020000
    v_lshlrev_b32 v5, 4, v5
    v_lshl_add_u32 v5, v2, 5, v5
    v_cmp_gt_u32 vcc, 128, v186
    v_add_u32 v56, 0x4000, v5
    v_add_u32 v57, 0x6000, v5
    v_cndmask_b32 v57, v6, v57, vcc
    v_add_u32 v6, 0x2000, v5
    v_lshlrev_b32 v4, 3, v4
    s_lshr_b32 s70, s2, 1
    s_mul_i32 s70, s70, 28672
    s_and_b32 s13, s2, 1
    s_lshl_b32 s13, s13, 6
    s_add_u32 s70, s70, s13
    s_lshl_b32 s71, s2, 6
    s_add_u32 s71, s71, 4194304
    s_and_b32 s66, s5, 1
    s_lshl_b32 s66, s66, 2
    s_and_b32 s13, s6, 3
    s_add_u32 s66, s66, s13
    s_lshr_b32 s67, s5, 1
    s_mul_i32 s67, s67, 7
    s_lshr_b32 s13, s6, 2
    s_add_u32 s67, s67, s13
    s_lshl_b32 s72, s7, 2
    s_or_b32 s13, s2, s4
    s_waitcnt lgkmcnt(0)
    s_cmp_lg_u32 s13, 0
    s_cbranch_scc1 L_nononce_1
    s_or_b32 s11, s10, 1
    s_atomic_swap s11, s[48:49], 0
    s_atomic_swap s11, s[48:49], 128
L_nononce_1:
    s_cmp_ge_u32 s6, 28
    s_cbranch_scc1 L_e0_2
    global_load_dword v36, v10, s[18:19]
    global_load_dword v37, v10, s[20:21]
    s_load_dword s64, s[30:31], s72
    s_load_dword s65, s[32:33], s72
L_e0_2:
    s_cmp_lt_u32 s4, 4
    s_cbranch_scc1 L_e1_3
    s_mov_b32 s56, s16
    s_mov_b32 s57, s17
    buffer_load_dwordx4 v[12:15], v8, s[56:59], s12 offen
    buffer_load_dwordx4 v[16:19], v8, s[56:59], s12 offen offset:448
    buffer_load_dword v20, v9, s[56:59], 0 offen offset:0
    buffer_load_dword v22, v9, s[56:59], 0 offen offset:896
    buffer_load_dword v24, v9, s[56:59], 0 offen offset:256
    buffer_load_dword v26, v9, s[56:59], 0 offen offset:1152
    buffer_load_dword v28, v9, s[56:59], 0 offen offset:512
    buffer_load_dword v30, v9, s[56:59], 0 offen offset:1408
    buffer_load_dword v32, v9, s[56:59], 0 offen offset:768
    buffer_load_dword v34, v9, s[56:59], 0 offen offset:1664
L_e1_3:
    s_mov_b32 s52, s50
    s_mov_b32 s53, s51
    s_cmp_ge_u32 s6, 28
    s_cbranch_scc1 L_spare
    s_cmp_lt_u32 s4, 4
    s_cbranch_scc1 L_e3_5
    global_load_dword v38, v10, s[22:23]
    global_load_dword v39, v10, s[24:25]
    global_load_dword v40, v10, s[26:27]
    global_load_dword v41, v10, s[28:29]
L_e3_5:
    v_lshrrev_b32 v180, 3, v0
    v_mul_u32_u24 v180, 28672, v180
    v_and_b32 v181, 7, v0
    v_lshl_add_u32 v180, v181, 4, v180
    s_lshl_b32 s13, s7, 7
    v_add_u32 v180, s13, v180
    v_add_u32 v181, 1835008, v180
    v_lshlrev_b32 v182, 4, v0
    v_add_u32 v182, 4194304, v182
    v_add_u32 v183, 8192, v182
    s_getpc_b64 s[12:13]
L_pc_6:
    s_add_u32 s12, s12, L_lagtab-L_pc_6
    s_addc_u32 s13, s13, 0
    v_lshlrev_b32 v178, 4, v186
    v_mov_b32 v179, s13
    v_add_co_u32 v178, vcc, s12, v178
    s_nop 1
    v_addc_co_u32 v179, vcc, 0, v179, vcc
    s_cmp_lt_u32 s4, 4
    s_cbranch_scc1 L_e2_4
    s_mov_b32 s60, s44
    s_mov_b32 s61, s45
    s_mov_b32 s62, 2408448
    s_mov_b32 s63, 0x00020000
    s_lshl_b32 s68, s3, 3
    s_add_u32 s68, s68, s5
    s_add_u32 s14, s68, 22
    s_sub_u32 s15, s68, 10
    s_cmp_lt_u32 s68, 10
    s_cselect_b32 s14, s14, s15
    s_cmp_ge_u32 s68, 32
    s_cselect_b32 s14, s68, s14
    s_mul_i32 s12, s14, 37
    s_lshr_b32 s12, s12, 8
    s_mul_i32 s13, s12, 7
    s_sub_u32 s13, s14, s13
    s_lshl_b32 s12, s12, 2
    s_lshr_b32 s12, 0x534210, s12
    s_and_b32 s73, s12, 15
    s_mul_i32 s74, s73, 7
    s_add_u32 s74, s74, s13
    s_add_u32 s68, s68, 32
    s_add_u32 s14, s68, 22
    s_sub_u32 s15, s68, 10
    s_cmp_lt_u32 s68, 10
    s_cselect_b32 s14, s14, s15
    s_cmp_ge_u32 s68, 32
    s_cselect_b32 s14, s68, s14
    s_mul_i32 s12, s14, 37
    s_lshr_b32 s12, s12, 8
    s_mul_i32 s13, s12, 7
    s_sub_u32 s13, s14, s13
    s_lshl_b32 s12, s12, 2
    s_lshr_b32 s12, 0x534210, s12
    s_and_b32 s73, s12, 15
    s_mul_i32 s75, s73, 7
    s_add_u32 s75, s75, s13
    s_cmp_lt_u32 s68, 42
    s_cselect_b32 s75, s75, s74
    s_lshl_b32 s13, s6, 4
    v_and_b32 v254, 15, v1
    v_add_u32 v254, s13, v254
    v_mul_u32_u24 v254, 5376, v254
    v_mov_b32 v255, s74
    v_mov_b32 v11, s75
    v_cmp_gt_u32 vcc, 16, v1
    s_nop 1
    v_cndmask_b32 v255, v11, v255, vcc
    v_lshl_add_u32 v254, v255, 7, v254
    s_getpc_b64 s[12:13]
L_pc_7:
    s_mul_i32 s14, s6, 16
    v_min_u32 v42, 15, v1
    v_add_u32 v42, s14, v42
    v_lshlrev_b32 v42, 7, v42
    v_min_u32 v42, L_lagtab+4096-L_pc_7, v42
    s_cmp_eq_u32 s4, 7
    s_cselect_b32 s14, -1, 0
    v_and_b32 v42, s14, v42
    v_mov_b32 v43, s13
    v_add_co_u32 v42, vcc, s12, v42
    s_nop 1
    v_addc_co_u32 v43, vcc, 0, v43, vcc
    global_load_dword v55, v[42:43], off
    s_setprio 2
    s_mov_b32 s13, 0x3f803f80
    s_waitcnt vmcnt(14)
    v_dot2_f32_bf16 v58, v12, s13, 0
    v_dot2_f32_bf16 v59, v12, v12, 0
    v_dot2_f32_bf16 v58, v13, s13, v58
    v_dot2_f32_bf16 v59, v13, v13, v59
    v_dot2_f32_bf16 v58, v14, s13, v58
    v_dot2_f32_bf16 v59, v14, v14, v59
    v_dot2_f32_bf16 v58, v15, s13, v58
    v_dot2_f32_bf16 v59, v15, v15, v59
    s_waitcnt vmcnt(13)
    v_dot2_f32_bf16 v58, v16, s13, v58
    v_dot2_f32_bf16 v59, v16, v16, v59
    v_dot2_f32_bf16 v58, v17, s13, v58
    v_dot2_f32_bf16 v59, v17, v17, v59
    v_dot2_f32_bf16 v58, v18, s13, v58
    v_dot2_f32_bf16 v59, v18, v18, v59
    v_dot2_f32_bf16 v58, v19, s13, v58
    v_dot2_f32_bf16 v59, v19, v19, v59
    s_nop 1
    v_add_f32_dpp v58, v58, v58 row_shr:1 row_mask:0xf bank_mask:0xf bound_ctrl:0
    v_add_f32_dpp v59, v59, v59 row_shr:1 row_mask:0xf bank_mask:0xf bound_ctrl:0
    s_nop 0
    v_add_f32_dpp v58, v58, v58 row_shr:2 row_mask:0xf bank_mask:0xf bound_ctrl:0
    v_add_f32_dpp v59, v59, v59 row_shr:2 row_mask:0xf bank_mask:0xf bound_ctrl:0
    s_nop 0
    v_add_f32_dpp v58, v58, v58 row_shr:4 row_mask:0xf bank_mask:0xf bound_ctrl:0
    v_add_f32_dpp v59, v59, v59 row_shr:4 row_mask:0xf bank_mask:0xf bound_ctrl:0
    s_nop 0
    v_add_f32_dpp v58, v58, v58 row_shr:8 row_mask:0xf bank_mask:0xf bound_ctrl:0
    v_add_f32_dpp v59, v59, v59 row_shr:8 row_mask:0xf bank_mask:0xf bound_ctrl:0
    s_nop 0
    v_add_f32_dpp v58, v58, v58 row_bcast:15 row_mask:0xa bank_mask:0xf
    v_add_f32_dpp v59, v59, v59 row_bcast:15 row_mask:0xa bank_mask:0xf
    s_waitcnt lgkmcnt(0)
    s_load_dword s8, s[48:49], 0
    v_mul_f32 v58, 0x3b124925, v58
    v_mul_f32 v59, 0x3b124925, v59
    v_fma_f32 v59, -v58, v58, v59
    v_max_f32 v59, 0, v59
    v_cvt_pk_bf16_f32 v59, v59, v59
    v_and_b32 v59, 0xffff0000, v59
    v_add_f32 v59, 0x3727c5ac, v59
    v_cvt_pk_bf16_f32 v59, v59, v59
    v_and_b32 v59, 0xffff0000, v59
    v_sqrt_f32 v59, v59
    s_nop 0
    v_cvt_pk_bf16_f32 v58, v58, v59
    s_waitcnt lgkmcnt(0)
    s_cmp_lg_u32 s8, 0
    s_cbranch_scc1 L_nonce_ok_8
    s_mov_b32 s9, 20000
    s_mov_b32 s96, s48
    s_mov_b32 s97, s49
    s_mov_b32 s98, 256
    s_mov_b32 s99, 0x00020000
L_nonce_poll_9:
    buffer_load_dword v8, v7, s[96:99], 0 offen offset:128 sc1
    s_waitcnt vmcnt(0)
    v_readfirstlane_b32 s8, v8
    s_sub_u32 s9, s9, 1
    s_cmp_eq_u32 s9, 0
    s_cbranch_scc1 L_nonce_ok_8
    s_cmp_eq_u32 s8, 0
    s_cbranch_scc1 L_nonce_poll_9
L_nonce_ok_8:
    s_nop 1
    v_mov_b32 v21, s8
    v_mov_b32 v23, s8
    s_waitcnt vmcnt(11)
    buffer_store_dwordx4 v[20:23], v5, s[52:55], s70 offen sc1
    v_mov_b32 v25, s8
    v_mov_b32 v27, s8
    s_waitcnt vmcnt(10)
    buffer_store_dwordx4 v[24:27], v6, s[52:55], s70 offen sc1
    v_mov_b32 v29, s8
    v_mov_b32 v31, s8
    s_waitcnt vmcnt(9)
    buffer_store_dwordx4 v[28:31], v56, s[52:55], s70 offen sc1
    v_mov_b32 v33, s8
    v_mov_b32 v35, s8
    s_waitcnt vmcnt(8)
    buffer_store_dwordx4 v[32:35], v57, s[52:55], s70 offen sc1
    v_mov_b32 v59, s8
    s_mov_b32 exec_lo, 0x80000000
    s_mov_b32 exec_hi, 0x80000000
    buffer_store_dwordx2 v[58:59], v4, s[52:55], s71 offen sc1
    s_mov_b64 exec, -1
    buffer_load_dword v255, v254, s[60:63], 0 offen
    ds_write_b32 v7, v59 offset:2816
    s_lshl_b32 s12, s64, 16
    s_and_b32 s13, s64, 0xffff0000
    s_cmp_lt_u32 s3, 2
    s_cselect_b32 s64, s12, s13
    s_lshl_b32 s12, s65, 16
    s_and_b32 s13, s65, 0xffff0000
    s_cmp_lt_u32 s3, 2
    s_cselect_b32 s65, s12, s13
    s_bitcmp1_b32 s4, 0
    s_cselect_b32 s65, 0, s65
    s_mul_i32 s68, s3, 28512
    s_add_u32 s68, s68, 37376
    v_mov_b32 v2, 0x3fb8aa3b
    v_mul_f32 v3, s64, v2
    v_fma_f32 v11, s64, v2, -v3
    v_mov_b32 v2, 0x32a57060
    v_fma_f32 v11, s64, v2, v11
    v_exp_f32 v3, v3
    v_mul_f32 v11, 0x3f317218, v11
    v_fma_f32 v3, v3, v11, v3
    v_cvt_pk_bf16_f32 v2, v3, v3
    v_and_b32 v2, 0xffff0000, v2
    v_lshl_add_u32 v10, v1, 3, s68
    v_lshlrev_b32 v80, 16, v36
    v_lshlrev_b32 v81, 16, v37
    v_mul_f32 v80, v2, v80
    v_mul_f32 v81, v2, v81
    v_mul_f32 v80, 0x3fb8aa3b, v80
    v_mul_f32 v81, 0x3e22f983, v81
    v_and_b32 v86, 0xffff0000, v36
    v_and_b32 v87, 0xffff0000, v37
    v_mul_f32 v86, v2, v86
    v_mul_f32 v87, v2, v87
    v_mul_f32 v86, 0x3fb8aa3b, v86
    v_mul_f32 v87, 0x3e22f983, v87
    s_waitcnt vmcnt(10)
    v_lshlrev_b32 v82, 16, v38
    s_waitcnt vmcnt(9)
    v_lshlrev_b32 v83, 16, v39
    s_waitcnt vmcnt(8)
    v_lshlrev_b32 v84, 16, v40
    s_waitcnt vmcnt(7)
    v_lshlrev_b32 v85, 16, v41
    v_mul_f32 v82, v2, v82
    v_mul_f32 v83, v2, v83
    v_mul_f32 v64, v84, v82
    v_mul_f32 v65, v84, v83
    v_fma_f32 v64, -v85, v83, v64
    v_fma_f32 v65, v85, v82, v65
    v_and_b32 v88, 0xffff0000, v38
    v_and_b32 v89, 0xffff0000, v39
    v_and_b32 v90, 0xffff0000, v40
    v_and_b32 v91, 0xffff0000, v41
    v_mul_f32 v88, v2, v88
    v_mul_f32 v89, v2, v89
    v_mul_f32 v66, v90, v88
    v_mul_f32 v67, v90, v89
    v_fma_f32 v66, -v91, v89, v66
    v_fma_f32 v67, v91, v88, v67
    v_mul_f32 v92, 0x3f800000, v80
    v_mul_f32 v93, 0x3f800000, v81
    v_fract_f32 v93, v93
    v_mul_f32 v94, 0x3f800000, v86
    v_mul_f32 v95, 0x3f800000, v87
    v_fract_f32 v95, v95
    v_exp_f32 v92, v92
    v_cos_f32 v68, v93
    v_sin_f32 v69, v93
    v_exp_f32 v94, v94
    v_cos_f32 v70, v95
    v_sin_f32 v71, v95
    v_mul_f32 v68, v92, v68
    v_mul_f32 v69, v92, v69
    v_mul_f32 v70, v94, v70
    v_mul_f32 v71, v94, v71
    v_mul_f32 v92, 0x43800000, v80
    v_mul_f32 v93, 0x43800000, v81
    v_fract_f32 v93, v93
    v_mul_f32 v94, 0x43800000, v86
    v_mul_f32 v95, 0x43800000, v87
    v_fract_f32 v95, v95
    v_exp_f32 v92, v92
    v_cos_f32 v76, v93
    v_sin_f32 v77, v93
    v_exp_f32 v94, v94
    v_cos_f32 v78, v95
    v_sin_f32 v79, v95
    v_mul_f32 v76, v92, v76
    v_mul_f32 v77, v92, v77
    v_mul_f32 v78, v94, v78
    v_mul_f32 v79, v94, v79
    v_pk_mul_f32 v[92:93], v[64:65], v[68:69] op_sel_hi:[1,0]
    v_pk_mul_f32 v[94:95], v[66:67], v[70:71] op_sel_hi:[1,0]
    v_cvt_pk_bf16_f32 v96, v64, v65
    v_pk_fma_f32 v[80:81], v[64:65], v[68:69], v[92:93] op_sel:[1,1,0] op_sel_hi:[0,1,1] neg_lo:[0,1,0]
    v_pk_fma_f32 v[82:83], v[66:67], v[70:71], v[94:95] op_sel:[1,1,0] op_sel_hi:[0,1,1] neg_lo:[0,1,0]
    v_cvt_pk_bf16_f32 v97, v66, v67
    ds_write_b64 v10, v[96:97] offset:0
    v_pk_mul_f32 v[92:93], v[80:81], v[68:69] op_sel_hi:[1,0]
    v_pk_mul_f32 v[94:95], v[82:83], v[70:71] op_sel_hi:[1,0]
    v_cvt_pk_bf16_f32 v98, v80, v81
    v_pk_fma_f32 v[104:105], v[80:81], v[68:69], v[92:93] op_sel:[1,1,0] op_sel_hi:[0,1,1] neg_lo:[0,1,0]
    v_pk_fma_f32 v[106:107], v[82:83], v[70:71], v[94:95] op_sel:[1,1,0] op_sel_hi:[0,1,1] neg_lo:[0,1,0]
    v_cvt_pk_bf16_f32 v99, v82, v83
    ds_write_b64 v10, v[98:99] offset:528
    v_pk_mul_f32 v[92:93], v[104:105], v[68:69] op_sel_hi:[1,0]
    v_pk_mul_f32 v[94:95], v[106:107], v[70:71] op_sel_hi:[1,0]
    v_cvt_pk_bf16_f32 v100, v104, v105
    v_pk_fma_f32 v[84:85], v[104:105], v[68:69], v[92:93] op_sel:[1,1,0] op_sel_hi:[0,1,1] neg_lo:[0,1,0]
    v_pk_fma_f32 v[86:87], v[106:107], v[70:71], v[94:95] op_sel:[1,1,0] op_sel_hi:[0,1,1] neg_lo:[0,1,0]
    v_cvt_pk_bf16_f32 v101, v106, v107
    ds_write_b64 v10, v[100:101] offset:1056
    v_pk_mul_f32 v[92:93], v[84:85], v[68:69] op_sel_hi:[1,0]
    v_pk_mul_f32 v[94:95], v[86:87], v[70:71] op_sel_hi:[1,0]
    v_cvt_pk_bf16_f32 v102, v84, v85
    v_pk_fma_f32 v[108:109], v[84:85], v[68:69], v[92:93] op_sel:[1,1,0] op_sel_hi:[0,1,1] neg_lo:[0,1,0]
    v_pk_fma_f32 v[110:111], v[86:87], v[70:71], v[94:95] op_sel:[1,1,0] op_sel_hi:[0,1,1] neg_lo:[0,1,0]
    v_cvt_pk_bf16_f32 v103, v86, v87
    ds_write_b64 v10, v[102:103] offset:1584
    v_pk_mul_f32 v[92:93], v[108:109], v[68:69] op_sel_hi:[1,0]
    v_pk_mul_f32 v[94:95], v[110:111], v[70:71] op_sel_hi:[1,0]
    v_cvt_pk_bf16_f32 v96, v108, v109
    v_pk_fma_f32 v[80:81], v[108:109], v[68:69], v[92:93] op_sel:[1,1,0] op_sel_hi:[0,1,1] neg_lo:[0,1,0]
    v_pk_fma_f32 v[82:83], v[110:111], v[70:71], v[94:95] op_sel:[1,1,0] op_sel_hi:[0,1,1] neg_lo:[0,1,0]
    v_cvt_pk_bf16_f32 v97, v110, v111
    ds_write_b64 v10, v[96:97] offset:2112
    v_pk_mul_f32 v[92:93], v[80:81], v[68:69] op_sel_hi:[1,0]
    v_pk_mul_f32 v[94:95], v[82:83], v[70:71] op_sel_hi:[1,0]
    v_cvt_pk_bf16_f32 v98, v80, v81
    v_pk_fma_f32 v[112:113], v[80:81], v[68:69], v[92:93] op_sel:[1,1,0] op_sel_hi:[0,1,1] neg_lo:[0,1,0]
    v_pk_fma_f32 v[114:115], v[82:83], v[70:71], v[94:95] op_sel:[1,1,0] op_sel_hi:[0,1,1] neg_lo:[0,1,0]
    v_cvt_pk_bf16_f32 v99, v82, v83
    ds_write_b64 v10, v[98:99] offset:2640
    v_pk_mul_f32 v[92:93], v[112:113], v[68:69] op_sel_hi:[1,0]
    v_pk_mul_f32 v[94:95], v[114:115], v[70:71] op_sel_hi:[1,0]
    v_cvt_pk_bf16_f32 v100, v112, v113
    v_pk_fma_f32 v[84:85], v[112:113], v[68:69], v[92:93] op_sel:[1,1,0] op_sel_hi:[0,1,1] neg_lo:[0,1,0]
    v_pk_fma_f32 v[86:87], v[114:115], v[70:71], v[94:95] op_sel:[1,1,0] op_sel_hi:[0,1,1] neg_lo:[0,1,0]
    v_cvt_pk_bf16_f32 v101, v114, v115
    ds_write_b64 v10, v[100:101] offset:3168
    v_pk_mul_f32 v[92:93], v[64:65], v[76:77] op_sel_hi:[1,0]
    v_pk_mul_f32 v[94:95], v[66:67], v[78:79] op_sel_hi:[1,0]
    v_cvt_pk_bf16_f32 v102, v84, v85
    v_pk_fma_f32 v[116:117], v[64:65], v[76:77], v[92:93] op_sel:[1,1,0] op_sel_hi:[0,1,1] neg_lo:[0,1,0]
    v_pk_fma_f32 v[118:119], v[66:67], v[78:79], v[94:95] op_sel:[1,1,0] op_sel_hi:[0,1,1] neg_lo:[0,1,0]
    v_cvt_pk_bf16_f32 v103, v86, v87
    ds_write_b64 v10, v[102:103] offset:3696
    v_pk_mul_f32 v[92:93], v[108:109], v[76:77] op_sel_hi:[1,0]
    v_pk_mul_f32 v[94:95], v[110:111], v[78:79] op_sel_hi:[1,0]
    v_cvt_pk_bf16_f32 v96, v116, v117
    v_pk_fma_f32 v[120:121], v[108:109], v[76:77], v[92:93] op_sel:[1,1,0] op_sel_hi:[0,1,1] neg_lo:[0,1,0]
    v_pk_fma_f32 v[122:123], v[110:111], v[78:79], v[94:95] op_sel:[1,1,0] op_sel_hi:[0,1,1] neg_lo:[0,1,0]
    v_cvt_pk_bf16_f32 v97, v118, v119
    ds_write_b64 v10, v[96:97] offset:4224
    v_pk_mul_f32 v[92:93], v[104:105], v[76:77] op_sel_hi:[1,0]
    v_pk_mul_f32 v[94:95], v[106:107], v[78:79] op_sel_hi:[1,0]
    v_cvt_pk_bf16_f32 v98, v120, v121
    v_pk_fma_f32 v[80:81], v[104:105], v[76:77], v[92:93] op_sel:[1,1,0] op_sel_hi:[0,1,1] neg_lo:[0,1,0]
    v_pk_fma_f32 v[82:83], v[106:107], v[78:79], v[94:95] op_sel:[1,1,0] op_sel_hi:[0,1,1] neg_lo:[0,1,0]
    v_cvt_pk_bf16_f32 v99, v122, v123
    ds_write_b64 v10, v[98:99] offset:6336
    v_pk_mul_f32 v[92:93], v[112:113], v[76:77] op_sel_hi:[1,0]
    v_pk_mul_f32 v[94:95], v[114:115], v[78:79] op_sel_hi:[1,0]
    v_cvt_pk_bf16_f32 v100, v80, v81
    v_pk_fma_f32 v[84:85], v[112:113], v[76:77], v[92:93] op_sel:[1,1,0] op_sel_hi:[0,1,1] neg_lo:[0,1,0]
    v_pk_fma_f32 v[86:87], v[114:115], v[78:79], v[94:95] op_sel:[1,1,0] op_sel_hi:[0,1,1] neg_lo:[0,1,0]
    v_cvt_pk_bf16_f32 v101, v82, v83
    ds_write_b64 v10, v[100:101] offset:4752
    v_pk_mul_f32 v[92:93], v[116:117], v[76:77] op_sel_hi:[1,0]
    v_pk_mul_f32 v[94:95], v[118:119], v[78:79] op_sel_hi:[1,0]
    v_cvt_pk_bf16_f32 v102, v84, v85
    v_pk_fma_f32 v[124:125], v[116:117], v[76:77], v[92:93] op_sel:[1,1,0] op_sel_hi:[0,1,1] neg_lo:[0,1,0]
    v_pk_fma_f32 v[126:127], v[118:119], v[78:79], v[94:95] op_sel:[1,1,0] op_sel_hi:[0,1,1] neg_lo:[0,1,0]
    v_cvt_pk_bf16_f32 v103, v86, v87
    ds_write_b64 v10, v[102:103] offset:6864
    v_pk_mul_f32 v[92:93], v[120:121], v[76:77] op_sel_hi:[1,0]
    v_pk_mul_f32 v[94:95], v[122:123], v[78:79] op_sel_hi:[1,0]
    v_cvt_pk_bf16_f32 v96, v124, v125
    v_pk_fma_f32 v[128:129], v[120:121], v[76:77], v[92:93] op_sel:[1,1,0] op_sel_hi:[0,1,1] neg_lo:[0,1,0]
    v_pk_fma_f32 v[130:131], v[122:123], v[78:79], v[94:95] op_sel:[1,1,0] op_sel_hi:[0,1,1] neg_lo:[0,1,0]
    v_cvt_pk_bf16_f32 v97, v126, v127
    ds_write_b64 v10, v[96:97] offset:5280
    v_pk_mul_f32 v[92:93], v[124:125], v[76:77] op_sel_hi:[1,0]
    v_pk_mul_f32 v[94:95], v[126:127], v[78:79] op_sel_hi:[1,0]
    v_cvt_pk_bf16_f32 v98, v128, v129
    v_pk_fma_f32 v[116:117], v[124:125], v[76:77], v[92:93] op_sel:[1,1,0] op_sel_hi:[0,1,1] neg_lo:[0,1,0]
    v_pk_fma_f32 v[118:119], v[126:127], v[78:79], v[94:95] op_sel:[1,1,0] op_sel_hi:[0,1,1] neg_lo:[0,1,0]
    v_cvt_pk_bf16_f32 v99, v130, v131
    ds_write_b64 v10, v[98:99] offset:7392
    v_pk_mul_f32 v[92:93], v[128:129], v[76:77] op_sel_hi:[1,0]
    v_pk_mul_f32 v[94:95], v[130:131], v[78:79] op_sel_hi:[1,0]
    v_cvt_pk_bf16_f32 v100, v116, v117
    v_pk_fma_f32 v[120:121], v[128:129], v[76:77], v[92:93] op_sel:[1,1,0] op_sel_hi:[0,1,1] neg_lo:[0,1,0]
    v_pk_fma_f32 v[122:123], v[130:131], v[78:79], v[94:95] op_sel:[1,1,0] op_sel_hi:[0,1,1] neg_lo:[0,1,0]
    v_cvt_pk_bf16_f32 v101, v118, v119
    ds_write_b64 v10, v[100:101] offset:5808
    v_pk_mul_f32 v[92:93], v[116:117], v[76:77] op_sel_hi:[1,0]
    v_pk_mul_f32 v[94:95], v[118:119], v[78:79] op_sel_hi:[1,0]
    v_cvt_pk_bf16_f32 v102, v120, v121
    v_pk_fma_f32 v[124:125], v[116:117], v[76:77], v[92:93] op_sel:[1,1,0] op_sel_hi:[0,1,1] neg_lo:[0,1,0]
    v_pk_fma_f32 v[126:127], v[118:119], v[78:79], v[94:95] op_sel:[1,1,0] op_sel_hi:[0,1,1] neg_lo:[0,1,0]
    v_cvt_pk_bf16_f32 v103, v122, v123
    ds_write_b64 v10, v[102:103] offset:7920
    v_pk_mul_f32 v[92:93], v[124:125], v[76:77] op_sel_hi:[1,0]
    v_pk_mul_f32 v[94:95], v[126:127], v[78:79] op_sel_hi:[1,0]
    v_cvt_pk_bf16_f32 v96, v124, v125
    v_pk_fma_f32 v[116:117], v[124:125], v[76:77], v[92:93] op_sel:[1,1,0] op_sel_hi:[0,1,1] neg_lo:[0,1,0]
    v_pk_fma_f32 v[118:119], v[126:127], v[78:79], v[94:95] op_sel:[1,1,0] op_sel_hi:[0,1,1] neg_lo:[0,1,0]
    v_cvt_pk_bf16_f32 v97, v126, v127
    ds_write_b64 v10, v[96:97] offset:8448
    v_pk_mul_f32 v[92:93], v[116:117], v[76:77] op_sel_hi:[1,0]
    v_pk_mul_f32 v[94:95], v[118:119], v[78:79] op_sel_hi:[1,0]
    v_cvt_pk_bf16_f32 v98, v116, v117
    v_pk_fma_f32 v[124:125], v[116:117], v[76:77], v[92:93] op_sel:[1,1,0] op_sel_hi:[0,1,1] neg_lo:[0,1,0]
    v_pk_fma_f32 v[126:127], v[118:119], v[78:79], v[94:95] op_sel:[1,1,0] op_sel_hi:[0,1,1] neg_lo:[0,1,0]
    v_cvt_pk_bf16_f32 v99, v118, v119
    ds_write_b64 v10, v[98:99] offset:8976
    v_pk_mul_f32 v[92:93], v[124:125], v[76:77] op_sel_hi:[1,0]
    v_pk_mul_f32 v[94:95], v[126:127], v[78:79] op_sel_hi:[1,0]
    v_cvt_pk_bf16_f32 v100, v124, v125
    v_pk_fma_f32 v[116:117], v[124:125], v[76:77], v[92:93] op_sel:[1,1,0] op_sel_hi:[0,1,1] neg_lo:[0,1,0]
    v_pk_fma_f32 v[118:119], v[126:127], v[78:79], v[94:95] op_sel:[1,1,0] op_sel_hi:[0,1,1] neg_lo:[0,1,0]
    v_cvt_pk_bf16_f32 v101, v126, v127
    ds_write_b64 v10, v[100:101] offset:9504
    v_pk_mul_f32 v[92:93], v[116:117], v[76:77] op_sel_hi:[1,0]
    v_pk_mul_f32 v[94:95], v[118:119], v[78:79] op_sel_hi:[1,0]
    v_cvt_pk_bf16_f32 v102, v116, v117
    v_pk_fma_f32 v[124:125], v[116:117], v[76:77], v[92:93] op_sel:[1,1,0] op_sel_hi:[0,1,1] neg_lo:[0,1,0]
    v_pk_fma_f32 v[126:127], v[118:119], v[78:79], v[94:95] op_sel:[1,1,0] op_sel_hi:[0,1,1] neg_lo:[0,1,0]
    v_cvt_pk_bf16_f32 v103, v118, v119
    ds_write_b64 v10, v[102:103] offset:10560
    v_cvt_pk_bf16_f32 v96, v124, v125
    v_cvt_pk_bf16_f32 v97, v126, v127
    ds_write_b64 v10, v[96:97] offset:11088
    global_load_dwordx4 v[172:175], v[178:179], off
    global_load_dwordx2 v[176:177], v[178:179], off offset:16
    s_setprio 0
    s_waitcnt lgkmcnt(0)
    s_barrier
    s_branch L_grpB
.p2align 12
L_stub0:
    s_setpc_b64 s[100:101]
    s_nop 0
L_pg0:
L_e2_4:
    v_mov_b32 v60, 0
    v_mov_b32 v61, 0
    v_lshlrev_b32 v11, 3, v1
    v_add_u32 v11, 151424, v11
    ds_write_b64 v11, v[60:61]
    ds_write_b64 v11, v[60:61] offset:4576
    ds_write_b64 v7, v[60:61] offset:2304
    ds_write_b64 v7, v[60:61] offset:20992
    v_mov_b32 v11, 163776
    ds_write_b64 v11, v[60:61]
    ds_write_b64 v11, v[60:61] offset:8
    ds_write_b64 v11, v[60:61] offset:16
    v_and_b32 v2, 31, v1
    v_mul_u32_u24 v208, 528, v2
    v_lshrrev_b32 v3, 5, v1
    v_lshl_add_u32 v208, v3, 4, v208
    s_mul_i32 s12, s3, 28512
    s_add_u32 s12, s12, 37376
    v_add_u32 v208, s12, v208
    s_lshr_b32 s12, s3, 1
    s_mul_i32 s12, s12, 18688
    s_and_b32 s13, s3, 1
    s_lshl_b32 s13, s13, 2
    s_add_u32 s12, s12, s13
    v_lshl_add_u32 v2, v2, 3, s12
    v_mul_u32_u24 v210, 6144, v3
    v_add_u32 v210, v210, v2
    v_lshl_add_u32 v209, v3, 10, v2
    v_mov_b32 v193, 0
    v_mov_b32 v194, 0
    v_mov_b32 v195, 0
    v_mov_b32 v196, 0
    v_mov_b32 v197, 0
    v_mov_b32 v198, 0
    v_mov_b32 v199, 0
    v_mov_b32 v200, 0
    v_mov_b32 v201, 0
    v_mov_b32 v202, 0
    v_mov_b32 v203, 0
    v_mov_b32 v204, 0
    v_mov_b32 v205, 0
    v_mov_b32 v206, 0
    v_mov_b32 v207, 0
    v_lshlrev_b32 v211, 4, v186
    v_add_u32 v211, 114688, v211
    v_lshlrev_b32 v213, 2, v0
    v_add_u32 v213, 151424, v213
    v_lshlrev_b32 v214, 3, v0
    v_add_u32 v214, 98304, v214
    s_lshr_b32 s12, s3, 1
    s_and_b32 s14, s3, 1
    s_lshl_b32 s15, s14, 8
    s_mul_i32 s13, s12, 16640
    s_add_u32 s13, s13, s15
    s_add_u32 s13, s13, 114712
    v_and_b32 v2, 3, v1
    v_sub_u32 v2, 3, v2
    v_mul_u32_u24 v2, 4160, v2
    v_lshrrev_b32 v3, 4, v1
    v_bfe_u32 v4, v1, 2, 2
    v_lshlrev_b32 v5, 1, v3
    v_sub_u32 v4, v5, v4
    v_lshlrev_b32 v4, 3, v4
    v_add3_u32 v220, v2, v4, s13
    s_mul_i32 s13, s12, 4576
    s_add_u32 s13, s13, s15
    s_add_u32 s13, s13, 151424
    v_and_b32 v2, 15, v1
    v_lshlrev_b32 v4, 5, v2
    v_lshl_add_u32 v4, v3, 4, v4
    v_add_u32 v221, s13, v4
    v_bfe_u32 v4, v1, 1, 2
    v_xor_b32 v4, v4, v3
    v_lshl_add_u32 v4, v2, 2, v4
    v_lshlrev_b32 v4, 4, v4
    s_mul_i32 s13, s3, 28672
    s_add_u32 s13, s13, 20480
    v_add_u32 v222, s13, v4
    s_bitcmp1_b32 s3, 0
    s_cselect_b32 s56, s38, s36
    s_cselect_b32 s57, s39, s37
    s_mov_b32 s58, 1605632
    s_mov_b32 s59, 0x00020000
    v_lshrrev_b32 v249, 2, v1
    v_mul_u32_u24 v249, 3584, v249
    s_and_b32 s13, s3, 1
    s_lshl_b32 s13, s13, 1
    v_and_b32 v250, 3, v1
    v_xor_b32 v250, s13, v250
    v_lshl_add_u32 v249, v250, 4, v249
    s_lshl_b32 s13, s67, 7
    s_and_b32 s14, s3, 2
    s_lshl_b32 s14, s14, 5
    s_add_u32 s13, s13, s14
    v_add_u32 v249, s13, v249
    s_and_b32 s74, s6, 28
    s_mul_i32 s75, s3, 28672
    s_waitcnt lgkmcnt(0)
    s_lshl_b32 s12, s64, 16
    s_and_b32 s13, s64, 0xffff0000
    s_cmp_lt_u32 s3, 2
    s_cselect_b32 s64, s12, s13
    s_lshl_b32 s12, s65, 16
    s_and_b32 s13, s65, 0xffff0000
    s_cmp_lt_u32 s3, 2
    s_cselect_b32 s65, s12, s13
    s_bitcmp1_b32 s4, 0
    s_cselect_b32 s65, 0, s65
    s_mul_i32 s68, s3, 28512
    s_add_u32 s68, s68, 37376
    v_mov_b32 v2, 0x3fb8aa3b
    v_mul_f32 v3, s64, v2
    v_fma_f32 v11, s64, v2, -v3
    v_mov_b32 v2, 0x32a57060
    v_fma_f32 v11, s64, v2, v11
    v_exp_f32 v3, v3
    v_mul_f32 v11, 0x3f317218, v11
    v_fma_f32 v3, v3, v11, v3
    v_cvt_pk_bf16_f32 v2, v3, v3
    v_and_b32 v2, 0xffff0000, v2
    v_lshl_add_u32 v10, v1, 3, s68
    s_waitcnt vmcnt(1)
    v_lshlrev_b32 v80, 16, v36
    s_waitcnt vmcnt(0)
    v_lshlrev_b32 v81, 16, v37
    v_mul_f32 v80, v2, v80
    v_mul_f32 v81, v2, v81
    v_mul_f32 v80, 0x3fb8aa3b, v80
    v_mul_f32 v81, 0x3e22f983, v81
    v_and_b32 v86, 0xffff0000, v36
    v_and_b32 v87, 0xffff0000, v37
    v_mul_f32 v86, v2, v86
    v_mul_f32 v87, v2, v87
    v_mul_f32 v86, 0x3fb8aa3b, v86
    v_mul_f32 v87, 0x3e22f983, v87
    v_mov_b32 v3, s65
    v_cmp_eq_u32 vcc, 0, v1
    s_nop 1
    v_cndmask_b32 v192, v193, v3, vcc
    v_mul_f32 v92, 0x41000000, v80
    v_mul_f32 v93, 0x41000000, v81
    v_fract_f32 v93, v93
    v_mul_f32 v94, 0x41000000, v86
    v_mul_f32 v95, 0x41000000, v87
    v_fract_f32 v95, v95
    v_exp_f32 v92, v92
    v_cos_f32 v72, v93
    v_sin_f32 v73, v93
    v_exp_f32 v94, v94
    v_cos_f32 v74, v95
    v_sin_f32 v75, v95
    v_mul_f32 v72, v92, v72
    v_mul_f32 v73, -v92, v73
    v_mul_f32 v74, v94, v74
    v_mul_f32 v75, -v94, v75
    v_mov_b32 v102, 0x3f80
    v_mov_b32 v103, 0x3f80
    ds_write_b64 v10, v[102:103] offset:11616
    v_pk_mul_f32 v[92:93], v[72:73], v[72:73] op_sel_hi:[1,0]
    v_pk_mul_f32 v[94:95], v[74:75], v[74:75] op_sel_hi:[1,0]
    v_cvt_pk_bf16_f32 v96, v72, v73
    v_pk_fma_f32 v[80:81], v[72:73], v[72:73], v[92:93] op_sel:[1,1,0] op_sel_hi:[0,1,1] neg_lo:[0,1,0]
    v_pk_fma_f32 v[82:83], v[74:75], v[74:75], v[94:95] op_sel:[1,1,0] op_sel_hi:[0,1,1] neg_lo:[0,1,0]
    v_cvt_pk_bf16_f32 v97, v74, v75
    ds_write_b64 v10, v[96:97] offset:12144
    v_pk_mul_f32 v[92:93], v[80:81], v[72:73] op_sel_hi:[1,0]
    v_pk_mul_f32 v[94:95], v[82:83], v[74:75] op_sel_hi:[1,0]
    v_cvt_pk_bf16_f32 v98, v80, v81
    v_pk_fma_f32 v[84:85], v[80:81], v[72:73], v[92:93] op_sel:[1,1,0] op_sel_hi:[0,1,1] neg_lo:[0,1,0]
    v_pk_fma_f32 v[86:87], v[82:83], v[74:75], v[94:95] op_sel:[1,1,0] op_sel_hi:[0,1,1] neg_lo:[0,1,0]
    v_cvt_pk_bf16_f32 v99, v82, v83
    ds_write_b64 v10, v[98:99] offset:12672
    v_pk_mul_f32 v[92:93], v[84:85], v[72:73] op_sel_hi:[1,0]
    v_pk_mul_f32 v[94:95], v[86:87], v[74:75] op_sel_hi:[1,0]
    v_cvt_pk_bf16_f32 v100, v84, v85
    v_pk_fma_f32 v[80:81], v[84:85], v[72:73], v[92:93] op_sel:[1,1,0] op_sel_hi:[0,1,1] neg_lo:[0,1,0]
    v_pk_fma_f32 v[82:83], v[86:87], v[74:75], v[94:95] op_sel:[1,1,0] op_sel_hi:[0,1,1] neg_lo:[0,1,0]
    v_cvt_pk_bf16_f32 v101, v86, v87
    ds_write_b64 v10, v[100:101] offset:13200
    v_pk_mul_f32 v[92:93], v[80:81], v[72:73] op_sel_hi:[1,0]
    v_pk_mul_f32 v[94:95], v[82:83], v[74:75] op_sel_hi:[1,0]
    v_cvt_pk_bf16_f32 v102, v80, v81
    v_pk_fma_f32 v[84:85], v[80:81], v[72:73], v[92:93] op_sel:[1,1,0] op_sel_hi:[0,1,1] neg_lo:[0,1,0]
    v_pk_fma_f32 v[86:87], v[82:83], v[74:75], v[94:95] op_sel:[1,1,0] op_sel_hi:[0,1,1] neg_lo:[0,1,0]
    v_cvt_pk_bf16_f32 v103, v82, v83
    ds_write_b64 v10, v[102:103] offset:13728
    v_pk_mul_f32 v[92:93], v[84:85], v[72:73] op_sel_hi:[1,0]
    v_pk_mul_f32 v[94:95], v[86:87], v[74:75] op_sel_hi:[1,0]
    v_cvt_pk_bf16_f32 v96, v84, v85
    v_pk_fma_f32 v[80:81], v[84:85], v[72:73], v[92:93] op_sel:[1,1,0] op_sel_hi:[0,1,1] neg_lo:[0,1,0]
    v_pk_fma_f32 v[82:83], v[86:87], v[74:75], v[94:95] op_sel:[1,1,0] op_sel_hi:[0,1,1] neg_lo:[0,1,0]
    v_cvt_pk_bf16_f32 v97, v86, v87
    ds_write_b64 v10, v[96:97] offset:14256
    v_pk_mul_f32 v[92:93], v[80:81], v[72:73] op_sel_hi:[1,0]
    v_pk_mul_f32 v[94:95], v[82:83], v[74:75] op_sel_hi:[1,0]
    v_cvt_pk_bf16_f32 v98, v80, v81
    v_pk_fma_f32 v[84:85], v[80:81], v[72:73], v[92:93] op_sel:[1,1,0] op_sel_hi:[0,1,1] neg_lo:[0,1,0]
    v_pk_fma_f32 v[86:87], v[82:83], v[74:75], v[94:95] op_sel:[1,1,0] op_sel_hi:[0,1,1] neg_lo:[0,1,0]
    v_cvt_pk_bf16_f32 v99, v82, v83
    ds_write_b64 v10, v[98:99] offset:14784
    v_pk_mul_f32 v[92:93], v[84:85], v[72:73] op_sel_hi:[1,0]
    v_pk_mul_f32 v[94:95], v[86:87], v[74:75] op_sel_hi:[1,0]
    v_cvt_pk_bf16_f32 v100, v84, v85
    v_pk_fma_f32 v[80:81], v[84:85], v[72:73], v[92:93] op_sel:[1,1,0] op_sel_hi:[0,1,1] neg_lo:[0,1,0]
    v_pk_fma_f32 v[82:83], v[86:87], v[74:75], v[94:95] op_sel:[1,1,0] op_sel_hi:[0,1,1] neg_lo:[0,1,0]
    v_cvt_pk_bf16_f32 v101, v86, v87
    ds_write_b64 v10, v[100:101] offset:15312
    v_pk_mul_f32 v[92:93], v[80:81], v[72:73] op_sel_hi:[1,0]
    v_pk_mul_f32 v[94:95], v[82:83], v[74:75] op_sel_hi:[1,0]
    v_cvt_pk_bf16_f32 v102, v80, v81
    v_pk_fma_f32 v[84:85], v[80:81], v[72:73], v[92:93] op_sel:[1,1,0] op_sel_hi:[0,1,1] neg_lo:[0,1,0]
    v_pk_fma_f32 v[86:87], v[82:83], v[74:75], v[94:95] op_sel:[1,1,0] op_sel_hi:[0,1,1] neg_lo:[0,1,0]
    v_cvt_pk_bf16_f32 v103, v82, v83
    ds_write_b64 v10, v[102:103] offset:15840
    v_pk_mul_f32 v[92:93], v[84:85], v[72:73] op_sel_hi:[1,0]
    v_pk_mul_f32 v[94:95], v[86:87], v[74:75] op_sel_hi:[1,0]
    v_cvt_pk_bf16_f32 v96, v84, v85
    v_pk_fma_f32 v[80:81], v[84:85], v[72:73], v[92:93] op_sel:[1,1,0] op_sel_hi:[0,1,1] neg_lo:[0,1,0]
    v_pk_fma_f32 v[82:83], v[86:87], v[74:75], v[94:95] op_sel:[1,1,0] op_sel_hi:[0,1,1] neg_lo:[0,1,0]
    v_cvt_pk_bf16_f32 v97, v86, v87
    ds_write_b64 v10, v[96:97] offset:16368
    v_pk_mul_f32 v[92:93], v[80:81], v[72:73] op_sel_hi:[1,0]
    v_pk_mul_f32 v[94:95], v[82:83], v[74:75] op_sel_hi:[1,0]
    v_cvt_pk_bf16_f32 v98, v80, v81
    v_pk_fma_f32 v[84:85], v[80:81], v[72:73], v[92:93] op_sel:[1,1,0] op_sel_hi:[0,1,1] neg_lo:[0,1,0]
    v_pk_fma_f32 v[86:87], v[82:83], v[74:75], v[94:95] op_sel:[1,1,0] op_sel_hi:[0,1,1] neg_lo:[0,1,0]
    v_cvt_pk_bf16_f32 v99, v82, v83
    ds_write_b64 v10, v[98:99] offset:16896
    v_pk_mul_f32 v[92:93], v[84:85], v[72:73] op_sel_hi:[1,0]
    v_pk_mul_f32 v[94:95], v[86:87], v[74:75] op_sel_hi:[1,0]
    v_cvt_pk_bf16_f32 v100, v84, v85
    v_pk_fma_f32 v[80:81], v[84:85], v[72:73], v[92:93] op_sel:[1,1,0] op_sel_hi:[0,1,1] neg_lo:[0,1,0]
    v_pk_fma_f32 v[82:83], v[86:87], v[74:75], v[94:95] op_sel:[1,1,0] op_sel_hi:[0,1,1] neg_lo:[0,1,0]
    v_cvt_pk_bf16_f32 v101, v86, v87
    ds_write_b64 v10, v[100:101] offset:17424
    v_pk_mul_f32 v[92:93], v[80:81], v[72:73] op_sel_hi:[1,0]
    v_pk_mul_f32 v[94:95], v[82:83], v[74:75] op_sel_hi:[1,0]
    v_cvt_pk_bf16_f32 v102, v80, v81
    v_pk_fma_f32 v[84:85], v[80:81], v[72:73], v[92:93] op_sel:[1,1,0] op_sel_hi:[0,1,1] neg_lo:[0,1,0]
    v_pk_fma_f32 v[86:87], v[82:83], v[74:75], v[94:95] op_sel:[1,1,0] op_sel_hi:[0,1,1] neg_lo:[0,1,0]
    v_cvt_pk_bf16_f32 v103, v82, v83
    ds_write_b64 v10, v[102:103] offset:17952
    v_pk_mul_f32 v[92:93], v[84:85], v[72:73] op_sel_hi:[1,0]
    v_pk_mul_f32 v[94:95], v[86:87], v[74:75] op_sel_hi:[1,0]
    v_cvt_pk_bf16_f32 v96, v84, v85
    v_pk_fma_f32 v[80:81], v[84:85], v[72:73], v[92:93] op_sel:[1,1,0] op_sel_hi:[0,1,1] neg_lo:[0,1,0]
    v_pk_fma_f32 v[82:83], v[86:87], v[74:75], v[94:95] op_sel:[1,1,0] op_sel_hi:[0,1,1] neg_lo:[0,1,0]
    v_cvt_pk_bf16_f32 v97, v86, v87
    ds_write_b64 v10, v[96:97] offset:18480
    v_pk_mul_f32 v[92:93], v[80:81], v[72:73] op_sel_hi:[1,0]
    v_pk_mul_f32 v[94:95], v[82:83], v[74:75] op_sel_hi:[1,0]
    v_cvt_pk_bf16_f32 v98, v80, v81
    v_pk_fma_f32 v[84:85], v[80:81], v[72:73], v[92:93] op_sel:[1,1,0] op_sel_hi:[0,1,1] neg_lo:[0,1,0]
    v_pk_fma_f32 v[86:87], v[82:83], v[74:75], v[94:95] op_sel:[1,1,0] op_sel_hi:[0,1,1] neg_lo:[0,1,0]
    v_cvt_pk_bf16_f32 v99, v82, v83
    ds_write_b64 v10, v[98:99] offset:19008
    v_pk_mul_f32 v[92:93], v[84:85], v[72:73] op_sel_hi:[1,0]
    v_pk_mul_f32 v[94:95], v[86:87], v[74:75] op_sel_hi:[1,0]
    v_cvt_pk_bf16_f32 v100, v84, v85
    v_pk_fma_f32 v[80:81], v[84:85], v[72:73], v[92:93] op_sel:[1,1,0] op_sel_hi:[0,1,1] neg_lo:[0,1,0]
    v_pk_fma_f32 v[82:83], v[86:87], v[74:75], v[94:95] op_sel:[1,1,0] op_sel_hi:[0,1,1] neg_lo:[0,1,0]
    v_cvt_pk_bf16_f32 v101, v86, v87
    ds_write_b64 v10, v[100:101] offset:19536
    v_pk_mul_f32 v[92:93], v[80:81], v[72:73] op_sel_hi:[1,0]
    v_pk_mul_f32 v[94:95], v[82:83], v[74:75] op_sel_hi:[1,0]
    v_cvt_pk_bf16_f32 v102, v80, v81
    v_pk_fma_f32 v[84:85], v[80:81], v[72:73], v[92:93] op_sel:[1,1,0] op_sel_hi:[0,1,1] neg_lo:[0,1,0]
    v_pk_fma_f32 v[86:87], v[82:83], v[74:75], v[94:95] op_sel:[1,1,0] op_sel_hi:[0,1,1] neg_lo:[0,1,0]
    v_cvt_pk_bf16_f32 v103, v82, v83
    ds_write_b64 v10, v[102:103] offset:20064
    v_pk_mul_f32 v[92:93], v[84:85], v[72:73] op_sel_hi:[1,0]
    v_pk_mul_f32 v[94:95], v[86:87], v[74:75] op_sel_hi:[1,0]
    v_cvt_pk_bf16_f32 v96, v84, v85
    v_pk_fma_f32 v[80:81], v[84:85], v[72:73], v[92:93] op_sel:[1,1,0] op_sel_hi:[0,1,1] neg_lo:[0,1,0]
    v_pk_fma_f32 v[82:83], v[86:87], v[74:75], v[94:95] op_sel:[1,1,0] op_sel_hi:[0,1,1] neg_lo:[0,1,0]
    v_cvt_pk_bf16_f32 v97, v86, v87
    ds_write_b64 v10, v[96:97] offset:20592
    v_pk_mul_f32 v[92:93], v[80:81], v[72:73] op_sel_hi:[1,0]
    v_pk_mul_f32 v[94:95], v[82:83], v[74:75] op_sel_hi:[1,0]
    v_cvt_pk_bf16_f32 v98, v80, v81
    v_pk_fma_f32 v[84:85], v[80:81], v[72:73], v[92:93] op_sel:[1,1,0] op_sel_hi:[0,1,1] neg_lo:[0,1,0]
    v_pk_fma_f32 v[86:87], v[82:83], v[74:75], v[94:95] op_sel:[1,1,0] op_sel_hi:[0,1,1] neg_lo:[0,1,0]
    v_cvt_pk_bf16_f32 v99, v82, v83
    ds_write_b64 v10, v[98:99] offset:21120
    v_pk_mul_f32 v[92:93], v[84:85], v[72:73] op_sel_hi:[1,0]
    v_pk_mul_f32 v[94:95], v[86:87], v[74:75] op_sel_hi:[1,0]
    v_cvt_pk_bf16_f32 v100, v84, v85
    v_pk_fma_f32 v[80:81], v[84:85], v[72:73], v[92:93] op_sel:[1,1,0] op_sel_hi:[0,1,1] neg_lo:[0,1,0]
    v_pk_fma_f32 v[82:83], v[86:87], v[74:75], v[94:95] op_sel:[1,1,0] op_sel_hi:[0,1,1] neg_lo:[0,1,0]
    v_cvt_pk_bf16_f32 v101, v86, v87
    ds_write_b64 v10, v[100:101] offset:21648
    v_pk_mul_f32 v[92:93], v[80:81], v[72:73] op_sel_hi:[1,0]
    v_pk_mul_f32 v[94:95], v[82:83], v[74:75] op_sel_hi:[1,0]
    v_cvt_pk_bf16_f32 v102, v80, v81
    v_pk_fma_f32 v[84:85], v[80:81], v[72:73], v[92:93] op_sel:[1,1,0] op_sel_hi:[0,1,1] neg_lo:[0,1,0]
    v_pk_fma_f32 v[86:87], v[82:83], v[74:75], v[94:95] op_sel:[1,1,0] op_sel_hi:[0,1,1] neg_lo:[0,1,0]
    v_cvt_pk_bf16_f32 v103, v82, v83
    ds_write_b64 v10, v[102:103] offset:22176
    v_pk_mul_f32 v[92:93], v[84:85], v[72:73] op_sel_hi:[1,0]
    v_pk_mul_f32 v[94:95], v[86:87], v[74:75] op_sel_hi:[1,0]
    v_cvt_pk_bf16_f32 v96, v84, v85
    v_pk_fma_f32 v[80:81], v[84:85], v[72:73], v[92:93] op_sel:[1,1,0] op_sel_hi:[0,1,1] neg_lo:[0,1,0]
    v_pk_fma_f32 v[82:83], v[86:87], v[74:75], v[94:95] op_sel:[1,1,0] op_sel_hi:[0,1,1] neg_lo:[0,1,0]
    v_cvt_pk_bf16_f32 v97, v86, v87
    ds_write_b64 v10, v[96:97] offset:22704
    v_pk_mul_f32 v[92:93], v[80:81], v[72:73] op_sel_hi:[1,0]
    v_pk_mul_f32 v[94:95], v[82:83], v[74:75] op_sel_hi:[1,0]
    v_cvt_pk_bf16_f32 v98, v80, v81
    v_pk_fma_f32 v[84:85], v[80:81], v[72:73], v[92:93] op_sel:[1,1,0] op_sel_hi:[0,1,1] neg_lo:[0,1,0]
    v_pk_fma_f32 v[86:87], v[82:83], v[74:75], v[94:95] op_sel:[1,1,0] op_sel_hi:[0,1,1] neg_lo:[0,1,0]
    v_cvt_pk_bf16_f32 v99, v82, v83
    ds_write_b64 v10, v[98:99] offset:23232
    v_pk_mul_f32 v[92:93], v[84:85], v[72:73] op_sel_hi:[1,0]
    v_pk_mul_f32 v[94:95], v[86:87], v[74:75] op_sel_hi:[1,0]
    v_cvt_pk_bf16_f32 v100, v84, v85
    v_pk_fma_f32 v[80:81], v[84:85], v[72:73], v[92:93] op_sel:[1,1,0] op_sel_hi:[0,1,1] neg_lo:[0,1,0]
    v_pk_fma_f32 v[82:83], v[86:87], v[74:75], v[94:95] op_sel:[1,1,0] op_sel_hi:[0,1,1] neg_lo:[0,1,0]
    v_cvt_pk_bf16_f32 v101, v86, v87
    ds_write_b64 v10, v[100:101] offset:23760
    v_pk_mul_f32 v[92:93], v[80:81], v[72:73] op_sel_hi:[1,0]
    v_pk_mul_f32 v[94:95], v[82:83], v[74:75] op_sel_hi:[1,0]
    v_cvt_pk_bf16_f32 v102, v80, v81
    v_pk_fma_f32 v[84:85], v[80:81], v[72:73], v[92:93] op_sel:[1,1,0] op_sel_hi:[0,1,1] neg_lo:[0,1,0]
    v_pk_fma_f32 v[86:87], v[82:83], v[74:75], v[94:95] op_sel:[1,1,0] op_sel_hi:[0,1,1] neg_lo:[0,1,0]
    v_cvt_pk_bf16_f32 v103, v82, v83
    ds_write_b64 v10, v[102:103] offset:24288
    v_pk_mul_f32 v[92:93], v[84:85], v[72:73] op_sel_hi:[1,0]
    v_pk_mul_f32 v[94:95], v[86:87], v[74:75] op_sel_hi:[1,0]
    v_cvt_pk_bf16_f32 v96, v84, v85
    v_pk_fma_f32 v[80:81], v[84:85], v[72:73], v[92:93] op_sel:[1,1,0] op_sel_hi:[0,1,1] neg_lo:[0,1,0]
    v_pk_fma_f32 v[82:83], v[86:87], v[74:75], v[94:95] op_sel:[1,1,0] op_sel_hi:[0,1,1] neg_lo:[0,1,0]
    v_cvt_pk_bf16_f32 v97, v86, v87
    ds_write_b64 v10, v[96:97] offset:24816
    v_pk_mul_f32 v[92:93], v[80:81], v[72:73] op_sel_hi:[1,0]
    v_pk_mul_f32 v[94:95], v[82:83], v[74:75] op_sel_hi:[1,0]
    v_cvt_pk_bf16_f32 v98, v80, v81
    v_pk_fma_f32 v[84:85], v[80:81], v[72:73], v[92:93] op_sel:[1,1,0] op_sel_hi:[0,1,1] neg_lo:[0,1,0]
    v_pk_fma_f32 v[86:87], v[82:83], v[74:75], v[94:95] op_sel:[1,1,0] op_sel_hi:[0,1,1] neg_lo:[0,1,0]
    v_cvt_pk_bf16_f32 v99, v82, v83
    ds_write_b64 v10, v[98:99] offset:25344
    v_pk_mul_f32 v[92:93], v[84:85], v[72:73] op_sel_hi:[1,0]
    v_pk_mul_f32 v[94:95], v[86:87], v[74:75] op_sel_hi:[1,0]
    v_cvt_pk_bf16_f32 v100, v84, v85
    v_pk_fma_f32 v[80:81], v[84:85], v[72:73], v[92:93] op_sel:[1,1,0] op_sel_hi:[0,1,1] neg_lo:[0,1,0]
    v_pk_fma_f32 v[82:83], v[86:87], v[74:75], v[94:95] op_sel:[1,1,0] op_sel_hi:[0,1,1] neg_lo:[0,1,0]
    v_cvt_pk_bf16_f32 v101, v86, v87
    ds_write_b64 v10, v[100:101] offset:25872
    v_pk_mul_f32 v[92:93], v[80:81], v[72:73] op_sel_hi:[1,0]
    v_pk_mul_f32 v[94:95], v[82:83], v[74:75] op_sel_hi:[1,0]
    v_cvt_pk_bf16_f32 v102, v80, v81
    v_pk_fma_f32 v[84:85], v[80:81], v[72:73], v[92:93] op_sel:[1,1,0] op_sel_hi:[0,1,1] neg_lo:[0,1,0]
    v_pk_fma_f32 v[86:87], v[82:83], v[74:75], v[94:95] op_sel:[1,1,0] op_sel_hi:[0,1,1] neg_lo:[0,1,0]
    v_cvt_pk_bf16_f32 v103, v82, v83
    ds_write_b64 v10, v[102:103] offset:26400
    v_pk_mul_f32 v[92:93], v[84:85], v[72:73] op_sel_hi:[1,0]
    v_pk_mul_f32 v[94:95], v[86:87], v[74:75] op_sel_hi:[1,0]
    v_cvt_pk_bf16_f32 v96, v84, v85
    v_pk_fma_f32 v[80:81], v[84:85], v[72:73], v[92:93] op_sel:[1,1,0] op_sel_hi:[0,1,1] neg_lo:[0,1,0]
    v_pk_fma_f32 v[82:83], v[86:87], v[74:75], v[94:95] op_sel:[1,1,0] op_sel_hi:[0,1,1] neg_lo:[0,1,0]
    v_cvt_pk_bf16_f32 v97, v86, v87
    ds_write_b64 v10, v[96:97] offset:26928
    v_pk_mul_f32 v[92:93], v[80:81], v[72:73] op_sel_hi:[1,0]
    v_pk_mul_f32 v[94:95], v[82:83], v[74:75] op_sel_hi:[1,0]
    v_cvt_pk_bf16_f32 v98, v80, v81
    v_pk_fma_f32 v[84:85], v[80:81], v[72:73], v[92:93] op_sel:[1,1,0] op_sel_hi:[0,1,1] neg_lo:[0,1,0]
    v_pk_fma_f32 v[86:87], v[82:83], v[74:75], v[94:95] op_sel:[1,1,0] op_sel_hi:[0,1,1] neg_lo:[0,1,0]
    v_cvt_pk_bf16_f32 v99, v82, v83
    ds_write_b64 v10, v[98:99] offset:27456
    v_cvt_pk_bf16_f32 v100, v84, v85
    v_cvt_pk_bf16_f32 v101, v86, v87
    ds_write_b64 v10, v[100:101] offset:27984
    global_load_dwordx4 v[172:175], v[178:179], off
    global_load_dwordx2 v[176:177], v[178:179], off offset:16
    s_waitcnt lgkmcnt(0)
    s_barrier
    ds_read_b32 v8, v7 offset:2816
    ds_read_b128 v[96:99], v208 offset:0
    ds_read_b128 v[100:103], v208 offset:11616
    ds_read_b128 v[104:107], v208 offset:32
    ds_read_b128 v[108:111], v208 offset:11648
    ds_read_b128 v[112:115], v208 offset:64
    ds_read_b128 v[116:119], v208 offset:11680
    ds_read_b128 v[120:123], v208 offset:96
    ds_read_b128 v[124:127], v208 offset:11712
    ds_read_b128 v[128:131], v208 offset:128
    ds_read_b128 v[132:135], v208 offset:11744
    ds_read_b128 v[136:139], v208 offset:160
    ds_read_b128 v[140:143], v208 offset:11776
    ds_read_b128 v[144:147], v208 offset:192
    ds_read_b128 v[148:151], v208 offset:11808
    s_waitcnt lgkmcnt(12)
    v_mfma_f32_32x32x16_bf16 v[192:207], v[96:99], v[100:103], v[192:207]
    ds_read_b128 v[96:99], v208 offset:224
    ds_read_b128 v[100:103], v208 offset:11840
    s_waitcnt lgkmcnt(12)
    v_mfma_f32_32x32x16_bf16 v[192:207], v[104:107], v[108:111], v[192:207]
    ds_read_b128 v[104:107], v208 offset:256
    ds_read_b128 v[108:111], v208 offset:11872
    s_waitcnt lgkmcnt(12)
    v_mfma_f32_32x32x16_bf16 v[192:207], v[112:115], v[116:119], v[192:207]
    ds_read_b128 v[112:115], v208 offset:288
    ds_read_b128 v[116:119], v208 offset:11904
    s_waitcnt lgkmcnt(12)
    v_mfma_f32_32x32x16_bf16 v[192:207], v[120:123], v[124:127], v[192:207]
    ds_read_b128 v[120:123], v208 offset:320
    ds_read_b128 v[124:127], v208 offset:11936
    s_waitcnt lgkmcnt(12)
    v_mfma_f32_32x32x16_bf16 v[192:207], v[128:131], v[132:135], v[192:207]
    ds_read_b128 v[128:131], v208 offset:352
    ds_read_b128 v[132:135], v208 offset:11968
    s_waitcnt lgkmcnt(12)
    v_mfma_f32_32x32x16_bf16 v[192:207], v[136:139], v[140:143], v[192:207]
    ds_read_b128 v[136:139], v208 offset:384
    ds_read_b128 v[140:143], v208 offset:12000
    s_waitcnt lgkmcnt(12)
    v_mfma_f32_32x32x16_bf16 v[192:207], v[144:147], v[148:151], v[192:207]
    ds_read_b128 v[144:147], v208 offset:416
    ds_read_b128 v[148:151], v208 offset:12032
    s_waitcnt lgkmcnt(12)
    v_mfma_f32_32x32x16_bf16 v[192:207], v[96:99], v[100:103], v[192:207]
    ds_read_b128 v[96:99], v208 offset:448
    ds_read_b128 v[100:103], v208 offset:12064
    s_waitcnt lgkmcnt(12)
    v_mfma_f32_32x32x16_bf16 v[192:207], v[104:107], v[108:111], v[192:207]
    ds_read_b128 v[104:107], v208 offset:480
    ds_read_b128 v[108:111], v208 offset:12096
    buffer_load_dwordx4 v[152:155], v180, s[52:55], 0 offen sc1
    buffer_load_dwordx4 v[156:159], v181, s[52:55], 0 offen sc1
    buffer_load_dwordx4 v[160:163], v182, s[52:55], 0 offen sc1
    buffer_load_dwordx4 v[164:167], v183, s[52:55], 0 offen sc1
    s_waitcnt lgkmcnt(12)
    v_mfma_f32_32x32x16_bf16 v[192:207], v[112:115], v[116:119], v[192:207]
    s_waitcnt lgkmcnt(10)
    v_mfma_f32_32x32x16_bf16 v[192:207], v[120:123], v[124:127], v[192:207]
    s_waitcnt lgkmcnt(8)
    v_mfma_f32_32x32x16_bf16 v[192:207], v[128:131], v[132:135], v[192:207]
    s_waitcnt lgkmcnt(6)
    v_mfma_f32_32x32x16_bf16 v[192:207], v[136:139], v[140:143], v[192:207]
    s_waitcnt lgkmcnt(4)
    v_mfma_f32_32x32x16_bf16 v[192:207], v[144:147], v[148:151], v[192:207]
    s_waitcnt lgkmcnt(2)
    v_mfma_f32_32x32x16_bf16 v[192:207], v[96:99], v[100:103], v[192:207]
    s_waitcnt lgkmcnt(0)
    v_mfma_f32_32x32x16_bf16 v[192:207], v[104:107], v[108:111], v[192:207]
    s_waitcnt vmcnt(5)
    v_and_b32 v44, 0xffff, v172
    v_lshrrev_b32 v45, 16, v172
    v_and_b32 v46, 0xffff, v173
    v_lshrrev_b32 v47, 16, v173
    v_and_b32 v48, 0xffff, v174
    v_lshrrev_b32 v49, 16, v174
    v_and_b32 v50, 0xffff, v175
    v_lshrrev_b32 v51, 16, v175
    s_waitcnt vmcnt(4)
    v_and_b32 v52, 0xffff, v176
    v_lshrrev_b32 v53, 16, v176
    v_and_b32 v54, 0xffff, v177
    ds_write_b32 v209, v192 offset:0
    ds_write_b32 v209, v193 offset:256
    ds_write_b32 v209, v194 offset:512
    ds_write_b32 v209, v195 offset:768
    ds_write_b32 v209, v196 offset:2048
    ds_write_b32 v209, v197 offset:2560
    ds_write_b32 v209, v198 offset:4096
    ds_write_b32 v209, v199 offset:6144
    ds_write_b32 v210, v200 offset:8192
    ds_write_b32 v210, v201 offset:10240
    ds_write_b32 v210, v202 offset:12288
    v_readfirstlane_b32 s8, v8
    s_branch L_pg1
.p2align 12
L_stub1:
    s_setpc_b64 s[100:101]
    s_nop 0
L_pg1:
    s_waitcnt lgkmcnt(0)
    s_barrier
    ds_read_b64 v[64:65], v44 offset:0
    ds_read_b64 v[66:67], v45 offset:0
    ds_read_b64 v[68:69], v46 offset:0
    ds_read_b64 v[70:71], v47 offset:0
    ds_read_b64 v[72:73], v48 offset:0
    ds_read_b64 v[74:75], v49 offset:0
    ds_read_b64 v[76:77], v50 offset:0
    ds_read_b64 v[78:79], v51 offset:0
    ds_read_b64 v[80:81], v52 offset:0
    ds_read_b64 v[82:83], v53 offset:0
    ds_read_b64 v[84:85], v54 offset:0
    s_waitcnt lgkmcnt(10)
    v_add_f32 v64, v64, v65
    s_waitcnt lgkmcnt(9)
    v_add_f32 v66, v66, v67
    s_waitcnt lgkmcnt(8)
    v_add_f32 v68, v68, v69
    s_waitcnt lgkmcnt(7)
    v_add_f32 v70, v70, v71
    s_waitcnt lgkmcnt(6)
    v_add_f32 v72, v72, v73
    s_waitcnt lgkmcnt(5)
    v_add_f32 v74, v74, v75
    s_waitcnt lgkmcnt(4)
    v_add_f32 v76, v76, v77
    s_waitcnt lgkmcnt(3)
    v_add_f32 v78, v78, v79
    s_waitcnt lgkmcnt(2)
    v_add_f32 v80, v80, v81
    s_waitcnt lgkmcnt(1)
    v_add_f32 v82, v82, v83
    s_waitcnt lgkmcnt(0)
    v_add_f32 v84, v84, v85
    v_cvt_pk_bf16_f32 v96, v64, v66
    v_cvt_pk_bf16_f32 v97, v68, v70
    v_cvt_pk_bf16_f32 v98, v72, v74
    v_cvt_pk_bf16_f32 v99, v76, v78
    ds_write_b128 v211, v[96:99] offset:0
    v_cvt_pk_bf16_f32 v100, v66, v68
    v_cvt_pk_bf16_f32 v101, v70, v72
    v_cvt_pk_bf16_f32 v102, v74, v76
    v_cvt_pk_bf16_f32 v103, v78, v80
    ds_write_b128 v211, v[100:103] offset:4160
    v_cvt_pk_bf16_f32 v104, v68, v70
    v_cvt_pk_bf16_f32 v105, v72, v74
    v_cvt_pk_bf16_f32 v106, v76, v78
    v_cvt_pk_bf16_f32 v107, v80, v82
    ds_write_b128 v211, v[104:107] offset:8320
    v_cvt_pk_bf16_f32 v108, v70, v72
    v_cvt_pk_bf16_f32 v109, v74, v76
    v_cvt_pk_bf16_f32 v110, v78, v80
    v_cvt_pk_bf16_f32 v111, v82, v84
    ds_write_b128 v211, v[108:111] offset:12480
    s_waitcnt vmcnt(3)
    v_bitop3_b32 v64, v153, v155, s8 bitop3:0x7e
    s_waitcnt vmcnt(2)
    v_bitop3_b32 v65, v157, v159, s8 bitop3:0x7e
    s_waitcnt vmcnt(1)
    v_bitop3_b32 v66, v161, v163, s8 bitop3:0x7e
    s_waitcnt vmcnt(0)
    v_bitop3_b32 v67, v165, v167, s8 bitop3:0x7e
    v_or3_b32 v64, v64, v65, v66
    v_or_b32 v60, v67, v64
    v_cmp_ne_u32 vcc, 0, v60
    s_cbranch_vccz L_ok_10
    s_mov_b32 s9, 20000
L_spin_11:
    s_mov_b64 exec, vcc
    buffer_load_dwordx4 v[152:155], v180, s[52:55], 0 offen sc1
    buffer_load_dwordx4 v[156:159], v181, s[52:55], 0 offen sc1
    buffer_load_dwordx4 v[160:163], v182, s[52:55], 0 offen sc1
    buffer_load_dwordx4 v[164:167], v183, s[52:55], 0 offen sc1
    s_waitcnt vmcnt(3)
    v_bitop3_b32 v64, v153, v155, s8 bitop3:0x7e
    s_waitcnt vmcnt(2)
    v_bitop3_b32 v65, v157, v159, s8 bitop3:0x7e
    s_waitcnt vmcnt(1)
    v_bitop3_b32 v66, v161, v163, s8 bitop3:0x7e
    s_waitcnt vmcnt(0)
    v_bitop3_b32 v67, v165, v167, s8 bitop3:0x7e
    v_or3_b32 v64, v64, v65, v66
    v_or_b32 v60, v67, v64
    v_cmp_ne_u32 vcc, 0, v60
    s_cbranch_vccz L_out_12
    s_sub_u32 s9, s9, 1
    s_cmp_lg_u32 s9, 0
    s_cbranch_scc1 L_spin_11
L_out_12:
    s_mov_b64 exec, -1
L_ok_10:
    v_and_b32 v65, 0xffff0000, v160
    v_lshlrev_b32 v64, 16, v160
    v_rcp_f32 v65, v65
    v_and_b32 v67, 0xffff0000, v162
    v_lshlrev_b32 v66, 16, v162
    v_rcp_f32 v67, v67
    v_and_b32 v69, 0xffff0000, v164
    v_lshlrev_b32 v68, 16, v164
    v_rcp_f32 v69, v69
    v_and_b32 v71, 0xffff0000, v166
    v_lshlrev_b32 v70, 16, v166
    v_rcp_f32 v71, v71
    v_lshlrev_b32 v80, 16, v152
    v_and_b32 v81, 0xffff0000, v152
    v_lshlrev_b32 v82, 16, v154
    v_and_b32 v83, 0xffff0000, v154
    v_lshlrev_b32 v84, 16, v156
    v_and_b32 v85, 0xffff0000, v156
    v_lshlrev_b32 v86, 16, v158
    v_and_b32 v87, 0xffff0000, v158
    v_sub_f32 v80, v80, v64
    v_sub_f32 v81, v81, v64
    v_sub_f32 v82, v82, v66
    v_sub_f32 v83, v83, v66
    v_sub_f32 v84, v84, v68
    v_sub_f32 v85, v85, v68
    v_sub_f32 v86, v86, v70
    v_sub_f32 v87, v87, v70
    v_mul_f32 v80, v80, v65
    v_mul_f32 v81, v81, v65
    v_mul_f32 v82, v82, v67
    v_mul_f32 v83, v83, v67
    v_mul_f32 v84, v84, v69
    v_mul_f32 v85, v85, v69
    v_mul_f32 v86, v86, v71
    v_mul_f32 v87, v87, v71
    v_cvt_pk_bf16_f32 v64, v80, v82
    ds_write_b32 v213, v64 offset:480
    v_cvt_pk_bf16_f32 v65, v81, v83
    ds_write_b32 v213, v65 offset:5056
    v_cvt_pk_bf16_f32 v66, v84, v86
    ds_write_b32 v213, v66 offset:2528
    v_cvt_pk_bf16_f32 v67, v85, v87
    ds_write_b32 v213, v67 offset:7104
    v_mov_b32 v153, v154
    ds_write_b64 v214, v[152:153] offset:0
    v_mov_b32 v157, v158
    ds_write_b64 v214, v[156:157] offset:4096
    s_setprio 1
    s_waitcnt lgkmcnt(0)
    s_barrier
    ds_read_b64 v[64:65], v220 offset:3584
    ds_read_b64 v[66:67], v220 offset:3592
    ds_read_b128 v[96:99], v221 offset:0
    ds_read_b64 v[68:69], v220 offset:3072
    ds_read_b64 v[70:71], v220 offset:3080
    ds_read_b128 v[100:103], v221 offset:512
    ds_read_b64 v[72:73], v220 offset:2560
    ds_read_b64 v[74:75], v220 offset:2568
    ds_read_b128 v[104:107], v221 offset:1024
    ds_read_b64 v[76:77], v220 offset:2048
    ds_read_b64 v[78:79], v220 offset:2056
    ds_read_b128 v[108:111], v221 offset:1536
    ds_read_b64 v[80:81], v220 offset:1536
    ds_read_b64 v[82:83], v220 offset:1544
    ds_read_b128 v[112:115], v221 offset:2048
    ds_read_b64 v[84:85], v220 offset:1024
    ds_read_b64 v[86:87], v220 offset:1032
    ds_read_b128 v[116:119], v221 offset:2560
    ds_read_b64 v[88:89], v220 offset:512
    ds_read_b64 v[90:91], v220 offset:520
    ds_read_b128 v[120:123], v221 offset:3072
    ds_read_b64 v[92:93], v220 offset:0
    ds_read_b64 v[94:95], v220 offset:8
    ds_read_b128 v[124:127], v221 offset:3584
    s_waitcnt lgkmcnt(15)
    v_mfma_f32_16x16x32_bf16 v[16:19], v[64:67], v[96:99], 0
    v_mfma_f32_16x16x32_bf16 v[20:23], v[64:67], v[100:103], 0
    ds_read_b64 v[128:129], v220 offset:3648
    v_mfma_f32_16x16x32_bf16 v[20:23], v[68:71], v[96:99], v[20:23]
    ds_read_b64 v[130:131], v220 offset:3656
    v_mfma_f32_16x16x32_bf16 v[24:27], v[68:71], v[100:103], 0
    v_mfma_f32_16x16x32_bf16 v[24:27], v[64:67], v[104:107], v[24:27]
    ds_read_b128 v[160:163], v221 offset:64
    v_mfma_f32_16x16x32_bf16 v[24:27], v[72:75], v[96:99], v[24:27]
    ds_read_b64 v[132:133], v220 offset:3136
    v_mfma_f32_16x16x32_bf16 v[28:31], v[68:71], v[104:107], 0
    v_mfma_f32_16x16x32_bf16 v[28:31], v[72:75], v[100:103], v[28:31]
    ds_read_b64 v[134:135], v220 offset:3144
    v_mfma_f32_16x16x32_bf16 v[32:35], v[72:75], v[104:107], 0
    ds_read_b128 v[164:167], v221 offset:576
    s_waitcnt lgkmcnt(15)
    v_mfma_f32_16x16x32_bf16 v[28:31], v[64:67], v[108:111], v[28:31]
    v_mfma_f32_16x16x32_bf16 v[28:31], v[76:79], v[96:99], v[28:31]
    ds_read_b64 v[136:137], v220 offset:2624
    v_mfma_f32_16x16x32_bf16 v[32:35], v[68:71], v[108:111], v[32:35]
    ds_read_b64 v[138:139], v220 offset:2632
    v_mfma_f32_16x16x32_bf16 v[32:35], v[76:79], v[100:103], v[32:35]
    v_mfma_f32_16x16x32_bf16 v[36:39], v[72:75], v[108:111], 0
    ds_read_b128 v[168:171], v221 offset:1088
    v_mfma_f32_16x16x32_bf16 v[36:39], v[76:79], v[104:107], v[36:39]
    ds_read_b64 v[140:141], v220 offset:2112
    v_mfma_f32_16x16x32_bf16 v[40:43], v[76:79], v[108:111], 0
    v_mfma_f32_16x16x32_bf16 v[32:35], v[64:67], v[112:115], v[32:35]
    ds_read_b64 v[142:143], v220 offset:2120
    v_mfma_f32_16x16x32_bf16 v[32:35], v[80:83], v[96:99], v[32:35]
    ds_read_b128 v[172:175], v221 offset:1600
    v_mfma_f32_16x16x32_bf16 v[36:39], v[68:71], v[112:115], v[36:39]
    v_mfma_f32_16x16x32_bf16 v[36:39], v[80:83], v[100:103], v[36:39]
    ds_read_b64 v[144:145], v220 offset:1600
    v_mfma_f32_16x16x32_bf16 v[40:43], v[72:75], v[112:115], v[40:43]
    ds_read_b64 v[146:147], v220 offset:1608
    v_mfma_f32_16x16x32_bf16 v[40:43], v[80:83], v[104:107], v[40:43]
    v_mfma_f32_16x16x32_bf16 v[44:47], v[76:79], v[112:115], 0
    ds_read_b128 v[176:179], v221 offset:2112
    v_mfma_f32_16x16x32_bf16 v[44:47], v[80:83], v[108:111], v[44:47]
    ds_read_b64 v[148:149], v220 offset:1088
    s_waitcnt lgkmcnt(15)
    v_mfma_f32_16x16x32_bf16 v[36:39], v[64:67], v[116:119], v[36:39]
    v_mfma_f32_16x16x32_bf16 v[36:39], v[84:87], v[96:99], v[36:39]
    ds_read_b64 v[150:151], v220 offset:1096
    v_mfma_f32_16x16x32_bf16 v[40:43], v[68:71], v[116:119], v[40:43]
    ds_read_b128 v[180:183], v221 offset:2624
    v_mfma_f32_16x16x32_bf16 v[40:43], v[84:87], v[100:103], v[40:43]
    v_mfma_f32_16x16x32_bf16 v[44:47], v[72:75], v[116:119], v[44:47]
    ds_read_b64 v[152:153], v220 offset:576
    v_mfma_f32_16x16x32_bf16 v[44:47], v[84:87], v[104:107], v[44:47]
    ds_read_b64 v[154:155], v220 offset:584
    v_mfma_f32_16x16x32_bf16 v[40:43], v[64:67], v[120:123], v[40:43]
    v_mfma_f32_16x16x32_bf16 v[40:43], v[88:91], v[96:99], v[40:43]
    ds_read_b128 v[184:187], v221 offset:3136
    v_mfma_f32_16x16x32_bf16 v[44:47], v[68:71], v[120:123], v[44:47]
    ds_read_b64 v[156:157], v220 offset:64
    v_mfma_f32_16x16x32_bf16 v[44:47], v[88:91], v[100:103], v[44:47]
    v_mfma_f32_16x16x32_bf16 v[44:47], v[64:67], v[124:127], v[44:47]
    ds_read_b64 v[158:159], v220 offset:72
    v_mfma_f32_16x16x32_bf16 v[44:47], v[92:95], v[96:99], v[44:47]
    ds_read_b128 v[188:191], v221 offset:3648
    s_waitcnt lgkmcnt(15)
    v_mfma_f32_16x16x32_bf16 v[16:19], v[128:131], v[160:163], v[16:19]
    v_mfma_f32_16x16x32_bf16 v[20:23], v[128:131], v[164:167], v[20:23]
    ds_read_b64 v[64:65], v220 offset:3712
    v_mfma_f32_16x16x32_bf16 v[20:23], v[132:135], v[160:163], v[20:23]
    ds_read_b64 v[66:67], v220 offset:3720
    v_mfma_f32_16x16x32_bf16 v[24:27], v[132:135], v[164:167], v[24:27]
    v_mfma_f32_16x16x32_bf16 v[24:27], v[128:131], v[168:171], v[24:27]
    ds_read_b128 v[96:99], v221 offset:128
    v_mfma_f32_16x16x32_bf16 v[24:27], v[136:139], v[160:163], v[24:27]
    ds_read_b64 v[68:69], v220 offset:3200
    v_mfma_f32_16x16x32_bf16 v[28:31], v[132:135], v[168:171], v[28:31]
    v_mfma_f32_16x16x32_bf16 v[28:31], v[136:139], v[164:167], v[28:31]
    ds_read_b64 v[70:71], v220 offset:3208
    v_mfma_f32_16x16x32_bf16 v[32:35], v[136:139], v[168:171], v[32:35]
    ds_read_b128 v[100:103], v221 offset:640
    s_waitcnt lgkmcnt(15)
    v_mfma_f32_16x16x32_bf16 v[28:31], v[128:131], v[172:175], v[28:31]
    v_mfma_f32_16x16x32_bf16 v[28:31], v[140:143], v[160:163], v[28:31]
    ds_read_b64 v[72:73], v220 offset:2688
    v_mfma_f32_16x16x32_bf16 v[32:35], v[132:135], v[172:175], v[32:35]
    ds_read_b64 v[74:75], v220 offset:2696
    v_mfma_f32_16x16x32_bf16 v[32:35], v[140:143], v[164:167], v[32:35]
    v_mfma_f32_16x16x32_bf16 v[36:39], v[136:139], v[172:175], v[36:39]
    ds_read_b128 v[104:107], v221 offset:1152
    v_mfma_f32_16x16x32_bf16 v[36:39], v[140:143], v[168:171], v[36:39]
    ds_read_b64 v[76:77], v220 offset:2176
    v_mfma_f32_16x16x32_bf16 v[40:43], v[140:143], v[172:175], v[40:43]
    v_mfma_f32_16x16x32_bf16 v[32:35], v[128:131], v[176:179], v[32:35]
    ds_read_b64 v[78:79], v220 offset:2184
    v_mfma_f32_16x16x32_bf16 v[32:35], v[144:147], v[160:163], v[32:35]
    ds_read_b128 v[108:111], v221 offset:1664
    v_mfma_f32_16x16x32_bf16 v[36:39], v[132:135], v[176:179], v[36:39]
    v_mfma_f32_16x16x32_bf16 v[36:39], v[144:147], v[164:167], v[36:39]
    ds_read_b64 v[80:81], v220 offset:1664
    v_mfma_f32_16x16x32_bf16 v[40:43], v[136:139], v[176:179], v[40:43]
    ds_read_b64 v[82:83], v220 offset:1672
    v_mfma_f32_16x16x32_bf16 v[40:43], v[144:147], v[168:171], v[40:43]
    v_mfma_f32_16x16x32_bf16 v[44:47], v[140:143], v[176:179], v[44:47]
    ds_read_b128 v[112:115], v221 offset:2176
    v_mfma_f32_16x16x32_bf16 v[44:47], v[144:147], v[172:175], v[44:47]
    ds_read_b64 v[84:85], v220 offset:1152
    s_waitcnt lgkmcnt(15)
    v_mfma_f32_16x16x32_bf16 v[36:39], v[128:131], v[180:183], v[36:39]
    v_mfma_f32_16x16x32_bf16 v[36:39], v[148:151], v[160:163], v[36:39]
    ds_read_b64 v[86:87], v220 offset:1160
    v_mfma_f32_16x16x32_bf16 v[40:43], v[132:135], v[180:183], v[40:43]
    ds_read_b128 v[116:119], v221 offset:2688
    v_mfma_f32_16x16x32_bf16 v[40:43], v[148:151], v[164:167], v[40:43]
    v_mfma_f32_16x16x32_bf16 v[44:47], v[136:139], v[180:183], v[44:47]
    ds_read_b64 v[88:89], v220 offset:640
    v_mfma_f32_16x16x32_bf16 v[44:47], v[148:151], v[168:171], v[44:47]
    ds_read_b64 v[90:91], v220 offset:648
    v_mfma_f32_16x16x32_bf16 v[40:43], v[128:131], v[184:187], v[40:43]
    v_mfma_f32_16x16x32_bf16 v[40:43], v[152:155], v[160:163], v[40:43]
    ds_read_b128 v[120:123], v221 offset:3200
    v_mfma_f32_16x16x32_bf16 v[44:47], v[132:135], v[184:187], v[44:47]
    ds_read_b64 v[92:93], v220 offset:128
    v_mfma_f32_16x16x32_bf16 v[44:47], v[152:155], v[164:167], v[44:47]
    v_mfma_f32_16x16x32_bf16 v[44:47], v[128:131], v[188:191], v[44:47]
    ds_read_b64 v[94:95], v220 offset:136
    v_mfma_f32_16x16x32_bf16 v[44:47], v[156:159], v[160:163], v[44:47]
    ds_read_b128 v[124:127], v221 offset:3712
    s_waitcnt lgkmcnt(15)
    v_mfma_f32_16x16x32_bf16 v[16:19], v[64:67], v[96:99], v[16:19]
    v_mfma_f32_16x16x32_bf16 v[20:23], v[64:67], v[100:103], v[20:23]
    ds_read_b64 v[128:129], v220 offset:3776
    v_mfma_f32_16x16x32_bf16 v[20:23], v[68:71], v[96:99], v[20:23]
    ds_read_b64 v[130:131], v220 offset:3784
    v_mfma_f32_16x16x32_bf16 v[24:27], v[68:71], v[100:103], v[24:27]
    v_mfma_f32_16x16x32_bf16 v[24:27], v[64:67], v[104:107], v[24:27]
    ds_read_b128 v[160:163], v221 offset:192
    v_mfma_f32_16x16x32_bf16 v[24:27], v[72:75], v[96:99], v[24:27]
    ds_read_b64 v[132:133], v220 offset:3264
    v_mfma_f32_16x16x32_bf16 v[28:31], v[68:71], v[104:107], v[28:31]
    v_mfma_f32_16x16x32_bf16 v[28:31], v[72:75], v[100:103], v[28:31]
    ds_read_b64 v[134:135], v220 offset:3272
    v_mfma_f32_16x16x32_bf16 v[32:35], v[72:75], v[104:107], v[32:35]
    ds_read_b128 v[164:167], v221 offset:704
    s_waitcnt lgkmcnt(15)
    v_mfma_f32_16x16x32_bf16 v[28:31], v[64:67], v[108:111], v[28:31]
    v_mfma_f32_16x16x32_bf16 v[28:31], v[76:79], v[96:99], v[28:31]
    ds_read_b64 v[136:137], v220 offset:2752
    v_mfma_f32_16x16x32_bf16 v[32:35], v[68:71], v[108:111], v[32:35]
    ds_read_b64 v[138:139], v220 offset:2760
    v_mfma_f32_16x16x32_bf16 v[32:35], v[76:79], v[100:103], v[32:35]
    v_mfma_f32_16x16x32_bf16 v[36:39], v[72:75], v[108:111], v[36:39]
    ds_read_b128 v[168:171], v221 offset:1216
    v_mfma_f32_16x16x32_bf16 v[36:39], v[76:79], v[104:107], v[36:39]
    ds_read_b64 v[140:141], v220 offset:2240
    v_mfma_f32_16x16x32_bf16 v[40:43], v[76:79], v[108:111], v[40:43]
    v_mfma_f32_16x16x32_bf16 v[32:35], v[64:67], v[112:115], v[32:35]
    ds_read_b64 v[142:143], v220 offset:2248
    v_mfma_f32_16x16x32_bf16 v[32:35], v[80:83], v[96:99], v[32:35]
    ds_read_b128 v[172:175], v221 offset:1728
    v_mfma_f32_16x16x32_bf16 v[36:39], v[68:71], v[112:115], v[36:39]
    v_mfma_f32_16x16x32_bf16 v[36:39], v[80:83], v[100:103], v[36:39]
    ds_read_b64 v[144:145], v220 offset:1728
    v_mfma_f32_16x16x32_bf16 v[40:43], v[72:75], v[112:115], v[40:43]
    ds_read_b64 v[146:147], v220 offset:1736
    v_mfma_f32_16x16x32_bf16 v[40:43], v[80:83], v[104:107], v[40:43]
    v_mfma_f32_16x16x32_bf16 v[44:47], v[76:79], v[112:115], v[44:47]
    ds_read_b128 v[176:179], v221 offset:2240
    v_mfma_f32_16x16x32_bf16 v[44:47], v[80:83], v[108:111], v[44:47]
    ds_read_b64 v[148:149], v220 offset:1216
    s_waitcnt lgkmcnt(15)
    v_mfma_f32_16x16x32_bf16 v[36:39], v[64:67], v[116:119], v[36:39]
    v_mfma_f32_16x16x32_bf16 v[36:39], v[84:87], v[96:99], v[36:39]
    ds_read_b64 v[150:151], v220 offset:1224
    v_mfma_f32_16x16x32_bf16 v[40:43], v[68:71], v[116:119], v[40:43]
    ds_read_b128 v[180:183], v221 offset:2752
    v_mfma_f32_16x16x32_bf16 v[40:43], v[84:87], v[100:103], v[40:43]
    v_mfma_f32_16x16x32_bf16 v[44:47], v[72:75], v[116:119], v[44:47]
    ds_read_b64 v[152:153], v220 offset:704
    v_mfma_f32_16x16x32_bf16 v[44:47], v[84:87], v[104:107], v[44:47]
    ds_read_b64 v[154:155], v220 offset:712
    v_mfma_f32_16x16x32_bf16 v[40:43], v[64:67], v[120:123], v[40:43]
    v_mfma_f32_16x16x32_bf16 v[40:43], v[88:91], v[96:99], v[40:43]
    ds_read_b128 v[184:187], v221 offset:3264
    v_mfma_f32_16x16x32_bf16 v[44:47], v[68:71], v[120:123], v[44:47]
    ds_read_b64 v[156:157], v220 offset:192
    v_mfma_f32_16x16x32_bf16 v[44:47], v[88:91], v[100:103], v[44:47]
    v_mfma_f32_16x16x32_bf16 v[44:47], v[64:67], v[124:127], v[44:47]
    ds_read_b64 v[158:159], v220 offset:200
    v_mfma_f32_16x16x32_bf16 v[44:47], v[92:95], v[96:99], v[44:47]
    ds_read_b128 v[188:191], v221 offset:3776
    s_waitcnt lgkmcnt(15)
    v_mfma_f32_16x16x32_bf16 v[16:19], v[128:131], v[160:163], v[16:19]
    v_mfma_f32_16x16x32_bf16 v[20:23], v[128:131], v[164:167], v[20:23]
    v_mfma_f32_16x16x32_bf16 v[20:23], v[132:135], v[160:163], v[20:23]
    v_mfma_f32_16x16x32_bf16 v[24:27], v[128:131], v[168:171], v[24:27]
    v_mfma_f32_16x16x32_bf16 v[24:27], v[132:135], v[164:167], v[24:27]
    v_mfma_f32_16x16x32_bf16 v[24:27], v[136:139], v[160:163], v[24:27]
    s_waitcnt lgkmcnt(12)
    v_mfma_f32_16x16x32_bf16 v[28:31], v[128:131], v[172:175], v[28:31]
    v_mfma_f32_16x16x32_bf16 v[28:31], v[132:135], v[168:171], v[28:31]
    v_mfma_f32_16x16x32_bf16 v[28:31], v[136:139], v[164:167], v[28:31]
    v_mfma_f32_16x16x32_bf16 v[28:31], v[140:143], v[160:163], v[28:31]
    s_waitcnt lgkmcnt(9)
    v_mfma_f32_16x16x32_bf16 v[32:35], v[128:131], v[176:179], v[32:35]
    v_mfma_f32_16x16x32_bf16 v[32:35], v[132:135], v[172:175], v[32:35]
    v_mfma_f32_16x16x32_bf16 v[32:35], v[136:139], v[168:171], v[32:35]
    ds_write_b128 v222, v[16:19] offset:0
    v_mfma_f32_16x16x32_bf16 v[32:35], v[140:143], v[164:167], v[32:35]
    v_mfma_f32_16x16x32_bf16 v[32:35], v[144:147], v[160:163], v[32:35]
    s_waitcnt lgkmcnt(7)
    v_mfma_f32_16x16x32_bf16 v[36:39], v[128:131], v[180:183], v[36:39]
    ds_write_b128 v222, v[20:23] offset:1024
    v_mfma_f32_16x16x32_bf16 v[36:39], v[132:135], v[176:179], v[36:39]
    v_mfma_f32_16x16x32_bf16 v[36:39], v[136:139], v[172:175], v[36:39]
    v_mfma_f32_16x16x32_bf16 v[36:39], v[140:143], v[168:171], v[36:39]
    ds_write_b128 v222, v[24:27] offset:2048
    v_mfma_f32_16x16x32_bf16 v[36:39], v[144:147], v[164:167], v[36:39]
    v_mfma_f32_16x16x32_bf16 v[36:39], v[148:151], v[160:163], v[36:39]
    s_waitcnt lgkmcnt(6)
    v_mfma_f32_16x16x32_bf16 v[40:43], v[128:131], v[184:187], v[40:43]
    ds_write_b128 v222, v[28:31] offset:3072
    v_mfma_f32_16x16x32_bf16 v[40:43], v[132:135], v[180:183], v[40:43]
    v_mfma_f32_16x16x32_bf16 v[40:43], v[136:139], v[176:179], v[40:43]
    v_mfma_f32_16x16x32_bf16 v[40:43], v[140:143], v[172:175], v[40:43]
    ds_write_b128 v222, v[32:35] offset:4096
    v_mfma_f32_16x16x32_bf16 v[40:43], v[144:147], v[168:171], v[40:43]
    v_mfma_f32_16x16x32_bf16 v[40:43], v[148:151], v[164:167], v[40:43]
    v_mfma_f32_16x16x32_bf16 v[40:43], v[152:155], v[160:163], v[40:43]
    s_waitcnt lgkmcnt(5)
    v_mfma_f32_16x16x32_bf16 v[44:47], v[128:131], v[188:191], v[44:47]
    v_mfma_f32_16x16x32_bf16 v[44:47], v[132:135], v[184:187], v[44:47]
    ds_write_b128 v222, v[36:39] offset:5120
    v_mfma_f32_16x16x32_bf16 v[44:47], v[136:139], v[180:183], v[44:47]
    v_mfma_f32_16x16x32_bf16 v[44:47], v[140:143], v[176:179], v[44:47]
    v_mfma_f32_16x16x32_bf16 v[44:47], v[144:147], v[172:175], v[44:47]
    v_mfma_f32_16x16x32_bf16 v[44:47], v[148:151], v[168:171], v[44:47]
    v_mfma_f32_16x16x32_bf16 v[44:47], v[152:155], v[164:167], v[44:47]
    v_mfma_f32_16x16x32_bf16 v[44:47], v[156:159], v[160:163], v[44:47]
    ds_write_b128 v222, v[40:43] offset:6144
    s_nop 6
    ds_write_b128 v222, v[44:47] offset:7168
    s_setprio 0
    s_waitcnt lgkmcnt(0)
    s_barrier
    s_cmp_lg_u32 s3, 0
    s_cbranch_scc1 L_wm_13
    s_call_b64 s[100:101], L_stub3
    s_call_b64 s[100:101], L_stub7
L_wm_13:
    s_cmp_lg_u32 s3, 1
    s_cbranch_scc1 L_wm_14
    s_call_b64 s[100:101], L_stub4
    s_call_b64 s[100:101], L_stub8
L_wm_14:
    s_cmp_lg_u32 s3, 2
    s_cbranch_scc1 L_wm_15
    s_call_b64 s[100:101], L_stub5
L_wm_15:
    s_cmp_lg_u32 s3, 3
    s_cbranch_scc1 L_wm_16
    s_call_b64 s[100:101], L_stub6
L_wm_16:
    v_mov_b32 v60, 163784
    s_mov_b32 s9, 400000
    s_waitcnt lgkmcnt(0)
L_cw_17:
    ds_read_b32 v61, v60
    s_waitcnt lgkmcnt(0)
    v_cmp_gt_u32 vcc, 4, v61
    s_cbranch_vccz L_cok_18
    s_sub_u32 s9, s9, 1
    s_cmp_lg_u32 s9, 0
    s_cbranch_scc1 L_cw_17
L_cok_18:
    s_and_b32 s73, s6, 3
    s_mul_i32 s73, s73, 4
    s_add_u32 s73, s73, 12
    s_add_u32 s68, s73, s74
    s_sub_u32 s69, s68, 28
    s_min_u32 s68, s68, s69
    s_mul_i32 s68, s68, 57344
    s_lshl_b32 s69, s73, 10
    s_add_u32 m0, s69, s75
    s_add_u32 s73, s73, 1
    buffer_load_dwordx4 v249, s[56:59], s68 offen lds
    s_cmp_eq_u32 s73, 28
    s_cselect_b32 s73, 12, s73
    s_add_u32 s68, s73, s74
    s_sub_u32 s69, s68, 28
    s_min_u32 s68, s68, s69
    s_mul_i32 s68, s68, 57344
    s_lshl_b32 s69, s73, 10
    s_add_u32 m0, s69, s75
    s_add_u32 s73, s73, 1
    buffer_load_dwordx4 v249, s[56:59], s68 offen lds
    s_cmp_eq_u32 s73, 28
    s_cselect_b32 s73, 12, s73
    s_add_u32 s68, s73, s74
    s_sub_u32 s69, s68, 28
    s_min_u32 s68, s68, s69
    s_mul_i32 s68, s68, 57344
    s_lshl_b32 s69, s73, 10
    s_add_u32 m0, s69, s75
    s_add_u32 s73, s73, 1
    buffer_load_dwordx4 v249, s[56:59], s68 offen lds
    s_cmp_eq_u32 s73, 28
    s_cselect_b32 s73, 12, s73
    s_add_u32 s68, s73, s74
    s_sub_u32 s69, s68, 28
    s_min_u32 s68, s68, s69
    s_mul_i32 s68, s68, 57344
    s_lshl_b32 s69, s73, 10
    s_add_u32 m0, s69, s75
    s_add_u32 s73, s73, 1
    buffer_load_dwordx4 v249, s[56:59], s68 offen lds
    s_cmp_eq_u32 s73, 28
    s_cselect_b32 s73, 12, s73
    s_add_u32 s68, s73, s74
    s_sub_u32 s69, s68, 28
    s_min_u32 s68, s68, s69
    s_mul_i32 s68, s68, 57344
    s_lshl_b32 s69, s73, 10
    s_add_u32 m0, s69, s75
    s_add_u32 s73, s73, 1
    buffer_load_dwordx4 v249, s[56:59], s68 offen lds
    s_cmp_eq_u32 s73, 28
    s_cselect_b32 s73, 12, s73
    s_add_u32 s68, s73, s74
    s_sub_u32 s69, s68, 28
    s_min_u32 s68, s68, s69
    s_mul_i32 s68, s68, 57344
    s_lshl_b32 s69, s73, 10
    s_add_u32 m0, s69, s75
    s_add_u32 s73, s73, 1
    buffer_load_dwordx4 v249, s[56:59], s68 offen lds
    s_cmp_eq_u32 s73, 28
    s_cselect_b32 s73, 12, s73
    s_add_u32 s68, s73, s74
    s_sub_u32 s69, s68, 28
    s_min_u32 s68, s68, s69
    s_mul_i32 s68, s68, 57344
    s_lshl_b32 s69, s73, 10
    s_add_u32 m0, s69, s75
    s_add_u32 s73, s73, 1
    buffer_load_dwordx4 v249, s[56:59], s68 offen lds
    s_cmp_eq_u32 s73, 28
    s_cselect_b32 s73, 12, s73
    s_add_u32 s68, s73, s74
    s_sub_u32 s69, s68, 28
    s_min_u32 s68, s68, s69
    s_mul_i32 s68, s68, 57344
    s_lshl_b32 s69, s73, 10
    s_add_u32 m0, s69, s75
    s_add_u32 s73, s73, 1
    buffer_load_dwordx4 v249, s[56:59], s68 offen lds
    s_cmp_eq_u32 s73, 28
    s_cselect_b32 s73, 12, s73
    s_add_u32 s68, s73, s74
    s_sub_u32 s69, s68, 28
    s_min_u32 s68, s68, s69
    s_mul_i32 s68, s68, 57344
    s_lshl_b32 s69, s73, 10
    s_add_u32 m0, s69, s75
    s_add_u32 s73, s73, 1
    buffer_load_dwordx4 v249, s[56:59], s68 offen lds
    s_cmp_eq_u32 s73, 28
    s_cselect_b32 s73, 12, s73
    s_add_u32 s68, s73, s74
    s_sub_u32 s69, s68, 28
    s_min_u32 s68, s68, s69
    s_mul_i32 s68, s68, 57344
    s_lshl_b32 s69, s73, 10
    s_add_u32 m0, s69, s75
    s_add_u32 s73, s73, 1
    buffer_load_dwordx4 v249, s[56:59], s68 offen lds
    s_cmp_eq_u32 s73, 28
    s_cselect_b32 s73, 12, s73
    s_add_u32 s68, s73, s74
    s_sub_u32 s69, s68, 28
    s_min_u32 s68, s68, s69
    s_mul_i32 s68, s68, 57344
    s_lshl_b32 s69, s73, 10
    s_add_u32 m0, s69, s75
    s_add_u32 s73, s73, 1
    buffer_load_dwordx4 v249, s[56:59], s68 offen lds
    s_cmp_eq_u32 s73, 28
    s_cselect_b32 s73, 12, s73
    s_add_u32 s68, s73, s74
    s_sub_u32 s69, s68, 28
    s_min_u32 s68, s68, s69
    s_mul_i32 s68, s68, 57344
    s_lshl_b32 s69, s73, 10
    s_add_u32 m0, s69, s75
    s_add_u32 s73, s73, 1
    buffer_load_dwordx4 v249, s[56:59], s68 offen lds
    s_cmp_eq_u32 s73, 28
    s_cselect_b32 s73, 12, s73
    s_add_u32 s68, s73, s74
    s_sub_u32 s69, s68, 28
    s_min_u32 s68, s68, s69
    s_mul_i32 s68, s68, 57344
    s_lshl_b32 s69, s73, 10
    s_add_u32 m0, s69, s75
    s_add_u32 s73, s73, 1
    buffer_load_dwordx4 v249, s[56:59], s68 offen lds
    s_cmp_eq_u32 s73, 28
    s_cselect_b32 s73, 12, s73
    s_add_u32 s68, s73, s74
    s_sub_u32 s69, s68, 28
    s_min_u32 s68, s68, s69
    s_mul_i32 s68, s68, 57344
    s_lshl_b32 s69, s73, 10
    s_add_u32 m0, s69, s75
    s_add_u32 s73, s73, 1
    buffer_load_dwordx4 v249, s[56:59], s68 offen lds
    s_cmp_eq_u32 s73, 28
    s_cselect_b32 s73, 12, s73
    s_add_u32 s68, s73, s74
    s_sub_u32 s69, s68, 28
    s_min_u32 s68, s68, s69
    s_mul_i32 s68, s68, 57344
    s_lshl_b32 s69, s73, 10
    s_add_u32 m0, s69, s75
    s_add_u32 s73, s73, 1
    buffer_load_dwordx4 v249, s[56:59], s68 offen lds
    s_cmp_eq_u32 s73, 28
    s_cselect_b32 s73, 12, s73
    s_add_u32 s68, s73, s74
    s_sub_u32 s69, s68, 28
    s_min_u32 s68, s68, s69
    s_mul_i32 s68, s68, 57344
    s_lshl_b32 s69, s73, 10
    s_add_u32 m0, s69, s75
    s_add_u32 s73, s73, 1
    buffer_load_dwordx4 v249, s[56:59], s68 offen lds
    s_cmp_eq_u32 s73, 28
    s_cselect_b32 s73, 12, s73
    s_waitcnt lgkmcnt(0)
    s_branch L_join
.p2align 12
L_stub2:
    s_setpc_b64 s[100:101]
    s_nop 0
L_pg2:
L_grpB:
    s_cmp_lg_u32 s3, 0
    s_cbranch_scc1 L_wm_19
    s_call_b64 s[100:101], L_stub1
L_wm_19:
    s_waitcnt vmcnt(1)
    v_and_b32 v44, 0xffff, v172
    v_lshrrev_b32 v45, 16, v172
    v_and_b32 v46, 0xffff, v173
    v_lshrrev_b32 v47, 16, v173
    v_and_b32 v48, 0xffff, v174
    v_lshrrev_b32 v49, 16, v174
    v_and_b32 v50, 0xffff, v175
    v_lshrrev_b32 v51, 16, v175
    s_waitcnt vmcnt(0)
    v_and_b32 v52, 0xffff, v176
    v_lshrrev_b32 v53, 16, v176
    v_and_b32 v54, 0xffff, v177
    s_bitcmp1_b32 s3, 0
    s_cselect_b32 s56, s38, s36
    s_cselect_b32 s57, s39, s37
    s_mov_b32 s58, 1605632
    s_mov_b32 s59, 0x00020000
    v_lshrrev_b32 v249, 2, v1
    v_mul_u32_u24 v249, 3584, v249
    s_and_b32 s13, s3, 1
    s_lshl_b32 s13, s13, 1
    v_and_b32 v250, 3, v1
    v_xor_b32 v250, s13, v250
    v_lshl_add_u32 v249, v250, 4, v249
    s_lshl_b32 s13, s67, 7
    s_and_b32 s14, s3, 2
    s_lshl_b32 s14, s14, 5
    s_add_u32 s13, s13, s14
    v_add_u32 v249, s13, v249
    s_and_b32 s74, s6, 28
    s_mul_i32 s75, s3, 28672
    s_lshl_b32 s13, s7, 4
    s_add_u32 s13, s13, 4259840
    v_mov_b32 v184, s13
    v_add_u32 v185, 7168, v184
    v_add_u32 v187, 14336, v184
    v_lshlrev_b32 v211, 4, v186
    v_add_u32 v211, 131328, v211
    v_lshlrev_b32 v213, 2, v0
    v_add_u32 v213, 151424, v213
    v_lshlrev_b32 v214, 3, v0
    v_add_u32 v214, 98304, v214
    s_mul_i32 s12, s3, 8320
    s_add_u32 s12, s12, 118784
    v_bfe_u32 v212, v1, 1, 1
    v_mul_u32_u24 v212, 4160, v212
    v_and_b32 v216, 1, v1
    v_lshl_add_u32 v212, v216, 4, v212
    v_add_u32 v212, s12, v212
    v_mov_b32 v216, 0
    v_mov_b32 v217, 0
    v_mov_b32 v218, 0
    v_mov_b32 v219, 0
    s_mov_b32 s60, s40
    s_mov_b32 s61, s41
    s_mov_b32 s62, 1605632
    s_mov_b32 s63, 0x00020000
    s_lshl_b32 s12, s7, 2
    s_add_u32 s12, s12, s3
    s_mul_i32 s13, s12, 9363
    s_lshr_b32 s13, s13, 16
    s_mul_i32 s14, s13, 7
    s_sub_u32 s15, s12, s14
    s_lshr_b32 s14, s13, 1
    s_mul_i32 s14, s14, 7
    s_add_u32 s14, s14, s15
    s_lshl_b32 s14, s14, 1
    s_and_b32 s9, s13, 1
    s_add_u32 s14, s14, s9
    s_lshl_b32 s14, s14, 11
    s_add_u32 s14, s14, 16777216
    s_mul_i32 s13, s13, 14336
    s_lshl_b32 s15, s15, 7
    s_add_u32 s13, s13, s15
    s_cmp_lt_u32 s12, 784
    s_cselect_b32 s14, s14, 2147418112
    s_lshl_b32 s42, s12, 7
    s_add_u32 s42, s42, 4849664
    v_and_b32 v189, 31, v1
    v_lshrrev_b32 v190, 5, v1
    v_mul_u32_u24 v190, 3584, v190
    v_lshl_add_u32 v189, v189, 2, v190
    v_add_u32 v189, s13, v189
    v_add_u32 v190, 7168, v189
    v_lshl_add_u32 v191, v1, 4, s14
    buffer_load_dwordx4 v[152:155], v180, s[52:55], 0 offen sc1
    buffer_load_dwordx4 v[156:159], v181, s[52:55], 0 offen sc1
    buffer_load_dwordx4 v[160:163], v182, s[52:55], 0 offen sc1
    buffer_load_dwordx4 v[164:167], v183, s[52:55], 0 offen sc1
    s_waitcnt lgkmcnt(0)
    s_barrier
    ds_read_b64 v[64:65], v44 offset:18688
    ds_read_b64 v[66:67], v45 offset:18688
    ds_read_b64 v[68:69], v46 offset:18688
    ds_read_b64 v[70:71], v47 offset:18688
    ds_read_b64 v[72:73], v48 offset:18688
    ds_read_b64 v[74:75], v49 offset:18688
    ds_read_b64 v[76:77], v50 offset:18688
    ds_read_b64 v[78:79], v51 offset:18688
    ds_read_b64 v[80:81], v52 offset:18688
    ds_read_b64 v[82:83], v53 offset:18688
    ds_read_b64 v[84:85], v54 offset:18688
    s_mov_b64 exec, 0xf
    ds_write_b128 v212, v[216:219]
    s_mov_b64 exec, -1
    s_waitcnt lgkmcnt(11)
    v_add_f32 v64, v64, v65
    s_waitcnt lgkmcnt(10)
    v_add_f32 v66, v66, v67
    s_waitcnt lgkmcnt(9)
    v_add_f32 v68, v68, v69
    s_waitcnt lgkmcnt(8)
    v_add_f32 v70, v70, v71
    s_waitcnt lgkmcnt(7)
    v_add_f32 v72, v72, v73
    s_waitcnt lgkmcnt(6)
    v_add_f32 v74, v74, v75
    s_waitcnt lgkmcnt(5)
    v_add_f32 v76, v76, v77
    s_waitcnt lgkmcnt(4)
    v_add_f32 v78, v78, v79
    s_waitcnt lgkmcnt(3)
    v_add_f32 v80, v80, v81
    s_waitcnt lgkmcnt(2)
    v_add_f32 v82, v82, v83
    s_waitcnt lgkmcnt(1)
    v_add_f32 v84, v84, v85
    v_cvt_pk_bf16_f32 v96, v64, v66
    v_cvt_pk_bf16_f32 v97, v68, v70
    v_cvt_pk_bf16_f32 v98, v72, v74
    v_cvt_pk_bf16_f32 v99, v76, v78
    ds_write_b128 v211, v[96:99] offset:0
    v_cvt_pk_bf16_f32 v100, v66, v68
    v_cvt_pk_bf16_f32 v101, v70, v72
    v_cvt_pk_bf16_f32 v102, v74, v76
    v_cvt_pk_bf16_f32 v103, v78, v80
    ds_write_b128 v211, v[100:103] offset:4160
    v_cvt_pk_bf16_f32 v104, v68, v70
    v_cvt_pk_bf16_f32 v105, v72, v74
    v_cvt_pk_bf16_f32 v106, v76, v78
    v_cvt_pk_bf16_f32 v107, v80, v82
    ds_write_b128 v211, v[104:107] offset:8320
    v_cvt_pk_bf16_f32 v108, v70, v72
    v_cvt_pk_bf16_f32 v109, v74, v76
    v_cvt_pk_bf16_f32 v110, v78, v80
    v_cvt_pk_bf16_f32 v111, v82, v84
    ds_write_b128 v211, v[108:111] offset:12480
    s_waitcnt vmcnt(3)
    v_bitop3_b32 v64, v153, v155, s8 bitop3:0x7e
    s_waitcnt vmcnt(2)
    v_bitop3_b32 v65, v157, v159, s8 bitop3:0x7e
    s_waitcnt vmcnt(1)
    v_bitop3_b32 v66, v161, v163, s8 bitop3:0x7e
    s_waitcnt vmcnt(0)
    v_bitop3_b32 v67, v165, v167, s8 bitop3:0x7e
    v_or3_b32 v64, v64, v65, v66
    v_or_b32 v60, v67, v64
    v_cmp_ne_u32 vcc, 0, v60
    s_cbranch_vccz L_ok_20
    s_mov_b32 s9, 20000
L_spin_21:
    s_mov_b64 exec, vcc
    buffer_load_dwordx4 v[152:155], v180, s[52:55], 0 offen sc1
    buffer_load_dwordx4 v[156:159], v181, s[52:55], 0 offen sc1
    buffer_load_dwordx4 v[160:163], v182, s[52:55], 0 offen sc1
    buffer_load_dwordx4 v[164:167], v183, s[52:55], 0 offen sc1
    s_waitcnt vmcnt(3)
    v_bitop3_b32 v64, v153, v155, s8 bitop3:0x7e
    s_waitcnt vmcnt(2)
    v_bitop3_b32 v65, v157, v159, s8 bitop3:0x7e
    s_waitcnt vmcnt(1)
    v_bitop3_b32 v66, v161, v163, s8 bitop3:0x7e
    s_waitcnt vmcnt(0)
    v_bitop3_b32 v67, v165, v167, s8 bitop3:0x7e
    v_or3_b32 v64, v64, v65, v66
    v_or_b32 v60, v67, v64
    v_cmp_ne_u32 vcc, 0, v60
    s_cbranch_vccz L_out_22
    s_sub_u32 s9, s9, 1
    s_cmp_lg_u32 s9, 0
    s_cbranch_scc1 L_spin_21
L_out_22:
    s_mov_b64 exec, -1
L_ok_20:
    v_and_b32 v65, 0xffff0000, v160
    v_lshlrev_b32 v64, 16, v160
    v_rcp_f32 v65, v65
    v_and_b32 v67, 0xffff0000, v162
    v_lshlrev_b32 v66, 16, v162
    v_rcp_f32 v67, v67
    v_and_b32 v69, 0xffff0000, v164
    v_lshlrev_b32 v68, 16, v164
    v_rcp_f32 v69, v69
    v_and_b32 v71, 0xffff0000, v166
    v_lshlrev_b32 v70, 16, v166
    v_rcp_f32 v71, v71
    v_lshlrev_b32 v80, 16, v152
    v_and_b32 v81, 0xffff0000, v152
    v_lshlrev_b32 v82, 16, v154
    v_and_b32 v83, 0xffff0000, v154
    v_lshlrev_b32 v84, 16, v156
    v_and_b32 v85, 0xffff0000, v156
    v_lshlrev_b32 v86, 16, v158
    v_and_b32 v87, 0xffff0000, v158
    v_sub_f32 v80, v80, v64
    v_sub_f32 v81, v81, v64
    v_sub_f32 v82, v82, v66
    v_sub_f32 v83, v83, v66
    v_sub_f32 v84, v84, v68
    v_sub_f32 v85, v85, v68
    v_sub_f32 v86, v86, v70
    v_sub_f32 v87, v87, v70
    v_mul_f32 v80, v80, v65
    v_mul_f32 v81, v81, v65
    v_mul_f32 v82, v82, v67
    v_mul_f32 v83, v83, v67
    v_mul_f32 v84, v84, v69
    v_mul_f32 v85, v85, v69
    v_mul_f32 v86, v86, v71
    v_mul_f32 v87, v87, v71
    v_cvt_pk_bf16_f32 v64, v80, v82
    ds_write_b32 v213, v64 offset:480
    v_cvt_pk_bf16_f32 v65, v81, v83
    ds_write_b32 v213, v65 offset:5056
    v_cvt_pk_bf16_f32 v66, v84, v86
    ds_write_b32 v213, v66 offset:2528
    v_cvt_pk_bf16_f32 v67, v85, v87
    ds_write_b32 v213, v67 offset:7104
    v_mov_b32 v153, v154
    ds_write_b64 v214, v[152:153] offset:0
    v_mov_b32 v157, v158
    ds_write_b64 v214, v[156:157] offset:4096
    s_waitcnt lgkmcnt(0)
    s_barrier
    s_setprio 0
    buffer_load_dword v136, v189, s[60:63], 0 offen offset:0
    buffer_load_dword v137, v189, s[60:63], 0 offen offset:896
    buffer_load_dword v138, v189, s[60:63], 0 offen offset:1792
    buffer_load_dword v139, v189, s[60:63], 0 offen offset:2688
    buffer_load_dword v140, v190, s[60:63], 0 offen offset:0
    buffer_load_dword v141, v190, s[60:63], 0 offen offset:896
    buffer_load_dword v142, v190, s[60:63], 0 offen offset:1792
    buffer_load_dword v143, v190, s[60:63], 0 offen offset:2688
    v_lshlrev_b32 v11, 4, v186
    v_add_u32 v11, 98304, v11
    ds_read_b128 v[152:155], v11 offset:0
    ds_read_b128 v[156:159], v11 offset:4096
    s_waitcnt lgkmcnt(1)
    v_lshlrev_b32 v120, 16, v152
    v_and_b32 v121, 0xffff0000, v152
    v_lshlrev_b32 v122, 16, v153
    v_and_b32 v123, 0xffff0000, v153
    s_and_b32 s73, s6, 3
    s_mul_i32 s73, s73, 3
    s_add_u32 s73, s73, 0
    s_add_u32 s68, s73, s74
    s_sub_u32 s69, s68, 28
    s_min_u32 s68, s68, s69
    s_mul_i32 s68, s68, 57344
    s_lshl_b32 s69, s73, 10
    s_add_u32 m0, s69, s75
    s_add_u32 s73, s73, 1
    buffer_load_dwordx4 v249, s[56:59], s68 offen lds
    s_cmp_eq_u32 s73, 12
    s_cselect_b32 s73, 0, s73
    v_lshlrev_b32 v124, 16, v154
    v_and_b32 v125, 0xffff0000, v154
    v_lshlrev_b32 v126, 16, v155
    v_and_b32 v127, 0xffff0000, v155
    s_waitcnt lgkmcnt(0)
    v_lshlrev_b32 v128, 16, v156
    v_and_b32 v129, 0xffff0000, v156
    v_lshlrev_b32 v130, 16, v157
    v_and_b32 v131, 0xffff0000, v157
    s_add_u32 s68, s73, s74
    s_sub_u32 s69, s68, 28
    s_min_u32 s68, s68, s69
    s_mul_i32 s68, s68, 57344
    s_lshl_b32 s69, s73, 10
    s_add_u32 m0, s69, s75
    s_add_u32 s73, s73, 1
    buffer_load_dwordx4 v249, s[56:59], s68 offen lds
    s_cmp_eq_u32 s73, 12
    s_cselect_b32 s73, 0, s73
    v_lshlrev_b32 v132, 16, v158
    v_and_b32 v133, 0xffff0000, v158
    v_lshlrev_b32 v134, 16, v159
    v_and_b32 v135, 0xffff0000, v159
    v_lshlrev_b32 v10, 3, v1
    v_sub_u32 v10, 115192, v10
    s_lshl_b32 s12, s3, 9
    v_subrev_u32 v11, s12, v10
    s_add_u32 s68, s73, s74
    s_sub_u32 s69, s68, 28
    s_min_u32 s68, s68, s69
    s_mul_i32 s68, s68, 57344
    s_lshl_b32 s69, s73, 10
    s_add_u32 m0, s69, s75
    s_add_u32 s73, s73, 1
    buffer_load_dwordx4 v249, s[56:59], s68 offen lds
    s_cmp_eq_u32 s73, 12
    s_cselect_b32 s73, 0, s73
    ds_read_b64 v[108:109], v11 offset:3584
    ds_read_b64 v[110:111], v11 offset:20224
    ds_read_b64 v[112:113], v11 offset:1536
    ds_read_b64 v[114:115], v11 offset:18176
    s_waitcnt lgkmcnt(3)
    v_and_b32 v64, 0xffff0000, v109
    v_lshlrev_b32 v65, 16, v109
    v_and_b32 v66, 0xffff0000, v108
    v_lshlrev_b32 v67, 16, v108
    s_add_u32 s68, s73, s74
    s_sub_u32 s69, s68, 28
    s_min_u32 s68, s68, s69
    s_mul_i32 s68, s68, 57344
    s_lshl_b32 s69, s73, 10
    s_add_u32 m0, s69, s75
    s_add_u32 s73, s73, 1
    buffer_load_dwordx4 v249, s[56:59], s68 offen lds
    s_cmp_eq_u32 s73, 12
    s_cselect_b32 s73, 0, s73
    v_add_f32 v65, v64, v65
    v_add_f32 v66, v65, v66
    v_add_f32 v67, v66, v67
    v_mov_b32 v48, v67
    s_waitcnt lgkmcnt(2)
    v_and_b32 v68, 0xffff0000, v111
    v_lshlrev_b32 v69, 16, v111
    v_and_b32 v70, 0xffff0000, v110
    v_lshlrev_b32 v71, 16, v110
    s_add_u32 s68, s73, s74
    s_sub_u32 s69, s68, 28
    s_min_u32 s68, s68, s69
    s_mul_i32 s68, s68, 57344
    s_lshl_b32 s69, s73, 10
    s_add_u32 m0, s69, s75
    s_add_u32 s73, s73, 1
    buffer_load_dwordx4 v249, s[56:59], s68 offen lds
    s_cmp_eq_u32 s73, 12
    s_cselect_b32 s73, 0, s73
    v_add_f32 v69, v68, v69
    v_add_f32 v70, v69, v70
    v_add_f32 v71, v70, v71
    v_mov_b32 v49, v71
    s_waitcnt lgkmcnt(1)
    v_and_b32 v72, 0xffff0000, v113
    v_lshlrev_b32 v73, 16, v113
    v_and_b32 v74, 0xffff0000, v112
    v_lshlrev_b32 v75, 16, v112
    s_add_u32 s68, s73, s74
    s_sub_u32 s69, s68, 28
    s_min_u32 s68, s68, s69
    s_mul_i32 s68, s68, 57344
    s_lshl_b32 s69, s73, 10
    s_add_u32 m0, s69, s75
    s_add_u32 s73, s73, 1
    buffer_load_dwordx4 v249, s[56:59], s68 offen lds
    s_cmp_eq_u32 s73, 12
    s_cselect_b32 s73, 0, s73
    v_add_f32 v73, v72, v73
    v_add_f32 v74, v73, v74
    v_add_f32 v75, v74, v75
    v_mov_b32 v50, v75
    s_waitcnt lgkmcnt(0)
    v_and_b32 v76, 0xffff0000, v115
    v_lshlrev_b32 v77, 16, v115
    v_and_b32 v78, 0xffff0000, v114
    v_lshlrev_b32 v79, 16, v114
    s_add_u32 s68, s73, s74
    s_sub_u32 s69, s68, 28
    s_min_u32 s68, s68, s69
    s_mul_i32 s68, s68, 57344
    s_lshl_b32 s69, s73, 10
    s_add_u32 m0, s69, s75
    s_add_u32 s73, s73, 1
    buffer_load_dwordx4 v249, s[56:59], s68 offen lds
    s_cmp_eq_u32 s73, 12
    s_cselect_b32 s73, 0, s73
    v_add_f32 v77, v76, v77
    v_add_f32 v78, v77, v78
    v_add_f32 v79, v78, v79
    v_mov_b32 v51, v79
    v_add_f32_dpp v48, v48, v48 row_shr:1 row_mask:0xf bank_mask:0xf bound_ctrl:0
    v_add_f32_dpp v49, v49, v49 row_shr:1 row_mask:0xf bank_mask:0xf bound_ctrl:0
    v_add_f32_dpp v50, v50, v50 row_shr:1 row_mask:0xf bank_mask:0xf bound_ctrl:0
    v_add_f32_dpp v51, v51, v51 row_shr:1 row_mask:0xf bank_mask:0xf bound_ctrl:0
    s_add_u32 s68, s73, s74
    s_sub_u32 s69, s68, 28
    s_min_u32 s68, s68, s69
    s_mul_i32 s68, s68, 57344
    s_lshl_b32 s69, s73, 10
    s_add_u32 m0, s69, s75
    s_add_u32 s73, s73, 1
    buffer_load_dwordx4 v249, s[56:59], s68 offen lds
    s_cmp_eq_u32 s73, 12
    s_cselect_b32 s73, 0, s73
    v_add_f32_dpp v48, v48, v48 row_shr:2 row_mask:0xf bank_mask:0xf bound_ctrl:0
    v_add_f32_dpp v49, v49, v49 row_shr:2 row_mask:0xf bank_mask:0xf bound_ctrl:0
    v_add_f32_dpp v50, v50, v50 row_shr:2 row_mask:0xf bank_mask:0xf bound_ctrl:0
    v_add_f32_dpp v51, v51, v51 row_shr:2 row_mask:0xf bank_mask:0xf bound_ctrl:0
    v_add_f32_dpp v48, v48, v48 row_shr:4 row_mask:0xf bank_mask:0xf bound_ctrl:0
    v_add_f32_dpp v49, v49, v49 row_shr:4 row_mask:0xf bank_mask:0xf bound_ctrl:0
    v_add_f32_dpp v50, v50, v50 row_shr:4 row_mask:0xf bank_mask:0xf bound_ctrl:0
    v_add_f32_dpp v51, v51, v51 row_shr:4 row_mask:0xf bank_mask:0xf bound_ctrl:0
    s_add_u32 s68, s73, s74
    s_sub_u32 s69, s68, 28
    s_min_u32 s68, s68, s69
    s_mul_i32 s68, s68, 57344
    s_lshl_b32 s69, s73, 10
    s_add_u32 m0, s69, s75
    s_add_u32 s73, s73, 1
    buffer_load_dwordx4 v249, s[56:59], s68 offen lds
    s_cmp_eq_u32 s73, 12
    s_cselect_b32 s73, 0, s73
    v_add_f32_dpp v48, v48, v48 row_shr:8 row_mask:0xf bank_mask:0xf bound_ctrl:0
    v_add_f32_dpp v49, v49, v49 row_shr:8 row_mask:0xf bank_mask:0xf bound_ctrl:0
    v_add_f32_dpp v50, v50, v50 row_shr:8 row_mask:0xf bank_mask:0xf bound_ctrl:0
    v_add_f32_dpp v51, v51, v51 row_shr:8 row_mask:0xf bank_mask:0xf bound_ctrl:0
    v_add_f32_dpp v48, v48, v48 row_bcast:15 row_mask:0xa bank_mask:0xf
    v_add_f32_dpp v49, v49, v49 row_bcast:15 row_mask:0xa bank_mask:0xf
    v_add_f32_dpp v50, v50, v50 row_bcast:15 row_mask:0xa bank_mask:0xf
    v_add_f32_dpp v51, v51, v51 row_bcast:15 row_mask:0xa bank_mask:0xf
    s_add_u32 s68, s73, s74
    s_sub_u32 s69, s68, 28
    s_min_u32 s68, s68, s69
    s_mul_i32 s68, s68, 57344
    s_lshl_b32 s69, s73, 10
    s_add_u32 m0, s69, s75
    s_add_u32 s73, s73, 1
    buffer_load_dwordx4 v249, s[56:59], s68 offen lds
    s_cmp_eq_u32 s73, 12
    s_cselect_b32 s73, 0, s73
    v_add_f32_dpp v48, v48, v48 row_bcast:31 row_mask:0xc bank_mask:0xf
    v_add_f32_dpp v49, v49, v49 row_bcast:31 row_mask:0xc bank_mask:0xf
    v_add_f32_dpp v50, v50, v50 row_bcast:31 row_mask:0xc bank_mask:0xf
    v_add_f32_dpp v51, v51, v51 row_bcast:31 row_mask:0xc bank_mask:0xf
    s_lshl_b32 s12, s3, 4
    v_mov_b32 v11, 160576
    v_add_u32 v10, s12, v11
    s_mov_b32 exec_lo, 0
    s_mov_b32 exec_hi, 0x80000000
    ds_write_b128 v10, v[48:51]
    s_mov_b64 exec, -1
    v_mov_b32 v60, 163780
    v_mov_b32 v61, 1
    s_mov_b64 exec, 1
    ds_add_u32 v60, v61
    s_mov_b64 exec, -1
    s_mov_b32 s12, 0x05040100
    s_mov_b32 s13, 0x07060302
    s_waitcnt vmcnt(16)
    v_perm_b32 v144, v137, v136, s12
    s_waitcnt vmcnt(14)
    v_perm_b32 v145, v139, v138, s12
    s_waitcnt vmcnt(12)
    v_perm_b32 v146, v141, v140, s12
    s_waitcnt vmcnt(10)
    v_perm_b32 v147, v143, v142, s12
    buffer_store_dwordx4 v[144:147], v191, s[52:55], 0 offen offset:0 sc1
    v_perm_b32 v148, v137, v136, s13
    v_perm_b32 v149, v139, v138, s13
    v_perm_b32 v150, v141, v140, s13
    v_perm_b32 v151, v143, v142, s13
    buffer_store_dwordx4 v[148:151], v191, s[52:55], 0 offen offset:1024 sc1
    buffer_load_dwordx4 v[168:171], v184, s[52:55], 0 offen sc1
    buffer_load_dwordx4 v[172:175], v184, s[52:55], 0 offen offset:3584 sc1
    buffer_load_dwordx4 v[176:179], v185, s[52:55], 0 offen sc1
    buffer_load_dwordx4 v[164:167], v187, s[52:55], 0 offen sc1
    v_mov_b32 v60, 163780
    s_mov_b32 s9, 400000
    s_waitcnt lgkmcnt(0)
L_cw_23:
    ds_read_b32 v61, v60
    s_waitcnt lgkmcnt(0)
    v_cmp_gt_u32 vcc, 4, v61
    s_cbranch_vccz L_cok_24
    s_sub_u32 s9, s9, 1
    s_cmp_lg_u32 s9, 0
    s_cbranch_scc1 L_cw_23
L_cok_24:
    ds_read_b128 v[80:83], v11 offset:0
    ds_read_b128 v[84:87], v11 offset:16
    ds_read_b128 v[88:91], v11 offset:32
    ds_read_b128 v[92:95], v11 offset:48
    s_add_u32 s68, s73, s74
    s_sub_u32 s69, s68, 28
    s_min_u32 s68, s68, s69
    s_mul_i32 s68, s68, 57344
    s_lshl_b32 s69, s73, 10
    s_add_u32 m0, s69, s75
    s_add_u32 s73, s73, 1
    buffer_load_dwordx4 v249, s[56:59], s68 offen lds
    s_cmp_eq_u32 s73, 12
    s_cselect_b32 s73, 0, s73
    s_cmp_gt_u32 s3, 0
    s_cselect_b32 s13, 1.0, 0
    s_cmp_gt_u32 s3, 1
    s_cselect_b32 s14, 1.0, 0
    s_cmp_gt_u32 s3, 2
    s_cselect_b32 s15, 1.0, 0
    v_sub_f32 v48, v48, v67
    s_add_u32 s68, s73, s74
    s_sub_u32 s69, s68, 28
    s_min_u32 s68, s68, s69
    s_mul_i32 s68, s68, 57344
    s_lshl_b32 s69, s73, 10
    s_add_u32 m0, s69, s75
    s_add_u32 s73, s73, 1
    buffer_load_dwordx4 v249, s[56:59], s68 offen lds
    s_cmp_eq_u32 s73, 12
    s_cselect_b32 s73, 0, s73
    v_sub_f32 v49, v49, v71
    v_sub_f32 v50, v50, v75
    v_sub_f32 v51, v51, v79
    s_waitcnt lgkmcnt(3)
    v_fmac_f32 v48, s13, v80
    v_fmac_f32 v49, s13, v81
    v_fmac_f32 v50, s13, v82
    v_fmac_f32 v51, s13, v83
    s_waitcnt lgkmcnt(2)
    v_fmac_f32 v48, s14, v84
    v_fmac_f32 v49, s14, v85
    v_fmac_f32 v50, s14, v86
    v_fmac_f32 v51, s14, v87
    s_waitcnt lgkmcnt(1)
    v_fmac_f32 v48, s15, v88
    v_fmac_f32 v49, s15, v89
    v_fmac_f32 v50, s15, v90
    v_fmac_f32 v51, s15, v91
    v_add_f32 v50, v50, v80
    v_add_f32 v51, v51, v81
    v_add_f32 v50, v50, v84
    v_add_f32 v51, v51, v85
    v_add_f32 v50, v50, v88
    v_add_f32 v51, v51, v89
    s_waitcnt lgkmcnt(0)
    v_add_f32 v50, v50, v92
    v_add_f32 v51, v51, v93
    v_add_f32 v64, v48, v64
    v_add_f32 v65, v48, v65
    v_add_f32 v66, v48, v66
    v_add_f32 v67, v48, v67
    v_add_f32 v68, v49, v68
    v_add_f32 v69, v49, v69
    v_add_f32 v70, v49, v70
    v_add_f32 v71, v49, v71
    v_add_f32 v72, v50, v72
    v_add_f32 v73, v50, v73
    v_add_f32 v74, v50, v74
    v_add_f32 v75, v50, v75
    v_add_f32 v76, v51, v76
    v_add_f32 v77, v51, v77
    v_add_f32 v78, v51, v78
    v_add_f32 v79, v51, v79
    v_bfe_u32 v2, v1, 3, 2
    v_xor_b32 v2, v2, v186
    v_lshlrev_b32 v2, 4, v2
    v_add_u32 v2, 20480, v2
    v_add_u32 v4, 57344, v2
    s_mul_i32 s12, s3, 229376
    s_lshl_b32 s13, s7, 10
    s_add_u32 s12, s12, s13
    s_add_u32 s70, s12, 5242880
    s_add_u32 s71, s70, 917504
    v_lshlrev_b32 v3, 4, v1
    v_add_u32 v5, 13631488, v3
    s_lshl_b32 s12, s3, 8
    s_add_u32 s12, s12, s7
    s_lshl_b32 s12, s12, 7
    s_add_u32 s72, s12, 4325376
    s_waitcnt vmcnt(2)
    v_bitop3_b32 v61, v165, v167, s8 bitop3:0x7e
    v_bitop3_b32 v62, v169, v171, s8 bitop3:0x7e
    v_bitop3_b32 v63, v173, v175, s8 bitop3:0x7e
    v_bitop3_b32 v59, v177, v179, s8 bitop3:0x7e
    v_or3_b32 v61, v61, v62, v63
    v_or_b32 v60, v59, v61
    v_cmp_ne_u32 vcc, 0, v60
    s_cbranch_vccz L_ok_25
    s_mov_b32 s9, 20000
L_spin_26:
    buffer_load_dwordx4 v[168:171], v184, s[52:55], 0 offen sc1
    buffer_load_dwordx4 v[172:175], v184, s[52:55], 0 offen offset:3584 sc1
    buffer_load_dwordx4 v[176:179], v185, s[52:55], 0 offen sc1
    buffer_load_dwordx4 v[164:167], v187, s[52:55], 0 offen sc1
    s_waitcnt vmcnt(0)
    v_bitop3_b32 v61, v165, v167, s8 bitop3:0x7e
    v_bitop3_b32 v62, v169, v171, s8 bitop3:0x7e
    v_bitop3_b32 v63, v173, v175, s8 bitop3:0x7e
    v_bitop3_b32 v59, v177, v179, s8 bitop3:0x7e
    v_or3_b32 v61, v61, v62, v63
    v_or_b32 v60, v59, v61
    v_cmp_ne_u32 vcc, 0, v60
    s_cbranch_vccz L_out_27
    s_sleep 2
    s_sub_u32 s9, s9, 1
    s_cmp_lg_u32 s9, 0
    s_cbranch_scc1 L_spin_26
L_out_27:
L_ok_25:
    v_mul_f32 v168, v176, v168
    v_mul_f32 v172, v176, v172
    v_mul_f32 v170, v178, v170
    v_mul_f32 v174, v178, v174
    v_fmac_f32 v120, v168, v64
    v_fmac_f32 v122, v168, v65
    v_fmac_f32 v124, v168, v66
    v_fmac_f32 v126, v168, v67
    v_fmac_f32 v121, v170, v68
    v_fmac_f32 v123, v170, v69
    v_fmac_f32 v125, v170, v70
    v_fmac_f32 v127, v170, v71
    v_fmac_f32 v128, v168, v72
    v_fmac_f32 v130, v168, v73
    v_fmac_f32 v132, v168, v74
    v_fmac_f32 v134, v168, v75
    v_fmac_f32 v129, v170, v76
    v_fmac_f32 v131, v170, v77
    v_fmac_f32 v133, v170, v78
    v_fmac_f32 v135, v170, v79
    s_waitcnt lgkmcnt(0)
    s_barrier
    s_setprio 1
    ds_read_b128 v[64:67], v2 offset:0
    ds_read_b128 v[68:71], v2 offset:28672
    ds_read_b128 v[72:75], v4 offset:0
    ds_read_b128 v[76:79], v4 offset:28672
    ds_read_b128 v[80:83], v2 offset:4096
    ds_read_b128 v[84:87], v2 offset:32768
    ds_read_b128 v[88:91], v4 offset:4096
    ds_read_b128 v[92:95], v4 offset:32768
    s_waitcnt lgkmcnt(6)
    v_add_f32 v64, v64, v68
    v_fmac_f32 v120, v172, v64
    v_mul_f32 v64, v164, v120
    v_add_f32 v65, v65, v69
    v_fmac_f32 v122, v172, v65
    v_mul_f32 v65, v164, v122
    v_add_f32 v66, v66, v70
    v_fmac_f32 v124, v172, v66
    v_mul_f32 v66, v164, v124
    v_add_f32 v67, v67, v71
    v_fmac_f32 v126, v172, v67
    v_mul_f32 v67, v164, v126
    s_waitcnt lgkmcnt(4)
    v_add_f32 v72, v72, v76
    v_fmac_f32 v121, v174, v72
    v_mul_f32 v72, v166, v121
    v_add_f32 v73, v73, v77
    v_fmac_f32 v123, v174, v73
    v_mul_f32 v73, v166, v123
    v_add_f32 v74, v74, v78
    v_fmac_f32 v125, v174, v74
    v_mul_f32 v74, v166, v125
    v_add_f32 v75, v75, v79
    v_fmac_f32 v127, v174, v75
    v_mul_f32 v75, v166, v127
    v_cvt_pk_bf16_f32 v104, v64, v72
    v_cvt_pk_bf16_f32 v105, v65, v73
    v_cvt_pk_bf16_f32 v106, v66, v74
    v_cvt_pk_bf16_f32 v107, v67, v75
    buffer_store_dwordx4 v[104:107], v5, s[52:55], s70 offen sc1
    s_waitcnt lgkmcnt(2)
    v_add_f32 v80, v80, v84
    v_fmac_f32 v128, v172, v80
    v_mul_f32 v80, v164, v128
    v_add_f32 v81, v81, v85
    v_fmac_f32 v130, v172, v81
    v_mul_f32 v81, v164, v130
    v_add_f32 v82, v82, v86
    v_fmac_f32 v132, v172, v82
    v_mul_f32 v82, v164, v132
    v_add_f32 v83, v83, v87
    v_fmac_f32 v134, v172, v83
    v_mul_f32 v83, v164, v134
    s_waitcnt lgkmcnt(0)
    v_add_f32 v88, v88, v92
    v_fmac_f32 v129, v174, v88
    v_mul_f32 v88, v166, v129
    v_add_f32 v89, v89, v93
    v_fmac_f32 v131, v174, v89
    v_mul_f32 v89, v166, v131
    v_add_f32 v90, v90, v94
    v_fmac_f32 v133, v174, v90
    v_mul_f32 v90, v166, v133
    v_add_f32 v91, v91, v95
    v_fmac_f32 v135, v174, v91
    v_mul_f32 v91, v166, v135
    v_cvt_pk_bf16_f32 v108, v80, v88
    v_cvt_pk_bf16_f32 v109, v81, v89
    v_cvt_pk_bf16_f32 v110, v82, v90
    v_cvt_pk_bf16_f32 v111, v83, v91
    buffer_store_dwordx4 v[108:111], v5, s[52:55], s71 offen sc1
    v_cvt_pk_bf16_f32 v96, v120, v121
    v_cvt_pk_bf16_f32 v97, v122, v123
    v_cvt_pk_bf16_f32 v98, v124, v125
    v_cvt_pk_bf16_f32 v99, v126, v127
    buffer_store_dwordx4 v[96:99], v3, s[52:55], s70 offen sc1
    v_cvt_pk_bf16_f32 v100, v128, v129
    v_cvt_pk_bf16_f32 v101, v130, v131
    v_cvt_pk_bf16_f32 v102, v132, v133
    v_cvt_pk_bf16_f32 v103, v134, v135
    buffer_store_dwordx4 v[100:103], v3, s[52:55], s71 offen sc1
    s_setprio 0
    v_mov_b32 v60, 163784
    v_mov_b32 v61, 1
    s_mov_b64 exec, 1
    ds_add_u32 v60, v61
    s_mov_b64 exec, -1
    s_mov_b32 s39, s72
    s_branch L_pg3
.p2align 12
L_stub3:
    s_setpc_b64 s[100:101]
    s_nop 0
L_pg3:
L_join:
    s_nop 1
    v_and_b32 v2, 31, v1
    v_lshrrev_b32 v3, 5, v1
    v_lshlrev_b32 v4, 2, v2
    v_lshl_add_u32 v4, v3, 12, v4
    s_mul_i32 s12, s66, 229376
    s_lshl_b32 s13, s4, 7
    s_add_u32 s12, s12, s13
    s_and_b32 s38, s6, 28
    s_lshl_b32 s13, s38, 13
    s_add_u32 s12, s12, s13
    s_add_u32 s12, s12, 18874368
    v_add_u32 v4, s12, v4
    v_bfe_u32 v6, v1, 4, 1
    v_bfe_u32 v8, v1, 2, 2
    v_lshl_add_u32 v10, v3, 3, v8
    v_lshlrev_b32 v10, 6, v10
    v_mul_u32_u24 v9, 28704, v6
    v_and_b32 v8, 3, v1
    v_lshl_add_u32 v10, v8, 3, v10
    v_add_u32 v10, v10, v9
    v_lshlrev_b32 v8, 3, v2
    v_add_u32 v8, 157824, v8
    s_lshl_b32 s12, s66, 3
    s_add_u32 s12, s12, s4
    s_lshl_b32 s13, s12, 8
    s_add_u32 s13, s13, 4227072
    v_lshl_add_u32 v9, v2, 3, s13
    s_mul_i32 s13, s12, 28
    s_add_u32 s13, s13, s67
    s_lshl_b32 s72, s13, 12
    s_add_u32 s72, s72, 7340032
    s_lshl_b32 s12, s66, 2
    s_add_u32 s12, s12, s3
    s_lshl_b32 s12, s12, 2
    s_lshr_b32 s13, s5, 1
    s_add_u32 s12, s12, s13
    s_lshl_b32 s73, s12, 7
    s_and_b32 s13, s6, 28
    s_add_u32 s73, s73, s13
    s_lshr_b32 s13, s4, 2
    s_mul_i32 s13, s13, 32768
    s_add_u32 s73, s73, s13
    s_add_u32 s73, s73, 4521984
    s_and_b32 s64, s6, 3
    s_lshr_b32 s65, s6, 2
    s_lshl_b32 s12, s64, 1
    s_add_u32 s12, s12, s65
    s_sub_u32 s13, s12, 7
    s_cmp_ge_u32 s12, 7
    s_cselect_b32 s69, s13, s12
    s_mul_i32 s70, s3, 7
    s_add_u32 s12, s70, s69
    s_lshl_b32 s12, s12, 2
    s_lshr_b32 s13, s4, 2
    s_lshl_b32 s13, s13, 1
    s_xor_b32 s13, s13, 2
    s_add_u32 s74, s12, s13
    s_lshr_b32 s12, s74, 1
    s_mul_i32 s12, s12, 7
    s_add_u32 s12, s12, s65
    s_lshl_b32 s12, s12, 12
    s_add_u32 s34, s12, 16777216
    s_mul_i32 s35, s3, 10240
    s_add_u32 s35, s35, 114688
    s_mul_i32 s36, s3, 14336
    v_lshlrev_b32 v15, 4, v1
    v_xor_b32 v11, 32, v10
    v_add_u32 v12, 57344, v10
    v_xor_b32 v13, 32, v12
    s_lshl_b32 s12, s5, 2
    s_add_u32 s12, s12, s64
    s_lshl_b32 s12, s12, 2
    s_add_u32 s12, s12, s3
    s_lshl_b32 s12, s12, 7
    s_add_u32 s12, s12, 4521984
    s_lshr_b32 s13, s4, 2
    s_xor_b32 s13, s13, 1
    s_mul_i32 s13, s13, 16384
    s_add_u32 s32, s12, s13
    s_add_u32 s33, s32, 32768
    s_lshl_b32 s12, s5, 3
    s_add_u32 s12, s12, s64
    s_mul_i32 s12, s12, 112
    s_add_u32 s12, s12, s74
    s_lshl_b32 s12, s12, 10
    s_add_u32 s75, s12, 7340032
    s_mov_b32 s12, 57344
    s_cmp_eq_u32 s69, 6
    s_cselect_b32 s41, 4294623232, s12
    s_cmp_eq_u32 s69, 5
    s_cselect_b32 s42, 4294623232, s12
    s_cmp_eq_u32 s69, 4
    s_cselect_b32 s43, 4294623232, s12
    s_cmp_eq_u32 s69, 3
    s_cselect_b32 s44, 4294623232, s12
    s_cmp_eq_u32 s69, 2
    s_cselect_b32 s45, 4294623232, s12
    s_cmp_eq_u32 s69, 1
    s_cselect_b32 s37, 4294623232, s12
    s_cmp_lt_u32 s4, 4
    s_cbranch_scc1 L_arr_28
    s_waitcnt vmcnt(2)
    s_atomic_swap s8, s[50:51], s39
    s_add_u32 s40, s39, 393216
    s_waitcnt vmcnt(0)
    s_atomic_swap s8, s[50:51], s40
    s_waitcnt lgkmcnt(0)
    s_branch L_arr2_29
L_arr_28:
    s_waitcnt vmcnt(0)
L_arr2_29:
    s_cmp_ge_u32 s4, 4
    s_cbranch_scc0 L_nopoll_30
    s_and_b32 s12, s66, 3
    s_lshl_b32 s12, s12, 15
    s_add_u32 s12, s12, 4325376
    v_and_b32 v62, 255, v0
    v_min_u32 v62, 223, v62
    v_lshl_add_u32 v62, v62, 7, s12
    s_mov_b64 vcc, -1
    s_mov_b32 s9, 20000
L_spin_32:
    s_mov_b64 exec, vcc
    buffer_load_dword v63, v62, s[52:55], 0 offen sc1
    s_waitcnt vmcnt(0)
    v_xor_b32 v60, s8, v63
    v_cmp_ne_u32 vcc, 0, v60
    s_cbranch_vccz L_out_33
    s_sub_u32 s9, s9, 1
    s_cmp_lg_u32 s9, 0
    s_cbranch_scc1 L_spin_32
L_out_33:
    s_mov_b64 exec, -1
L_ok_31:
L_nopoll_30:
    s_barrier
    s_cmp_ge_u32 s4, 4
    s_cbranch_scc1 L_ffnB
    s_setprio 2
    buffer_load_dword v80, v4, s[52:55], 0 offen offset:0 sc1
    buffer_load_dword v81, v4, s[52:55], 0 offen offset:1024 sc1
    buffer_load_dword v82, v4, s[52:55], 0 offen offset:2048 sc1
    buffer_load_dword v83, v4, s[52:55], 0 offen offset:3072 sc1
    v_add_u32 v4, 8192, v4
    buffer_load_dword v84, v4, s[52:55], 0 offen offset:0 sc1
    buffer_load_dword v85, v4, s[52:55], 0 offen offset:1024 sc1
    buffer_load_dword v86, v4, s[52:55], 0 offen offset:2048 sc1
    buffer_load_dword v87, v4, s[52:55], 0 offen offset:3072 sc1
    v_add_u32 v4, 8192, v4
    buffer_load_dword v88, v4, s[52:55], 0 offen offset:0 sc1
    buffer_load_dword v89, v4, s[52:55], 0 offen offset:1024 sc1
    buffer_load_dword v90, v4, s[52:55], 0 offen offset:2048 sc1
    buffer_load_dword v91, v4, s[52:55], 0 offen offset:3072 sc1
    v_add_u32 v4, 8192, v4
    buffer_load_dword v92, v4, s[52:55], 0 offen offset:0 sc1
    buffer_load_dword v93, v4, s[52:55], 0 offen offset:1024 sc1
    buffer_load_dword v94, v4, s[52:55], 0 offen offset:2048 sc1
    buffer_load_dword v95, v4, s[52:55], 0 offen offset:3072 sc1
    s_mov_b32 s14, 8192
    s_cmp_eq_u32 s38, 24
    s_cselect_b32 s14, 4294746112, s14
    v_add_u32 v4, s14, v4
    buffer_load_dword v96, v4, s[52:55], 0 offen offset:0 sc1
    buffer_load_dword v97, v4, s[52:55], 0 offen offset:1024 sc1
    buffer_load_dword v98, v4, s[52:55], 0 offen offset:2048 sc1
    buffer_load_dword v99, v4, s[52:55], 0 offen offset:3072 sc1
    v_add_u32 v4, 8192, v4
    buffer_load_dword v100, v4, s[52:55], 0 offen offset:0 sc1
    buffer_load_dword v101, v4, s[52:55], 0 offen offset:1024 sc1
    buffer_load_dword v102, v4, s[52:55], 0 offen offset:2048 sc1
    buffer_load_dword v103, v4, s[52:55], 0 offen offset:3072 sc1
    v_add_u32 v4, 8192, v4
    ds_read_b64_tr_b16 v[192:193], v10 offset:0
    ds_read_b64_tr_b16 v[194:195], v10 offset:256
    ds_read_b64_tr_b16 v[196:197], v11 offset:0
    ds_read_b64_tr_b16 v[198:199], v11 offset:256
    ds_read_b64_tr_b16 v[200:201], v12 offset:0
    ds_read_b64_tr_b16 v[202:203], v12 offset:256
    ds_read_b64_tr_b16 v[204:205], v13 offset:0
    ds_read_b64_tr_b16 v[206:207], v13 offset:256
    ds_read_b64_tr_b16 v[208:209], v10 offset:1024
    ds_read_b64_tr_b16 v[210:211], v10 offset:1280
    ds_read_b64_tr_b16 v[212:213], v11 offset:1024
    ds_read_b64_tr_b16 v[214:215], v11 offset:1280
    s_waitcnt vmcnt(20) lgkmcnt(10)
    v_mfma_f32_32x32x16_bf16 v[16:31], v[192:195], v[80:83], 0
    ds_read_b64_tr_b16 v[216:217], v12 offset:1024
    ds_read_b64_tr_b16 v[218:219], v12 offset:1280
    buffer_load_dword v104, v4, s[52:55], 0 offen offset:0 sc1
    buffer_load_dword v105, v4, s[52:55], 0 offen offset:1024 sc1
    s_waitcnt lgkmcnt(10)
    v_mfma_f32_32x32x16_bf16 v[32:47], v[196:199], v[80:83], 0
    ds_read_b64_tr_b16 v[220:221], v13 offset:1024
    ds_read_b64_tr_b16 v[222:223], v13 offset:1280
    buffer_load_dword v106, v4, s[52:55], 0 offen offset:2048 sc1
    buffer_load_dword v107, v4, s[52:55], 0 offen offset:3072 sc1
    v_add_u32 v4, 8192, v4
    s_waitcnt lgkmcnt(10)
    v_mfma_f32_32x32x16_bf16 v[48:63], v[200:203], v[80:83], 0
    ds_read_b64_tr_b16 v[224:225], v10 offset:2048
    ds_read_b64_tr_b16 v[226:227], v10 offset:2304
    buffer_load_dword v108, v4, s[52:55], 0 offen offset:0 sc1
    buffer_load_dword v109, v4, s[52:55], 0 offen offset:1024 sc1
    s_waitcnt lgkmcnt(10)
    v_mfma_f32_32x32x16_bf16 v[64:79], v[204:207], v[80:83], 0
    ds_read_b64_tr_b16 v[228:229], v11 offset:2048
    ds_read_b64_tr_b16 v[230:231], v11 offset:2304
    buffer_load_dword v110, v4, s[52:55], 0 offen offset:2048 sc1
    buffer_load_dword v111, v4, s[52:55], 0 offen offset:3072 sc1
    s_mov_b32 s14, 8192
    s_cmp_eq_u32 s38, 20
    s_cselect_b32 s14, 4294746112, s14
    v_add_u32 v4, s14, v4
    s_waitcnt vmcnt(24) lgkmcnt(10)
    v_mfma_f32_32x32x16_bf16 v[16:31], v[208:211], v[84:87], v[16:31]
    ds_read_b64_tr_b16 v[232:233], v12 offset:2048
    ds_read_b64_tr_b16 v[234:235], v12 offset:2304
    buffer_load_dword v112, v4, s[52:55], 0 offen offset:0 sc1
    buffer_load_dword v113, v4, s[52:55], 0 offen offset:1024 sc1
    s_waitcnt lgkmcnt(10)
    v_mfma_f32_32x32x16_bf16 v[32:47], v[212:215], v[84:87], v[32:47]
    ds_read_b64_tr_b16 v[236:237], v13 offset:2048
    ds_read_b64_tr_b16 v[238:239], v13 offset:2304
    buffer_load_dword v114, v4, s[52:55], 0 offen offset:2048 sc1
    buffer_load_dword v115, v4, s[52:55], 0 offen offset:3072 sc1
    v_add_u32 v4, 8192, v4
    s_waitcnt lgkmcnt(10)
    v_mfma_f32_32x32x16_bf16 v[48:63], v[216:219], v[84:87], v[48:63]
    ds_read_b64_tr_b16 v[192:193], v10 offset:3072
    ds_read_b64_tr_b16 v[194:195], v10 offset:3328
    buffer_load_dword v116, v4, s[52:55], 0 offen offset:0 sc1
    buffer_load_dword v117, v4, s[52:55], 0 offen offset:1024 sc1
    s_waitcnt lgkmcnt(10)
    v_mfma_f32_32x32x16_bf16 v[64:79], v[220:223], v[84:87], v[64:79]
    ds_read_b64_tr_b16 v[196:197], v11 offset:3072
    ds_read_b64_tr_b16 v[198:199], v11 offset:3328
    buffer_load_dword v118, v4, s[52:55], 0 offen offset:2048 sc1
    buffer_load_dword v119, v4, s[52:55], 0 offen offset:3072 sc1
    v_add_u32 v4, 8192, v4
    s_waitcnt vmcnt(28) lgkmcnt(10)
    v_mfma_f32_32x32x16_bf16 v[16:31], v[224:227], v[88:91], v[16:31]
    ds_read_b64_tr_b16 v[200:201], v12 offset:3072
    ds_read_b64_tr_b16 v[202:203], v12 offset:3328
    buffer_load_dword v120, v4, s[52:55], 0 offen offset:0 sc1
    buffer_load_dword v121, v4, s[52:55], 0 offen offset:1024 sc1
    s_waitcnt lgkmcnt(10)
    v_mfma_f32_32x32x16_bf16 v[32:47], v[228:231], v[88:91], v[32:47]
    ds_read_b64_tr_b16 v[204:205], v13 offset:3072
    ds_read_b64_tr_b16 v[206:207], v13 offset:3328
    buffer_load_dword v122, v4, s[52:55], 0 offen offset:2048 sc1
    buffer_load_dword v123, v4, s[52:55], 0 offen offset:3072 sc1
    v_add_u32 v4, 8192, v4
    s_waitcnt lgkmcnt(10)
    v_mfma_f32_32x32x16_bf16 v[48:63], v[232:235], v[88:91], v[48:63]
    ds_read_b64_tr_b16 v[208:209], v10 offset:4096
    ds_read_b64_tr_b16 v[210:211], v10 offset:4352
    buffer_load_dword v124, v4, s[52:55], 0 offen offset:0 sc1
    buffer_load_dword v125, v4, s[52:55], 0 offen offset:1024 sc1
    s_waitcnt lgkmcnt(10)
    v_mfma_f32_32x32x16_bf16 v[64:79], v[236:239], v[88:91], v[64:79]
    ds_read_b64_tr_b16 v[212:213], v11 offset:4096
    ds_read_b64_tr_b16 v[214:215], v11 offset:4352
    buffer_load_dword v126, v4, s[52:55], 0 offen offset:2048 sc1
    buffer_load_dword v127, v4, s[52:55], 0 offen offset:3072 sc1
    s_mov_b32 s14, 8192
    s_cmp_eq_u32 s38, 16
    s_cselect_b32 s14, 4294746112, s14
    v_add_u32 v4, s14, v4
    s_waitcnt vmcnt(32) lgkmcnt(10)
    v_mfma_f32_32x32x16_bf16 v[16:31], v[192:195], v[92:95], v[16:31]
    ds_read_b64_tr_b16 v[216:217], v12 offset:4096
    ds_read_b64_tr_b16 v[218:219], v12 offset:4352
    buffer_load_dword v128, v4, s[52:55], 0 offen offset:0 sc1
    buffer_load_dword v129, v4, s[52:55], 0 offen offset:1024 sc1
    s_waitcnt lgkmcnt(10)
    v_mfma_f32_32x32x16_bf16 v[32:47], v[196:199], v[92:95], v[32:47]
    ds_read_b64_tr_b16 v[220:221], v13 offset:4096
    ds_read_b64_tr_b16 v[222:223], v13 offset:4352
    buffer_load_dword v130, v4, s[52:55], 0 offen offset:2048 sc1
    buffer_load_dword v131, v4, s[52:55], 0 offen offset:3072 sc1
    v_add_u32 v4, 8192, v4
    s_waitcnt lgkmcnt(10)
    v_mfma_f32_32x32x16_bf16 v[48:63], v[200:203], v[92:95], v[48:63]
    ds_read_b64_tr_b16 v[224:225], v10 offset:5120
    ds_read_b64_tr_b16 v[226:227], v10 offset:5376
    buffer_load_dword v132, v4, s[52:55], 0 offen offset:0 sc1
    buffer_load_dword v133, v4, s[52:55], 0 offen offset:1024 sc1
    s_waitcnt lgkmcnt(10)
    v_mfma_f32_32x32x16_bf16 v[64:79], v[204:207], v[92:95], v[64:79]
    ds_read_b64_tr_b16 v[228:229], v11 offset:5120
    ds_read_b64_tr_b16 v[230:231], v11 offset:5376
    buffer_load_dword v134, v4, s[52:55], 0 offen offset:2048 sc1
    buffer_load_dword v135, v4, s[52:55], 0 offen offset:3072 sc1
    v_add_u32 v4, 8192, v4
    s_waitcnt vmcnt(36) lgkmcnt(10)
    v_mfma_f32_32x32x16_bf16 v[16:31], v[208:211], v[96:99], v[16:31]
    ds_read_b64_tr_b16 v[232:233], v12 offset:5120
    ds_read_b64_tr_b16 v[234:235], v12 offset:5376
    buffer_load_dword v136, v4, s[52:55], 0 offen offset:0 sc1
    buffer_load_dword v137, v4, s[52:55], 0 offen offset:1024 sc1
    s_waitcnt lgkmcnt(10)
    v_mfma_f32_32x32x16_bf16 v[32:47], v[212:215], v[96:99], v[32:47]
    ds_read_b64_tr_b16 v[236:237], v13 offset:5120
    ds_read_b64_tr_b16 v[238:239], v13 offset:5376
    buffer_load_dword v138, v4, s[52:55], 0 offen offset:2048 sc1
    buffer_load_dword v139, v4, s[52:55], 0 offen offset:3072 sc1
    v_add_u32 v4, 8192, v4
    s_waitcnt lgkmcnt(10)
    v_mfma_f32_32x32x16_bf16 v[48:63], v[216:219], v[96:99], v[48:63]
    ds_read_b64_tr_b16 v[192:193], v10 offset:6144
    ds_read_b64_tr_b16 v[194:195], v10 offset:6400
    buffer_load_dword v140, v4, s[52:55], 0 offen offset:0 sc1
    buffer_load_dword v141, v4, s[52:55], 0 offen offset:1024 sc1
    s_waitcnt lgkmcnt(10)
    v_mfma_f32_32x32x16_bf16 v[64:79], v[220:223], v[96:99], v[64:79]
    ds_read_b64_tr_b16 v[196:197], v11 offset:6144
    ds_read_b64_tr_b16 v[198:199], v11 offset:6400
    buffer_load_dword v142, v4, s[52:55], 0 offen offset:2048 sc1
    buffer_load_dword v143, v4, s[52:55], 0 offen offset:3072 sc1
    s_mov_b32 s14, 8192
    s_cmp_eq_u32 s38, 12
    s_cselect_b32 s14, 4294746112, s14
    v_add_u32 v4, s14, v4
    s_waitcnt vmcnt(40) lgkmcnt(10)
    v_mfma_f32_32x32x16_bf16 v[16:31], v[224:227], v[100:103], v[16:31]
    ds_read_b64_tr_b16 v[200:201], v12 offset:6144
    ds_read_b64_tr_b16 v[202:203], v12 offset:6400
    buffer_load_dword v144, v4, s[52:55], 0 offen offset:0 sc1
    buffer_load_dword v145, v4, s[52:55], 0 offen offset:1024 sc1
    s_waitcnt lgkmcnt(10)
    v_mfma_f32_32x32x16_bf16 v[32:47], v[228:231], v[100:103], v[32:47]
    ds_read_b64_tr_b16 v[204:205], v13 offset:6144
    ds_read_b64_tr_b16 v[206:207], v13 offset:6400
    buffer_load_dword v146, v4, s[52:55], 0 offen offset:2048 sc1
    buffer_load_dword v147, v4, s[52:55], 0 offen offset:3072 sc1
    v_add_u32 v4, 8192, v4
    s_waitcnt lgkmcnt(10)
    v_mfma_f32_32x32x16_bf16 v[48:63], v[232:235], v[100:103], v[48:63]
    ds_read_b64_tr_b16 v[208:209], v10 offset:7168
    ds_read_b64_tr_b16 v[210:211], v10 offset:7424
    buffer_load_dword v148, v4, s[52:55], 0 offen offset:0 sc1
    buffer_load_dword v149, v4, s[52:55], 0 offen offset:1024 sc1
    s_waitcnt lgkmcnt(10)
    v_mfma_f32_32x32x16_bf16 v[64:79], v[236:239], v[100:103], v[64:79]
    ds_read_b64_tr_b16 v[212:213], v11 offset:7168
    ds_read_b64_tr_b16 v[214:215], v11 offset:7424
    buffer_load_dword v150, v4, s[52:55], 0 offen offset:2048 sc1
    buffer_load_dword v151, v4, s[52:55], 0 offen offset:3072 sc1
    v_add_u32 v4, 8192, v4
    s_waitcnt vmcnt(44) lgkmcnt(10)
    v_mfma_f32_32x32x16_bf16 v[16:31], v[192:195], v[104:107], v[16:31]
    ds_read_b64_tr_b16 v[216:217], v12 offset:7168
    ds_read_b64_tr_b16 v[218:219], v12 offset:7424
    buffer_load_dword v152, v4, s[52:55], 0 offen offset:0 sc1
    buffer_load_dword v153, v4, s[52:55], 0 offen offset:1024 sc1
    s_waitcnt lgkmcnt(10)
    v_mfma_f32_32x32x16_bf16 v[32:47], v[196:199], v[104:107], v[32:47]
    ds_read_b64_tr_b16 v[220:221], v13 offset:7168
    ds_read_b64_tr_b16 v[222:223], v13 offset:7424
    buffer_load_dword v154, v4, s[52:55], 0 offen offset:2048 sc1
    buffer_load_dword v155, v4, s[52:55], 0 offen offset:3072 sc1
    v_add_u32 v4, 8192, v4
    s_waitcnt lgkmcnt(10)
    v_mfma_f32_32x32x16_bf16 v[48:63], v[200:203], v[104:107], v[48:63]
    ds_read_b64_tr_b16 v[224:225], v10 offset:8192
    ds_read_b64_tr_b16 v[226:227], v10 offset:8448
    buffer_load_dword v156, v4, s[52:55], 0 offen offset:0 sc1
    buffer_load_dword v157, v4, s[52:55], 0 offen offset:1024 sc1
    s_waitcnt lgkmcnt(10)
    v_mfma_f32_32x32x16_bf16 v[64:79], v[204:207], v[104:107], v[64:79]
    ds_read_b64_tr_b16 v[228:229], v11 offset:8192
    ds_read_b64_tr_b16 v[230:231], v11 offset:8448
    buffer_load_dword v158, v4, s[52:55], 0 offen offset:2048 sc1
    buffer_load_dword v159, v4, s[52:55], 0 offen offset:3072 sc1
    s_mov_b32 s14, 8192
    s_cmp_eq_u32 s38, 8
    s_cselect_b32 s14, 4294746112, s14
    v_add_u32 v4, s14, v4
    s_barrier
    s_waitcnt vmcnt(48) lgkmcnt(10)
    v_mfma_f32_32x32x16_bf16 v[16:31], v[208:211], v[108:111], v[16:31]
    ds_read_b64_tr_b16 v[232:233], v12 offset:8192
    ds_read_b64_tr_b16 v[234:235], v12 offset:8448
    buffer_load_dword v160, v4, s[52:55], 0 offen offset:0 sc1
    buffer_load_dword v161, v4, s[52:55], 0 offen offset:1024 sc1
    s_waitcnt lgkmcnt(10)
    v_mfma_f32_32x32x16_bf16 v[32:47], v[212:215], v[108:111], v[32:47]
    ds_read_b64_tr_b16 v[236:237], v13 offset:8192
    ds_read_b64_tr_b16 v[238:239], v13 offset:8448
    buffer_load_dword v162, v4, s[52:55], 0 offen offset:2048 sc1
    buffer_load_dword v163, v4, s[52:55], 0 offen offset:3072 sc1
    v_add_u32 v4, 8192, v4
    s_waitcnt lgkmcnt(10)
    v_mfma_f32_32x32x16_bf16 v[48:63], v[216:219], v[108:111], v[48:63]
    ds_read_b64_tr_b16 v[192:193], v10 offset:9216
    ds_read_b64_tr_b16 v[194:195], v10 offset:9472
    buffer_load_dword v164, v4, s[52:55], 0 offen offset:0 sc1
    buffer_load_dword v165, v4, s[52:55], 0 offen offset:1024 sc1
    s_waitcnt lgkmcnt(10)
    v_mfma_f32_32x32x16_bf16 v[64:79], v[220:223], v[108:111], v[64:79]
    ds_read_b64_tr_b16 v[196:197], v11 offset:9216
    ds_read_b64_tr_b16 v[198:199], v11 offset:9472
    buffer_load_dword v166, v4, s[52:55], 0 offen offset:2048 sc1
    buffer_load_dword v167, v4, s[52:55], 0 offen offset:3072 sc1
    v_add_u32 v4, 8192, v4
    s_waitcnt vmcnt(52) lgkmcnt(10)
    v_mfma_f32_32x32x16_bf16 v[16:31], v[224:227], v[112:115], v[16:31]
    ds_read_b64_tr_b16 v[200:201], v12 offset:9216
    ds_read_b64_tr_b16 v[202:203], v12 offset:9472
    buffer_load_dword v168, v4, s[52:55], 0 offen offset:0 sc1
    buffer_load_dword v169, v4, s[52:55], 0 offen offset:1024 sc1
    s_waitcnt lgkmcnt(10)
    v_mfma_f32_32x32x16_bf16 v[32:47], v[228:231], v[112:115], v[32:47]
    ds_read_b64_tr_b16 v[204:205], v13 offset:9216
    ds_read_b64_tr_b16 v[206:207], v13 offset:9472
    buffer_load_dword v170, v4, s[52:55], 0 offen offset:2048 sc1
    buffer_load_dword v171, v4, s[52:55], 0 offen offset:3072 sc1
    v_add_u32 v4, 8192, v4
    s_waitcnt lgkmcnt(10)
    v_mfma_f32_32x32x16_bf16 v[48:63], v[232:235], v[112:115], v[48:63]
    ds_read_b64_tr_b16 v[208:209], v10 offset:10240
    ds_read_b64_tr_b16 v[210:211], v10 offset:10496
    buffer_load_dword v172, v4, s[52:55], 0 offen offset:0 sc1
    buffer_load_dword v173, v4, s[52:55], 0 offen offset:1024 sc1
    s_waitcnt lgkmcnt(10)
    v_mfma_f32_32x32x16_bf16 v[64:79], v[236:239], v[112:115], v[64:79]
    ds_read_b64_tr_b16 v[212:213], v11 offset:10240
    ds_read_b64_tr_b16 v[214:215], v11 offset:10496
    buffer_load_dword v174, v4, s[52:55], 0 offen offset:2048 sc1
    buffer_load_dword v175, v4, s[52:55], 0 offen offset:3072 sc1
    s_mov_b32 s14, 8192
    s_cmp_eq_u32 s38, 4
    s_cselect_b32 s14, 4294746112, s14
    v_add_u32 v4, s14, v4
    s_waitcnt vmcnt(56) lgkmcnt(10)
    v_mfma_f32_32x32x16_bf16 v[16:31], v[192:195], v[116:119], v[16:31]
    ds_read_b64_tr_b16 v[216:217], v12 offset:10240
    ds_read_b64_tr_b16 v[218:219], v12 offset:10496
    buffer_load_dword v176, v4, s[52:55], 0 offen offset:0 sc1
    buffer_load_dword v177, v4, s[52:55], 0 offen offset:1024 sc1
    s_waitcnt lgkmcnt(10)
    v_mfma_f32_32x32x16_bf16 v[32:47], v[196:199], v[116:119], v[32:47]
    ds_read_b64_tr_b16 v[220:221], v13 offset:10240
    ds_read_b64_tr_b16 v[222:223], v13 offset:10496
    buffer_load_dword v178, v4, s[52:55], 0 offen offset:2048 sc1
    buffer_load_dword v179, v4, s[52:55], 0 offen offset:3072 sc1
    v_add_u32 v4, 8192, v4
    s_waitcnt lgkmcnt(10)
    v_mfma_f32_32x32x16_bf16 v[48:63], v[200:203], v[116:119], v[48:63]
    ds_read_b64_tr_b16 v[224:225], v10 offset:11264
    ds_read_b64_tr_b16 v[226:227], v10 offset:11520
    buffer_load_dword v180, v4, s[52:55], 0 offen offset:0 sc1
    buffer_load_dword v181, v4, s[52:55], 0 offen offset:1024 sc1
    s_waitcnt lgkmcnt(10)
    v_mfma_f32_32x32x16_bf16 v[64:79], v[204:207], v[116:119], v[64:79]
    ds_read_b64_tr_b16 v[228:229], v11 offset:11264
    ds_read_b64_tr_b16 v[230:231], v11 offset:11520
    buffer_load_dword v182, v4, s[52:55], 0 offen offset:2048 sc1
    buffer_load_dword v183, v4, s[52:55], 0 offen offset:3072 sc1
    v_add_u32 v4, 8192, v4
    s_waitcnt vmcnt(60) lgkmcnt(10)
    v_mfma_f32_32x32x16_bf16 v[16:31], v[208:211], v[120:123], v[16:31]
    ds_read_b64_tr_b16 v[232:233], v12 offset:11264
    ds_read_b64_tr_b16 v[234:235], v12 offset:11520
    buffer_load_dword v184, v4, s[52:55], 0 offen offset:0 sc1
    buffer_load_dword v185, v4, s[52:55], 0 offen offset:1024 sc1
    s_waitcnt lgkmcnt(10)
    v_mfma_f32_32x32x16_bf16 v[32:47], v[212:215], v[120:123], v[32:47]
    ds_read_b64_tr_b16 v[236:237], v13 offset:11264
    ds_read_b64_tr_b16 v[238:239], v13 offset:11520
    buffer_load_dword v186, v4, s[52:55], 0 offen offset:2048 sc1
    buffer_load_dword v187, v4, s[52:55], 0 offen offset:3072 sc1
    v_add_u32 v4, 8192, v4
    s_waitcnt lgkmcnt(10)
    v_mfma_f32_32x32x16_bf16 v[48:63], v[216:219], v[120:123], v[48:63]
    ds_read_b64_tr_b16 v[192:193], v10 offset:12288
    ds_read_b64_tr_b16 v[194:195], v10 offset:12544
    buffer_load_dword v188, v4, s[52:55], 0 offen offset:0 sc1
    buffer_load_dword v189, v4, s[52:55], 0 offen offset:1024 sc1
    s_waitcnt lgkmcnt(10)
    v_mfma_f32_32x32x16_bf16 v[64:79], v[220:223], v[120:123], v[64:79]
    ds_read_b64_tr_b16 v[196:197], v11 offset:12288
    ds_read_b64_tr_b16 v[198:199], v11 offset:12544
    buffer_load_dword v190, v4, s[52:55], 0 offen offset:2048 sc1
    buffer_load_dword v191, v4, s[52:55], 0 offen offset:3072 sc1
    v_add_u32 v4, 8192, v4
    s_waitcnt vmcnt(63) lgkmcnt(10)
    v_mfma_f32_32x32x16_bf16 v[16:31], v[224:227], v[124:127], v[16:31]
    ds_read_b64_tr_b16 v[200:201], v12 offset:12288
    ds_read_b64_tr_b16 v[202:203], v12 offset:12544
    s_waitcnt lgkmcnt(10)
    v_mfma_f32_32x32x16_bf16 v[32:47], v[228:231], v[124:127], v[32:47]
    ds_read_b64_tr_b16 v[204:205], v13 offset:12288
    ds_read_b64_tr_b16 v[206:207], v13 offset:12544
    s_waitcnt lgkmcnt(10)
    v_mfma_f32_32x32x16_bf16 v[48:63], v[232:235], v[124:127], v[48:63]
    ds_read_b64_tr_b16 v[208:209], v10 offset:13312
    ds_read_b64_tr_b16 v[210:211], v10 offset:13568
    s_waitcnt lgkmcnt(10)
    v_mfma_f32_32x32x16_bf16 v[64:79], v[236:239], v[124:127], v[64:79]
    ds_read_b64_tr_b16 v[212:213], v11 offset:13312
    ds_read_b64_tr_b16 v[214:215], v11 offset:13568
    s_waitcnt vmcnt(60) lgkmcnt(10)
    v_mfma_f32_32x32x16_bf16 v[16:31], v[192:195], v[128:131], v[16:31]
    ds_read_b64_tr_b16 v[216:217], v12 offset:13312
    ds_read_b64_tr_b16 v[218:219], v12 offset:13568
    s_waitcnt lgkmcnt(10)
    v_mfma_f32_32x32x16_bf16 v[32:47], v[196:199], v[128:131], v[32:47]
    ds_read_b64_tr_b16 v[220:221], v13 offset:13312
    ds_read_b64_tr_b16 v[222:223], v13 offset:13568
    s_waitcnt lgkmcnt(10)
    v_mfma_f32_32x32x16_bf16 v[48:63], v[200:203], v[128:131], v[48:63]
    ds_read_b64_tr_b16 v[224:225], v10 offset:14336
    ds_read_b64_tr_b16 v[226:227], v10 offset:14592
    s_waitcnt lgkmcnt(10)
    v_mfma_f32_32x32x16_bf16 v[64:79], v[204:207], v[128:131], v[64:79]
    ds_read_b64_tr_b16 v[228:229], v11 offset:14336
    ds_read_b64_tr_b16 v[230:231], v11 offset:14592
    s_waitcnt vmcnt(56) lgkmcnt(10)
    v_mfma_f32_32x32x16_bf16 v[16:31], v[208:211], v[132:135], v[16:31]
    ds_read_b64_tr_b16 v[232:233], v12 offset:14336
    ds_read_b64_tr_b16 v[234:235], v12 offset:14592
    s_waitcnt lgkmcnt(10)
    v_mfma_f32_32x32x16_bf16 v[32:47], v[212:215], v[132:135], v[32:47]
    ds_read_b64_tr_b16 v[236:237], v13 offset:14336
    ds_read_b64_tr_b16 v[238:239], v13 offset:14592
    s_waitcnt lgkmcnt(10)
    v_mfma_f32_32x32x16_bf16 v[48:63], v[216:219], v[132:135], v[48:63]
    ds_read_b64_tr_b16 v[192:193], v10 offset:15360
    ds_read_b64_tr_b16 v[194:195], v10 offset:15616
    s_waitcnt lgkmcnt(10)
    v_mfma_f32_32x32x16_bf16 v[64:79], v[220:223], v[132:135], v[64:79]
    ds_read_b64_tr_b16 v[196:197], v11 offset:15360
    ds_read_b64_tr_b16 v[198:199], v11 offset:15616
    s_waitcnt vmcnt(52) lgkmcnt(10)
    v_mfma_f32_32x32x16_bf16 v[16:31], v[224:227], v[136:139], v[16:31]
    ds_read_b64_tr_b16 v[200:201], v12 offset:15360
    ds_read_b64_tr_b16 v[202:203], v12 offset:15616
    s_waitcnt lgkmcnt(10)
    v_mfma_f32_32x32x16_bf16 v[32:47], v[228:231], v[136:139], v[32:47]
    ds_read_b64_tr_b16 v[204:205], v13 offset:15360
    ds_read_b64_tr_b16 v[206:207], v13 offset:15616
    s_waitcnt lgkmcnt(10)
    v_mfma_f32_32x32x16_bf16 v[48:63], v[232:235], v[136:139], v[48:63]
    ds_read_b64_tr_b16 v[208:209], v10 offset:16384
    ds_read_b64_tr_b16 v[210:211], v10 offset:16640
    s_waitcnt lgkmcnt(10)
    v_mfma_f32_32x32x16_bf16 v[64:79], v[236:239], v[136:139], v[64:79]
    ds_read_b64_tr_b16 v[212:213], v11 offset:16384
    ds_read_b64_tr_b16 v[214:215], v11 offset:16640
    s_waitcnt vmcnt(48) lgkmcnt(10)
    v_mfma_f32_32x32x16_bf16 v[16:31], v[192:195], v[140:143], v[16:31]
    ds_read_b64_tr_b16 v[216:217], v12 offset:16384
    ds_read_b64_tr_b16 v[218:219], v12 offset:16640
    s_waitcnt lgkmcnt(10)
    v_mfma_f32_32x32x16_bf16 v[32:47], v[196:199], v[140:143], v[32:47]
    ds_read_b64_tr_b16 v[220:221], v13 offset:16384
    ds_read_b64_tr_b16 v[222:223], v13 offset:16640
    s_waitcnt lgkmcnt(10)
    v_mfma_f32_32x32x16_bf16 v[48:63], v[200:203], v[140:143], v[48:63]
    ds_read_b64_tr_b16 v[224:225], v10 offset:17408
    ds_read_b64_tr_b16 v[226:227], v10 offset:17664
    s_waitcnt lgkmcnt(10)
    v_mfma_f32_32x32x16_bf16 v[64:79], v[204:207], v[140:143], v[64:79]
    ds_read_b64_tr_b16 v[228:229], v11 offset:17408
    ds_read_b64_tr_b16 v[230:231], v11 offset:17664
    s_waitcnt vmcnt(44) lgkmcnt(10)
    v_mfma_f32_32x32x16_bf16 v[16:31], v[208:211], v[144:147], v[16:31]
    ds_read_b64_tr_b16 v[232:233], v12 offset:17408
    ds_read_b64_tr_b16 v[234:235], v12 offset:17664
    s_waitcnt lgkmcnt(10)
    v_mfma_f32_32x32x16_bf16 v[32:47], v[212:215], v[144:147], v[32:47]
    ds_read_b64_tr_b16 v[236:237], v13 offset:17408
    ds_read_b64_tr_b16 v[238:239], v13 offset:17664
    s_waitcnt lgkmcnt(10)
    v_mfma_f32_32x32x16_bf16 v[48:63], v[216:219], v[144:147], v[48:63]
    ds_read_b64_tr_b16 v[192:193], v10 offset:18432
    ds_read_b64_tr_b16 v[194:195], v10 offset:18688
    s_waitcnt lgkmcnt(10)
    v_mfma_f32_32x32x16_bf16 v[64:79], v[220:223], v[144:147], v[64:79]
    ds_read_b64_tr_b16 v[196:197], v11 offset:18432
    ds_read_b64_tr_b16 v[198:199], v11 offset:18688
    s_waitcnt vmcnt(40) lgkmcnt(10)
    v_mfma_f32_32x32x16_bf16 v[16:31], v[224:227], v[148:151], v[16:31]
    ds_read_b64_tr_b16 v[200:201], v12 offset:18432
    ds_read_b64_tr_b16 v[202:203], v12 offset:18688
    s_waitcnt lgkmcnt(10)
    v_mfma_f32_32x32x16_bf16 v[32:47], v[228:231], v[148:151], v[32:47]
    ds_read_b64_tr_b16 v[204:205], v13 offset:18432
    ds_read_b64_tr_b16 v[206:207], v13 offset:18688
    s_waitcnt lgkmcnt(10)
    v_mfma_f32_32x32x16_bf16 v[48:63], v[232:235], v[148:151], v[48:63]
    ds_read_b64_tr_b16 v[208:209], v10 offset:19456
    ds_read_b64_tr_b16 v[210:211], v10 offset:19712
    s_waitcnt lgkmcnt(10)
    v_mfma_f32_32x32x16_bf16 v[64:79], v[236:239], v[148:151], v[64:79]
    ds_read_b64_tr_b16 v[212:213], v11 offset:19456
    ds_read_b64_tr_b16 v[214:215], v11 offset:19712
    s_waitcnt vmcnt(36) lgkmcnt(10)
    v_mfma_f32_32x32x16_bf16 v[16:31], v[192:195], v[152:155], v[16:31]
    ds_read_b64_tr_b16 v[216:217], v12 offset:19456
    ds_read_b64_tr_b16 v[218:219], v12 offset:19712
    s_waitcnt lgkmcnt(10)
    v_mfma_f32_32x32x16_bf16 v[32:47], v[196:199], v[152:155], v[32:47]
    ds_read_b64_tr_b16 v[220:221], v13 offset:19456
    ds_read_b64_tr_b16 v[222:223], v13 offset:19712
    s_branch L_pg4
.p2align 12
L_stub4:
    s_setpc_b64 s[100:101]
    s_nop 0
L_pg4:
    s_waitcnt lgkmcnt(10)
    v_mfma_f32_32x32x16_bf16 v[48:63], v[200:203], v[152:155], v[48:63]
    ds_read_b64_tr_b16 v[224:225], v10 offset:20480
    ds_read_b64_tr_b16 v[226:227], v10 offset:20736
    s_waitcnt lgkmcnt(10)
    v_mfma_f32_32x32x16_bf16 v[64:79], v[204:207], v[152:155], v[64:79]
    ds_read_b64_tr_b16 v[228:229], v11 offset:20480
    ds_read_b64_tr_b16 v[230:231], v11 offset:20736
    s_waitcnt vmcnt(32) lgkmcnt(10)
    v_mfma_f32_32x32x16_bf16 v[16:31], v[208:211], v[156:159], v[16:31]
    ds_read_b64_tr_b16 v[232:233], v12 offset:20480
    ds_read_b64_tr_b16 v[234:235], v12 offset:20736
    s_waitcnt lgkmcnt(10)
    v_mfma_f32_32x32x16_bf16 v[32:47], v[212:215], v[156:159], v[32:47]
    ds_read_b64_tr_b16 v[236:237], v13 offset:20480
    ds_read_b64_tr_b16 v[238:239], v13 offset:20736
    s_waitcnt lgkmcnt(10)
    v_mfma_f32_32x32x16_bf16 v[48:63], v[216:219], v[156:159], v[48:63]
    ds_read_b64_tr_b16 v[192:193], v10 offset:21504
    ds_read_b64_tr_b16 v[194:195], v10 offset:21760
    s_waitcnt lgkmcnt(10)
    v_mfma_f32_32x32x16_bf16 v[64:79], v[220:223], v[156:159], v[64:79]
    ds_read_b64_tr_b16 v[196:197], v11 offset:21504
    ds_read_b64_tr_b16 v[198:199], v11 offset:21760
    s_waitcnt vmcnt(28) lgkmcnt(10)
    v_mfma_f32_32x32x16_bf16 v[16:31], v[224:227], v[160:163], v[16:31]
    ds_read_b64_tr_b16 v[200:201], v12 offset:21504
    ds_read_b64_tr_b16 v[202:203], v12 offset:21760
    s_waitcnt lgkmcnt(10)
    v_mfma_f32_32x32x16_bf16 v[32:47], v[228:231], v[160:163], v[32:47]
    ds_read_b64_tr_b16 v[204:205], v13 offset:21504
    ds_read_b64_tr_b16 v[206:207], v13 offset:21760
    s_waitcnt lgkmcnt(10)
    v_mfma_f32_32x32x16_bf16 v[48:63], v[232:235], v[160:163], v[48:63]
    ds_read_b64_tr_b16 v[208:209], v10 offset:22528
    ds_read_b64_tr_b16 v[210:211], v10 offset:22784
    s_waitcnt lgkmcnt(10)
    v_mfma_f32_32x32x16_bf16 v[64:79], v[236:239], v[160:163], v[64:79]
    ds_read_b64_tr_b16 v[212:213], v11 offset:22528
    ds_read_b64_tr_b16 v[214:215], v11 offset:22784
    s_waitcnt vmcnt(24) lgkmcnt(10)
    v_mfma_f32_32x32x16_bf16 v[16:31], v[192:195], v[164:167], v[16:31]
    ds_read_b64_tr_b16 v[216:217], v12 offset:22528
    ds_read_b64_tr_b16 v[218:219], v12 offset:22784
    s_waitcnt lgkmcnt(10)
    v_mfma_f32_32x32x16_bf16 v[32:47], v[196:199], v[164:167], v[32:47]
    ds_read_b64_tr_b16 v[220:221], v13 offset:22528
    ds_read_b64_tr_b16 v[222:223], v13 offset:22784
    s_waitcnt lgkmcnt(10)
    v_mfma_f32_32x32x16_bf16 v[48:63], v[200:203], v[164:167], v[48:63]
    ds_read_b64_tr_b16 v[224:225], v10 offset:23552
    ds_read_b64_tr_b16 v[226:227], v10 offset:23808
    s_waitcnt lgkmcnt(10)
    v_mfma_f32_32x32x16_bf16 v[64:79], v[204:207], v[164:167], v[64:79]
    ds_read_b64_tr_b16 v[228:229], v11 offset:23552
    ds_read_b64_tr_b16 v[230:231], v11 offset:23808
    s_waitcnt vmcnt(20) lgkmcnt(10)
    v_mfma_f32_32x32x16_bf16 v[16:31], v[208:211], v[168:171], v[16:31]
    ds_read_b64_tr_b16 v[232:233], v12 offset:23552
    ds_read_b64_tr_b16 v[234:235], v12 offset:23808
    s_waitcnt lgkmcnt(10)
    v_mfma_f32_32x32x16_bf16 v[32:47], v[212:215], v[168:171], v[32:47]
    ds_read_b64_tr_b16 v[236:237], v13 offset:23552
    ds_read_b64_tr_b16 v[238:239], v13 offset:23808
    s_waitcnt lgkmcnt(10)
    v_mfma_f32_32x32x16_bf16 v[48:63], v[216:219], v[168:171], v[48:63]
    ds_read_b64_tr_b16 v[192:193], v10 offset:24576
    ds_read_b64_tr_b16 v[194:195], v10 offset:24832
    s_waitcnt lgkmcnt(10)
    v_mfma_f32_32x32x16_bf16 v[64:79], v[220:223], v[168:171], v[64:79]
    ds_read_b64_tr_b16 v[196:197], v11 offset:24576
    ds_read_b64_tr_b16 v[198:199], v11 offset:24832
    s_waitcnt vmcnt(16) lgkmcnt(10)
    v_mfma_f32_32x32x16_bf16 v[16:31], v[224:227], v[172:175], v[16:31]
    ds_read_b64_tr_b16 v[200:201], v12 offset:24576
    ds_read_b64_tr_b16 v[202:203], v12 offset:24832
    buffer_load_dwordx2 v[6:7], v9, s[52:55], 0 offen sc1
    s_waitcnt lgkmcnt(10)
    v_mfma_f32_32x32x16_bf16 v[32:47], v[228:231], v[172:175], v[32:47]
    ds_read_b64_tr_b16 v[204:205], v13 offset:24576
    ds_read_b64_tr_b16 v[206:207], v13 offset:24832
    s_waitcnt lgkmcnt(10)
    v_mfma_f32_32x32x16_bf16 v[48:63], v[232:235], v[172:175], v[48:63]
    ds_read_b64_tr_b16 v[208:209], v10 offset:25600
    ds_read_b64_tr_b16 v[210:211], v10 offset:25856
    s_waitcnt lgkmcnt(10)
    v_mfma_f32_32x32x16_bf16 v[64:79], v[236:239], v[172:175], v[64:79]
    ds_read_b64_tr_b16 v[212:213], v11 offset:25600
    ds_read_b64_tr_b16 v[214:215], v11 offset:25856
    v_mov_b32 v250, 163784
    ds_read_b32 v251, v250
    s_waitcnt vmcnt(13) lgkmcnt(11)
    v_mfma_f32_32x32x16_bf16 v[16:31], v[192:195], v[176:179], v[16:31]
    ds_read_b64_tr_b16 v[216:217], v12 offset:25600
    ds_read_b64_tr_b16 v[218:219], v12 offset:25856
    s_waitcnt lgkmcnt(11)
    v_mfma_f32_32x32x16_bf16 v[32:47], v[196:199], v[176:179], v[32:47]
    ds_read_b64_tr_b16 v[220:221], v13 offset:25600
    ds_read_b64_tr_b16 v[222:223], v13 offset:25856
    s_waitcnt lgkmcnt(11)
    v_mfma_f32_32x32x16_bf16 v[48:63], v[200:203], v[176:179], v[48:63]
    ds_read_b64_tr_b16 v[224:225], v10 offset:26624
    ds_read_b64_tr_b16 v[226:227], v10 offset:26880
    s_waitcnt lgkmcnt(11)
    v_mfma_f32_32x32x16_bf16 v[64:79], v[204:207], v[176:179], v[64:79]
    ds_read_b64_tr_b16 v[228:229], v11 offset:26624
    ds_read_b64_tr_b16 v[230:231], v11 offset:26880
    s_waitcnt lgkmcnt(8)
    v_cmp_gt_u32 vcc, 8, v251
    s_cbranch_vccz L_pk_34
    v_mov_b32 v250, 163784
    s_mov_b32 s9, 400000
    s_waitcnt lgkmcnt(0)
L_cw_35:
    ds_read_b32 v251, v250
    s_waitcnt lgkmcnt(0)
    v_cmp_gt_u32 vcc, 8, v251
    s_cbranch_vccz L_cok_36
    s_sub_u32 s9, s9, 1
    s_cmp_lg_u32 s9, 0
    s_cbranch_scc1 L_cw_35
L_cok_36:
L_pk_34:
    ds_read_b64 v[240:241], v8 offset:0
    ds_read_b64 v[242:243], v8 offset:256
    ds_read_b64 v[244:245], v8 offset:512
    ds_read_b64 v[246:247], v8 offset:768
    s_waitcnt vmcnt(9)
    v_mfma_f32_32x32x16_bf16 v[16:31], v[208:211], v[180:183], v[16:31]
    ds_read_b64_tr_b16 v[232:233], v12 offset:26624
    ds_read_b64_tr_b16 v[234:235], v12 offset:26880
    v_mfma_f32_32x32x16_bf16 v[32:47], v[212:215], v[180:183], v[32:47]
    ds_read_b64_tr_b16 v[236:237], v13 offset:26624
    ds_read_b64_tr_b16 v[238:239], v13 offset:26880
    s_waitcnt lgkmcnt(14)
    v_mfma_f32_32x32x16_bf16 v[48:63], v[216:219], v[180:183], v[48:63]
    ds_read_b64_tr_b16 v[192:193], v10 offset:27648
    ds_read_b64_tr_b16 v[194:195], v10 offset:27904
    s_waitcnt lgkmcnt(14)
    v_mfma_f32_32x32x16_bf16 v[64:79], v[220:223], v[180:183], v[64:79]
    ds_read_b64_tr_b16 v[196:197], v11 offset:27648
    ds_read_b64_tr_b16 v[198:199], v11 offset:27904
    s_waitcnt vmcnt(5) lgkmcnt(14)
    v_mfma_f32_32x32x16_bf16 v[16:31], v[224:227], v[184:187], v[16:31]
    ds_read_b64_tr_b16 v[200:201], v12 offset:27648
    ds_read_b64_tr_b16 v[202:203], v12 offset:27904
    s_waitcnt lgkmcnt(14)
    v_mfma_f32_32x32x16_bf16 v[32:47], v[228:231], v[184:187], v[32:47]
    ds_read_b64_tr_b16 v[204:205], v13 offset:27648
    ds_read_b64_tr_b16 v[206:207], v13 offset:27904
    s_waitcnt lgkmcnt(10)
    v_mfma_f32_32x32x16_bf16 v[48:63], v[232:235], v[184:187], v[48:63]
    s_waitcnt lgkmcnt(8)
    v_mfma_f32_32x32x16_bf16 v[64:79], v[236:239], v[184:187], v[64:79]
    s_waitcnt vmcnt(1) lgkmcnt(6)
    v_mfma_f32_32x32x16_bf16 v[16:31], v[192:195], v[188:191], v[16:31]
    s_waitcnt lgkmcnt(4)
    v_mfma_f32_32x32x16_bf16 v[32:47], v[196:199], v[188:191], v[32:47]
    s_waitcnt lgkmcnt(2)
    v_mfma_f32_32x32x16_bf16 v[48:63], v[200:203], v[188:191], v[48:63]
    s_waitcnt lgkmcnt(0)
    v_mfma_f32_32x32x16_bf16 v[64:79], v[204:207], v[188:191], v[64:79]
    s_waitcnt vmcnt(0)
    v_xor_b32 v250, s8, v7
    v_cmp_ne_u32 vcc, 0, v250
    s_cbranch_vccz L_ok_37
    s_mov_b32 s9, 20000
L_spin_38:
    buffer_load_dwordx2 v[6:7], v9, s[52:55], 0 offen sc1
    s_waitcnt vmcnt(0)
    v_xor_b32 v250, s8, v7
    v_cmp_ne_u32 vcc, 0, v250
    s_cbranch_vccz L_out_39
    s_sleep 2
    s_sub_u32 s9, s9, 1
    s_cmp_lg_u32 s9, 0
    s_cbranch_scc1 L_spin_38
L_out_39:
L_ok_37:
    s_mov_b32 s12, 0x01000100
    s_mov_b32 s13, 0x03020302
    v_and_b32 v9, 0xffff0000, v6
    v_perm_b32 v4, v6, v6, s12
    v_rcp_f32 v250, v9
    v_perm_b32 v5, v6, v6, s13
    v_xor_b32 v4, 0x80008000, v4
    v_cmp_gt_u32 vcc, 32, v1
    v_mov_b32 v6, 0
    v_mov_b32 v7, 0
    v_mul_f32 v8, 0xbfb8aa3b, v250
    v_mul_f32 v9, v9, v9
    v_cndmask_b32 v4, 0, v4, vcc
    v_cndmask_b32 v5, 0, v5, vcc
    v_mov_b32 v248, 0
    v_mov_b32 v249, 0
    v_mfma_f32_32x32x16_bf16 v[48:63], v[244:247], v[4:7], v[48:63]
    s_nop 0
    v_mfma_f32_32x32x16_bf16 v[64:79], v[246:249], v[4:7], v[64:79]
    v_mfma_f32_32x32x16_bf16 v[16:31], v[240:243], v[4:7], v[16:31]
    v_mfma_f32_32x32x16_bf16 v[32:47], v[242:245], v[4:7], v[32:47]
    v_mov_b32 v250, 163788
    v_mov_b32 v251, 1
    s_mov_b64 exec, 1
    ds_add_u32 v250, v251
    s_mov_b64 exec, -1
    v_add_u32 v14, s34, v15
    s_add_u32 s12, s41, s42
    s_sub_u32 s12, s12, 28672
    v_add_u32 v12, s12, v14
    buffer_load_dwordx4 v[80:83], v14, s[52:55], 0 offen offset:0 sc1
    buffer_load_dwordx4 v[84:87], v14, s[52:55], 0 offen offset:1024 sc1
    v_mul_f32 v192, v8, v48
    v_mul_f32 v193, v8, v49
    v_mul_f32 v194, v8, v50
    v_mul_f32 v195, v8, v51
    v_mul_f32 v196, v8, v52
    v_mul_f32 v197, v8, v53
    buffer_load_dwordx4 v[88:91], v14, s[52:55], 0 offen offset:2048 sc1
    v_mul_f32 v198, v8, v54
    v_mul_f32 v199, v8, v55
    v_exp_f32 v192, v192
    v_mul_f32 v48, v48, v56
    v_exp_f32 v193, v193
    v_mul_f32 v49, v49, v57
    buffer_load_dwordx4 v[92:95], v14, s[52:55], 0 offen offset:3072 sc1
    v_add_u32 v14, s41, v14
    v_exp_f32 v194, v194
    v_mul_f32 v50, v50, v58
    v_exp_f32 v195, v195
    v_mul_f32 v51, v51, v59
    v_exp_f32 v196, v196
    v_mul_f32 v52, v52, v60
    buffer_load_dwordx4 v[96:99], v14, s[52:55], 0 offen offset:0 sc1
    v_exp_f32 v197, v197
    v_mul_f32 v53, v53, v61
    v_exp_f32 v198, v198
    v_mul_f32 v54, v54, v62
    v_exp_f32 v199, v199
    v_mul_f32 v55, v55, v63
    buffer_load_dwordx4 v[100:103], v14, s[52:55], 0 offen offset:1024 sc1
    v_fma_f32 v192, v192, v9, v9
    v_fma_f32 v193, v193, v9, v9
    v_fma_f32 v194, v194, v9, v9
    v_fma_f32 v195, v195, v9, v9
    v_fma_f32 v196, v196, v9, v9
    buffer_load_dwordx4 v[104:107], v14, s[52:55], 0 offen offset:2048 sc1
    v_fma_f32 v197, v197, v9, v9
    v_fma_f32 v198, v198, v9, v9
    v_fma_f32 v199, v199, v9, v9
    v_rcp_f32 v192, v192
    v_rcp_f32 v193, v193
    v_rcp_f32 v194, v194
    buffer_load_dwordx4 v[108:111], v14, s[52:55], 0 offen offset:3072 sc1
    v_add_u32 v14, s42, v14
    v_rcp_f32 v195, v195
    v_rcp_f32 v196, v196
    v_rcp_f32 v197, v197
    v_rcp_f32 v198, v198
    v_rcp_f32 v199, v199
    v_mul_f32 v48, v48, v192
    buffer_load_dwordx4 v[112:115], v14, s[52:55], 0 offen offset:0 sc1
    v_mul_f32 v49, v49, v193
    v_mul_f32 v50, v50, v194
    v_mul_f32 v51, v51, v195
    v_mul_f32 v52, v52, v196
    v_mul_f32 v53, v53, v197
    v_mul_f32 v54, v54, v198
    buffer_load_dwordx4 v[116:119], v14, s[52:55], 0 offen offset:1024 sc1
    v_mul_f32 v55, v55, v199
    v_cvt_pk_bf16_f32 v208, v48, v49
    v_cvt_pk_bf16_f32 v209, v50, v51
    v_cvt_pk_bf16_f32 v210, v52, v53
    v_cvt_pk_bf16_f32 v211, v54, v55
    buffer_load_dwordx4 v[120:123], v14, s[52:55], 0 offen offset:2048 sc1
    v_mul_f32 v192, v8, v64
    v_mul_f32 v193, v8, v65
    v_mul_f32 v194, v8, v66
    v_mul_f32 v195, v8, v67
    v_mul_f32 v196, v8, v68
    v_mul_f32 v197, v8, v69
    buffer_load_dwordx4 v[124:127], v14, s[52:55], 0 offen offset:3072 sc1
    v_add_u32 v14, s43, v14
    v_mul_f32 v198, v8, v70
    v_mul_f32 v199, v8, v71
    v_exp_f32 v192, v192
    v_mul_f32 v64, v64, v72
    v_exp_f32 v193, v193
    v_mul_f32 v65, v65, v73
    buffer_load_dwordx4 v[128:131], v14, s[52:55], 0 offen offset:0 sc1
    v_exp_f32 v194, v194
    v_mul_f32 v66, v66, v74
    v_exp_f32 v195, v195
    v_mul_f32 v67, v67, v75
    v_exp_f32 v196, v196
    v_mul_f32 v68, v68, v76
    buffer_load_dwordx4 v[132:135], v14, s[52:55], 0 offen offset:1024 sc1
    v_exp_f32 v197, v197
    v_mul_f32 v69, v69, v77
    v_exp_f32 v198, v198
    v_mul_f32 v70, v70, v78
    v_exp_f32 v199, v199
    v_mul_f32 v71, v71, v79
    buffer_load_dwordx4 v[136:139], v14, s[52:55], 0 offen offset:2048 sc1
    v_fma_f32 v192, v192, v9, v9
    v_fma_f32 v193, v193, v9, v9
    v_fma_f32 v194, v194, v9, v9
    v_fma_f32 v195, v195, v9, v9
    v_fma_f32 v196, v196, v9, v9
    buffer_load_dwordx4 v[140:143], v14, s[52:55], 0 offen offset:3072 sc1
    v_add_u32 v14, s44, v14
    v_fma_f32 v197, v197, v9, v9
    v_fma_f32 v198, v198, v9, v9
    v_fma_f32 v199, v199, v9, v9
    v_rcp_f32 v192, v192
    v_rcp_f32 v193, v193
    v_rcp_f32 v194, v194
    buffer_load_dwordx4 v[144:147], v14, s[52:55], 0 offen offset:0 sc1
    v_rcp_f32 v195, v195
    v_rcp_f32 v196, v196
    v_rcp_f32 v197, v197
    v_rcp_f32 v198, v198
    v_rcp_f32 v199, v199
    v_mul_f32 v64, v64, v192
    buffer_load_dwordx4 v[148:151], v14, s[52:55], 0 offen offset:1024 sc1
    v_mul_f32 v65, v65, v193
    v_mul_f32 v66, v66, v194
    v_mul_f32 v67, v67, v195
    v_mul_f32 v68, v68, v196
    v_mul_f32 v69, v69, v197
    v_mul_f32 v70, v70, v198
    buffer_load_dwordx4 v[152:155], v14, s[52:55], 0 offen offset:2048 sc1
    v_mul_f32 v71, v71, v199
    v_cvt_pk_bf16_f32 v212, v64, v65
    v_cvt_pk_bf16_f32 v213, v66, v67
    v_cvt_pk_bf16_f32 v214, v68, v69
    v_cvt_pk_bf16_f32 v215, v70, v71
    buffer_load_dwordx4 v[156:159], v14, s[52:55], 0 offen offset:3072 sc1
    v_add_u32 v14, s45, v14
    buffer_store_dwordx4 v[208:211], v15, s[52:55], s72 offen offset:2048 sc1
    buffer_store_dwordx4 v[212:215], v15, s[52:55], s72 offen offset:3072 sc1
    v_mul_f32 v192, v8, v16
    v_mul_f32 v193, v8, v17
    v_mul_f32 v194, v8, v18
    v_mul_f32 v195, v8, v19
    v_mul_f32 v196, v8, v20
    v_mul_f32 v197, v8, v21
    v_mul_f32 v198, v8, v22
    buffer_load_dwordx4 v[160:163], v14, s[52:55], 0 offen offset:0 sc1
    v_mul_f32 v199, v8, v23
    v_exp_f32 v192, v192
    v_mul_f32 v16, v16, v24
    v_exp_f32 v193, v193
    v_mul_f32 v17, v17, v25
    v_exp_f32 v194, v194
    buffer_load_dwordx4 v[164:167], v14, s[52:55], 0 offen offset:1024 sc1
    v_mul_f32 v18, v18, v26
    v_exp_f32 v195, v195
    v_mul_f32 v19, v19, v27
    v_exp_f32 v196, v196
    v_mul_f32 v20, v20, v28
    v_exp_f32 v197, v197
    v_mul_f32 v21, v21, v29
    buffer_load_dwordx4 v[168:171], v14, s[52:55], 0 offen offset:2048 sc1
    v_exp_f32 v198, v198
    v_mul_f32 v22, v22, v30
    v_exp_f32 v199, v199
    v_mul_f32 v23, v23, v31
    v_fma_f32 v192, v192, v9, v9
    v_fma_f32 v193, v193, v9, v9
    buffer_load_dwordx4 v[172:175], v14, s[52:55], 0 offen offset:3072 sc1
    v_add_u32 v14, s37, v14
    v_fma_f32 v194, v194, v9, v9
    v_fma_f32 v195, v195, v9, v9
    v_fma_f32 v196, v196, v9, v9
    v_fma_f32 v197, v197, v9, v9
    v_fma_f32 v198, v198, v9, v9
    v_fma_f32 v199, v199, v9, v9
    v_rcp_f32 v192, v192
    buffer_load_dwordx4 v[176:179], v14, s[52:55], 0 offen offset:0 sc1
    v_rcp_f32 v193, v193
    v_rcp_f32 v194, v194
    v_rcp_f32 v195, v195
    v_rcp_f32 v196, v196
    v_rcp_f32 v197, v197
    v_rcp_f32 v198, v198
    buffer_load_dwordx4 v[180:183], v14, s[52:55], 0 offen offset:1024 sc1
    v_rcp_f32 v199, v199
    v_mul_f32 v16, v16, v192
    v_mul_f32 v17, v17, v193
    v_mov_b32 v250, 163788
    ds_read_b32 v251, v250
    v_mul_f32 v18, v18, v194
    v_mul_f32 v19, v19, v195
    v_mul_f32 v20, v20, v196
    v_mul_f32 v21, v21, v197
    buffer_load_dwordx4 v[184:187], v14, s[52:55], 0 offen offset:2048 sc1
    v_mul_f32 v22, v22, v198
    v_mul_f32 v23, v23, v199
    v_cvt_pk_bf16_f32 v200, v16, v17
    v_cvt_pk_bf16_f32 v201, v18, v19
    v_cvt_pk_bf16_f32 v202, v20, v21
    v_cvt_pk_bf16_f32 v203, v22, v23
    buffer_load_dwordx4 v[188:191], v14, s[52:55], 0 offen offset:3072 sc1
    s_waitcnt lgkmcnt(0)
    s_waitcnt vmcnt(8)
    s_add_u32 s39, s73, 16384
    s_atomic_swap s8, s[50:51], s39
    v_cmp_gt_u32 vcc, 8, v251
    s_cbranch_vccz L_pk_40
    v_mov_b32 v250, 163788
    s_mov_b32 s9, 400000
    s_waitcnt lgkmcnt(0)
L_cw_41:
    ds_read_b32 v251, v250
    s_waitcnt lgkmcnt(0)
    v_cmp_gt_u32 vcc, 8, v251
    s_cbranch_vccz L_cok_42
    s_sub_u32 s9, s9, 1
    s_cmp_lg_u32 s9, 0
    s_cbranch_scc1 L_cw_41
L_cok_42:
L_pk_40:
    v_mul_f32 v192, v8, v32
    v_mul_f32 v193, v8, v33
    v_mul_f32 v194, v8, v34
    v_mul_f32 v195, v8, v35
    v_mul_f32 v196, v8, v36
    v_mul_f32 v197, v8, v37
    v_mul_f32 v198, v8, v38
    s_add_u32 m0, s36, 10240
    s_nop 0
    buffer_load_dwordx4 v12, s[52:55], 0 offen offset:2048 sc1 lds
    v_mul_f32 v199, v8, v39
    v_exp_f32 v192, v192
    v_mul_f32 v32, v32, v40
    v_exp_f32 v193, v193
    v_mul_f32 v33, v33, v41
    v_exp_f32 v194, v194
    buffer_load_dwordx4 v12, s[52:55], 0 offen offset:3072 sc1 lds
    v_add_u32 v12, s43, v12
    v_mul_f32 v34, v34, v42
    v_exp_f32 v195, v195
    v_mul_f32 v35, v35, v43
    v_exp_f32 v196, v196
    v_mul_f32 v36, v36, v44
    v_exp_f32 v197, v197
    v_mul_f32 v37, v37, v45
    s_add_u32 m0, s36, 0
    s_nop 0
    buffer_load_dwordx4 v12, s[52:55], 0 offen offset:0 sc1 lds
    v_exp_f32 v198, v198
    v_mul_f32 v38, v38, v46
    v_exp_f32 v199, v199
    v_mul_f32 v39, v39, v47
    v_fma_f32 v192, v192, v9, v9
    v_fma_f32 v193, v193, v9, v9
    buffer_load_dwordx4 v12, s[52:55], 0 offen offset:1024 sc1 lds
    v_fma_f32 v194, v194, v9, v9
    v_fma_f32 v195, v195, v9, v9
    v_fma_f32 v196, v196, v9, v9
    v_fma_f32 v197, v197, v9, v9
    v_fma_f32 v198, v198, v9, v9
    v_fma_f32 v199, v199, v9, v9
    v_rcp_f32 v192, v192
    buffer_load_dwordx4 v12, s[52:55], 0 offen offset:2048 sc1 lds
    v_rcp_f32 v193, v193
    v_rcp_f32 v194, v194
    v_rcp_f32 v195, v195
    v_rcp_f32 v196, v196
    v_rcp_f32 v197, v197
    v_rcp_f32 v198, v198
    buffer_load_dwordx4 v12, s[52:55], 0 offen offset:3072 sc1 lds
    v_add_u32 v12, s44, v12
    v_rcp_f32 v199, v199
    v_mul_f32 v32, v32, v192
    v_mul_f32 v33, v33, v193
    v_mul_f32 v34, v34, v194
    v_mul_f32 v35, v35, v195
    v_mul_f32 v36, v36, v196
    v_mul_f32 v37, v37, v197
    s_add_u32 m0, s36, 4096
    s_nop 0
    buffer_load_dwordx4 v12, s[52:55], 0 offen offset:0 sc1 lds
    v_mul_f32 v38, v38, v198
    v_mul_f32 v39, v39, v199
    v_cvt_pk_bf16_f32 v204, v32, v33
    v_cvt_pk_bf16_f32 v205, v34, v35
    v_cvt_pk_bf16_f32 v206, v36, v37
    v_cvt_pk_bf16_f32 v207, v38, v39
    buffer_load_dwordx4 v12, s[52:55], 0 offen offset:1024 sc1 lds
    buffer_store_dwordx4 v[200:203], v15, s[52:55], s72 offen offset:0 sc1
    buffer_store_dwordx4 v[204:207], v15, s[52:55], s72 offen offset:1024 sc1
    s_setprio 0
    v_add_u32 v7, 458752, v15
    s_load_dwordx8 s[16:23], s[50:51], s32 glc
    buffer_load_dwordx4 v12, s[52:55], 0 offen offset:2048 sc1 lds
    buffer_load_dwordx4 v12, s[52:55], 0 offen offset:3072 sc1 lds
    v_add_u32 v12, s45, v12
    s_add_u32 m0, s36, 8192
    s_nop 0
    buffer_load_dwordx4 v12, s[52:55], 0 offen offset:0 sc1 lds
    buffer_load_dwordx4 v12, s[52:55], 0 offen offset:1024 sc1 lds
    buffer_load_dwordx4 v12, s[52:55], 0 offen offset:2048 sc1 lds
    buffer_load_dwordx4 v12, s[52:55], 0 offen offset:3072 sc1 lds
    v_add_u32 v12, s37, v12
    s_waitcnt lgkmcnt(0)
    s_mov_b32 s9, 20000
    s_branch L_fc_44
L_fw_43:
    s_load_dwordx8 s[16:23], s[50:51], s32 glc
    s_waitcnt lgkmcnt(0)
L_fc_44:
    s_xor_b32 s16, s16, s8
    s_xor_b32 s17, s17, s8
    s_xor_b32 s18, s18, s8
    s_xor_b32 s19, s19, s8
    s_xor_b32 s20, s20, s8
    s_xor_b32 s21, s21, s8
    s_xor_b32 s22, s22, s8
    s_or_b32 s16, s16, s17
    s_or_b32 s16, s16, s18
    s_or_b32 s16, s16, s19
    s_or_b32 s16, s16, s20
    s_or_b32 s16, s16, s21
    s_or_b32 s16, s16, s22
    s_cbranch_scc0 L_fok_45
    s_sub_u32 s9, s9, 1
    s_cmp_lg_u32 s9, 0
    s_cbranch_scc1 L_fw_43
L_fok_45:
    s_sub_u32 s38, s32, 16384
    v_add_u32 v10, s35, v15
    v_add_u32 v11, s36, v15
    s_waitcnt vmcnt(6)
    s_atomic_swap s8, s[50:51], s73
    s_mov_b32 s71, s75
    buffer_load_dwordx4 v[16:19], v15, s[52:55], s71 offen sc1
    s_add_u32 s71, s71, 1024
    buffer_load_dwordx4 v[20:23], v15, s[52:55], s71 offen sc1
    s_mov_b32 s14, 3072
    s_cmp_eq_u32 s69, 6
    s_cselect_b32 s14, 4294941696, s14
    s_add_u32 s71, s71, s14
    buffer_load_dwordx4 v[24:27], v15, s[52:55], s71 offen sc1
    s_add_u32 s71, s71, 1024
    buffer_load_dwordx4 v[28:31], v15, s[52:55], s71 offen sc1
    s_mov_b32 s14, 3072
    s_cmp_eq_u32 s69, 5
    s_cselect_b32 s14, 4294941696, s14
    s_add_u32 s71, s71, s14
    buffer_load_dwordx4 v[32:35], v15, s[52:55], s71 offen sc1
    s_add_u32 s71, s71, 1024
    s_waitcnt vmcnt(5)
    v_mov_b32 v13, 163788
    v_mov_b32 v14, 1
    s_mov_b64 exec, 1
    ds_add_u32 v13, v14
    s_mov_b64 exec, -1
    s_waitcnt vmcnt(4)
    v_mfma_f32_32x32x16_bf16 v[192:207], v[80:83], v[16:19], 0
    v_mfma_f32_32x32x16_bf16 v[208:223], v[84:87], v[16:19], 0
    buffer_load_dwordx4 v[36:39], v15, s[52:55], s71 offen sc1
    s_mov_b32 s14, 3072
    s_cmp_eq_u32 s69, 4
    s_cselect_b32 s14, 4294941696, s14
    s_add_u32 s71, s71, s14
    buffer_load_dwordx4 v[40:43], v15, s[52:55], s71 offen sc1
    s_add_u32 s71, s71, 1024
    s_waitcnt vmcnt(5)
    v_mfma_f32_32x32x16_bf16 v[192:207], v[88:91], v[20:23], v[192:207]
    v_mfma_f32_32x32x16_bf16 v[208:223], v[92:95], v[20:23], v[208:223]
    buffer_load_dwordx4 v[44:47], v15, s[52:55], s71 offen sc1
    s_mov_b32 s14, 3072
    s_cmp_eq_u32 s69, 3
    s_cselect_b32 s14, 4294941696, s14
    s_add_u32 s71, s71, s14
    s_waitcnt vmcnt(5)
    v_mfma_f32_32x32x16_bf16 v[192:207], v[96:99], v[24:27], v[192:207]
    v_mfma_f32_32x32x16_bf16 v[208:223], v[100:103], v[24:27], v[208:223]
    s_load_dwordx8 s[16:23], s[50:51], s38 glc
    buffer_load_dwordx4 v[48:51], v15, s[52:55], s71 offen sc1
    s_add_u32 s71, s71, 1024
    s_waitcnt vmcnt(5)
    v_mfma_f32_32x32x16_bf16 v[192:207], v[104:107], v[28:31], v[192:207]
    v_mfma_f32_32x32x16_bf16 v[208:223], v[108:111], v[28:31], v[208:223]
    buffer_load_dwordx4 v[52:55], v15, s[52:55], s71 offen sc1
    s_mov_b32 s14, 3072
    s_cmp_eq_u32 s69, 2
    s_cselect_b32 s14, 4294941696, s14
    s_add_u32 s71, s71, s14
    s_waitcnt vmcnt(5)
    v_mfma_f32_32x32x16_bf16 v[192:207], v[112:115], v[32:35], v[192:207]
    v_mfma_f32_32x32x16_bf16 v[208:223], v[116:119], v[32:35], v[208:223]
    buffer_load_dwordx4 v[56:59], v15, s[52:55], s71 offen sc1
    s_add_u32 s71, s71, 1024
    s_waitcnt vmcnt(5)
    v_mfma_f32_32x32x16_bf16 v[192:207], v[120:123], v[36:39], v[192:207]
    v_mfma_f32_32x32x16_bf16 v[208:223], v[124:127], v[36:39], v[208:223]
    buffer_load_dwordx4 v[60:63], v15, s[52:55], s71 offen sc1
    s_mov_b32 s14, 3072
    s_cmp_eq_u32 s69, 1
    s_cselect_b32 s14, 4294941696, s14
    s_add_u32 s71, s71, s14
    s_waitcnt vmcnt(5)
    v_mfma_f32_32x32x16_bf16 v[192:207], v[128:131], v[40:43], v[192:207]
    v_mfma_f32_32x32x16_bf16 v[208:223], v[132:135], v[40:43], v[208:223]
    buffer_load_dwordx4 v[64:67], v15, s[52:55], s71 offen sc1
    s_add_u32 s71, s71, 1024
    s_waitcnt vmcnt(5)
    v_mfma_f32_32x32x16_bf16 v[192:207], v[136:139], v[44:47], v[192:207]
    v_mfma_f32_32x32x16_bf16 v[208:223], v[140:143], v[44:47], v[208:223]
    buffer_load_dwordx4 v[68:71], v15, s[52:55], s71 offen sc1
    s_waitcnt vmcnt(5)
    v_mfma_f32_32x32x16_bf16 v[192:207], v[144:147], v[48:51], v[192:207]
    v_mfma_f32_32x32x16_bf16 v[208:223], v[148:151], v[48:51], v[208:223]
    s_waitcnt lgkmcnt(0)
    s_mov_b32 s9, 20000
    s_branch L_fc_47
L_fw_46:
    s_load_dwordx8 s[16:23], s[50:51], s38 glc
    s_waitcnt lgkmcnt(0)
L_fc_47:
    s_xor_b32 s16, s16, s8
    s_xor_b32 s17, s17, s8
    s_xor_b32 s18, s18, s8
    s_xor_b32 s19, s19, s8
    s_xor_b32 s20, s20, s8
    s_xor_b32 s21, s21, s8
    s_xor_b32 s22, s22, s8
    s_or_b32 s16, s16, s17
    s_or_b32 s16, s16, s18
    s_or_b32 s16, s16, s19
    s_or_b32 s16, s16, s20
    s_or_b32 s16, s16, s21
    s_or_b32 s16, s16, s22
    s_cbranch_scc0 L_fok_48
    s_sub_u32 s9, s9, 1
    s_cmp_lg_u32 s9, 0
    s_cbranch_scc1 L_fw_46
L_fok_48:
    s_sub_u32 s71, s75, 2048
    buffer_load_dwordx4 v[16:19], v15, s[52:55], s71 offen sc1
    s_add_u32 s71, s71, 1024
    s_waitcnt vmcnt(5)
    v_mfma_f32_32x32x16_bf16 v[192:207], v[152:155], v[52:55], v[192:207]
    v_mfma_f32_32x32x16_bf16 v[208:223], v[156:159], v[52:55], v[208:223]
    buffer_load_dwordx4 v[20:23], v15, s[52:55], s71 offen sc1
    s_mov_b32 s14, 3072
    s_cmp_eq_u32 s69, 6
    s_cselect_b32 s14, 4294941696, s14
    s_add_u32 s71, s71, s14
    s_waitcnt vmcnt(5)
    v_mfma_f32_32x32x16_bf16 v[192:207], v[160:163], v[56:59], v[192:207]
    v_mfma_f32_32x32x16_bf16 v[208:223], v[164:167], v[56:59], v[208:223]
    buffer_load_dwordx4 v[24:27], v15, s[52:55], s71 offen sc1
    s_add_u32 s71, s71, 1024
    s_waitcnt vmcnt(5)
    v_mfma_f32_32x32x16_bf16 v[192:207], v[168:171], v[60:63], v[192:207]
    v_mfma_f32_32x32x16_bf16 v[208:223], v[172:175], v[60:63], v[208:223]
    buffer_load_dwordx4 v[28:31], v15, s[52:55], s71 offen sc1
    s_mov_b32 s14, 3072
    s_cmp_eq_u32 s69, 5
    s_cselect_b32 s14, 4294941696, s14
    s_add_u32 s71, s71, s14
    ds_read_b128 v[72:75], v10 offset:0
    ds_read_b128 v[76:79], v10 offset:1024
    s_waitcnt vmcnt(5)
    v_mfma_f32_32x32x16_bf16 v[192:207], v[176:179], v[64:67], v[192:207]
    v_mfma_f32_32x32x16_bf16 v[208:223], v[180:183], v[64:67], v[208:223]
    buffer_load_dwordx4 v[32:35], v15, s[52:55], s71 offen sc1
    s_add_u32 s71, s71, 1024
    ds_read_b128 v[224:227], v10 offset:2048
    ds_read_b128 v[228:231], v10 offset:3072
    s_waitcnt vmcnt(5)
    v_mfma_f32_32x32x16_bf16 v[192:207], v[184:187], v[68:71], v[192:207]
    v_mfma_f32_32x32x16_bf16 v[208:223], v[188:191], v[68:71], v[208:223]
    buffer_load_dwordx4 v[36:39], v15, s[52:55], s71 offen sc1
    s_mov_b32 s14, 3072
    s_cmp_eq_u32 s69, 4
    s_cselect_b32 s14, 4294941696, s14
    s_add_u32 s71, s71, s14
    ds_read_b128 v[232:235], v10 offset:4096
    ds_read_b128 v[236:239], v10 offset:5120
    s_waitcnt vmcnt(5) lgkmcnt(5)
    v_mfma_f32_32x32x16_bf16 v[192:207], v[72:75], v[16:19], v[192:207]
    s_waitcnt lgkmcnt(4)
    v_mfma_f32_32x32x16_bf16 v[208:223], v[76:79], v[16:19], v[208:223]
    buffer_load_dwordx4 v[40:43], v15, s[52:55], s71 offen sc1
    s_add_u32 s71, s71, 1024
    ds_read_b128 v[72:75], v10 offset:6144
    ds_read_b128 v[76:79], v10 offset:7168
    s_waitcnt vmcnt(5) lgkmcnt(5)
    v_mfma_f32_32x32x16_bf16 v[192:207], v[224:227], v[20:23], v[192:207]
    s_waitcnt lgkmcnt(4)
    v_mfma_f32_32x32x16_bf16 v[208:223], v[228:231], v[20:23], v[208:223]
    buffer_load_dwordx4 v[44:47], v15, s[52:55], s71 offen sc1
    s_mov_b32 s14, 3072
    s_cmp_eq_u32 s69, 3
    s_cselect_b32 s14, 4294941696, s14
    s_branch L_pg5
.p2align 12
L_stub5:
    s_setpc_b64 s[100:101]
    s_nop 0
L_pg5:
    s_add_u32 s71, s71, s14
    ds_read_b128 v[224:227], v10 offset:8192
    ds_read_b128 v[228:231], v10 offset:9216
    s_waitcnt vmcnt(5) lgkmcnt(5)
    v_mfma_f32_32x32x16_bf16 v[192:207], v[232:235], v[24:27], v[192:207]
    s_waitcnt lgkmcnt(4)
    v_mfma_f32_32x32x16_bf16 v[208:223], v[236:239], v[24:27], v[208:223]
    s_load_dwordx8 s[24:31], s[50:51], s33 glc
    buffer_load_dwordx4 v[48:51], v15, s[52:55], s71 offen sc1
    s_add_u32 s71, s71, 1024
    ds_read_b128 v[232:235], v11 offset:12288
    ds_read_b128 v[236:239], v11 offset:13312
    s_waitcnt vmcnt(5) lgkmcnt(5)
    v_mfma_f32_32x32x16_bf16 v[192:207], v[72:75], v[28:31], v[192:207]
    s_waitcnt lgkmcnt(4)
    v_mfma_f32_32x32x16_bf16 v[208:223], v[76:79], v[28:31], v[208:223]
    buffer_load_dwordx4 v[52:55], v15, s[52:55], s71 offen sc1
    s_mov_b32 s14, 3072
    s_cmp_eq_u32 s69, 2
    s_cselect_b32 s14, 4294941696, s14
    s_add_u32 s71, s71, s14
    ds_read_b128 v[72:75], v11 offset:0
    ds_read_b128 v[76:79], v11 offset:1024
    s_waitcnt vmcnt(5) lgkmcnt(5)
    v_mfma_f32_32x32x16_bf16 v[192:207], v[224:227], v[32:35], v[192:207]
    s_waitcnt lgkmcnt(4)
    v_mfma_f32_32x32x16_bf16 v[208:223], v[228:231], v[32:35], v[208:223]
    buffer_load_dwordx4 v[56:59], v15, s[52:55], s71 offen sc1
    s_add_u32 s71, s71, 1024
    ds_read_b128 v[224:227], v11 offset:2048
    ds_read_b128 v[228:231], v11 offset:3072
    s_waitcnt vmcnt(5) lgkmcnt(5)
    v_mfma_f32_32x32x16_bf16 v[192:207], v[232:235], v[36:39], v[192:207]
    s_waitcnt lgkmcnt(4)
    v_mfma_f32_32x32x16_bf16 v[208:223], v[236:239], v[36:39], v[208:223]
    buffer_load_dwordx4 v[60:63], v15, s[52:55], s71 offen sc1
    s_mov_b32 s14, 3072
    s_cmp_eq_u32 s69, 1
    s_cselect_b32 s14, 4294941696, s14
    s_add_u32 s71, s71, s14
    ds_read_b128 v[232:235], v11 offset:4096
    ds_read_b128 v[236:239], v11 offset:5120
    s_waitcnt vmcnt(5) lgkmcnt(5)
    v_mfma_f32_32x32x16_bf16 v[192:207], v[72:75], v[40:43], v[192:207]
    s_waitcnt lgkmcnt(4)
    v_mfma_f32_32x32x16_bf16 v[208:223], v[76:79], v[40:43], v[208:223]
    buffer_load_dwordx4 v[240:243], v12, s[52:55], 0 offen offset:0 sc1
    buffer_load_dwordx4 v[244:247], v12, s[52:55], 0 offen offset:1024 sc1
    buffer_load_dwordx4 v[64:67], v15, s[52:55], s71 offen sc1
    s_add_u32 s71, s71, 1024
    ds_read_b128 v[72:75], v11 offset:6144
    ds_read_b128 v[76:79], v11 offset:7168
    s_waitcnt vmcnt(7) lgkmcnt(5)
    v_mfma_f32_32x32x16_bf16 v[192:207], v[224:227], v[44:47], v[192:207]
    s_waitcnt lgkmcnt(4)
    v_mfma_f32_32x32x16_bf16 v[208:223], v[228:231], v[44:47], v[208:223]
    buffer_load_dwordx4 v[248:251], v12, s[52:55], 0 offen offset:2048 sc1
    buffer_load_dwordx4 v[252:255], v12, s[52:55], 0 offen offset:3072 sc1
    buffer_load_dwordx4 v[68:71], v15, s[52:55], s71 offen sc1
    ds_read_b128 v[224:227], v11 offset:8192
    ds_read_b128 v[228:231], v11 offset:9216
    s_waitcnt vmcnt(9) lgkmcnt(5)
    v_mfma_f32_32x32x16_bf16 v[192:207], v[232:235], v[48:51], v[192:207]
    s_waitcnt lgkmcnt(4)
    v_mfma_f32_32x32x16_bf16 v[208:223], v[236:239], v[48:51], v[208:223]
    s_waitcnt lgkmcnt(0)
    s_mov_b32 s9, 20000
    s_branch L_fc_50
L_fw_49:
    s_load_dwordx8 s[24:31], s[50:51], s33 glc
    s_waitcnt lgkmcnt(0)
L_fc_50:
    s_xor_b32 s24, s24, s8
    s_xor_b32 s25, s25, s8
    s_xor_b32 s26, s26, s8
    s_xor_b32 s27, s27, s8
    s_xor_b32 s28, s28, s8
    s_xor_b32 s29, s29, s8
    s_xor_b32 s30, s30, s8
    s_or_b32 s24, s24, s25
    s_or_b32 s24, s24, s26
    s_or_b32 s24, s24, s27
    s_or_b32 s24, s24, s28
    s_or_b32 s24, s24, s29
    s_or_b32 s24, s24, s30
    s_cbranch_scc0 L_fok_51
    s_sub_u32 s9, s9, 1
    s_cmp_lg_u32 s9, 0
    s_cbranch_scc1 L_fw_49
L_fok_51:
    s_mov_b32 s71, s75
    buffer_load_dwordx4 v[16:19], v7, s[52:55], s71 offen sc1
    s_add_u32 s71, s71, 1024
    ds_read_b128 v[232:235], v11 offset:10240
    ds_read_b128 v[236:239], v11 offset:11264
    s_waitcnt vmcnt(9)
    v_mfma_f32_32x32x16_bf16 v[192:207], v[72:75], v[52:55], v[192:207]
    v_mfma_f32_32x32x16_bf16 v[208:223], v[76:79], v[52:55], v[208:223]
    buffer_load_dwordx4 v[20:23], v7, s[52:55], s71 offen sc1
    s_mov_b32 s14, 3072
    s_cmp_eq_u32 s69, 6
    s_cselect_b32 s14, 4294941696, s14
    s_add_u32 s71, s71, s14
    s_waitcnt vmcnt(9)
    v_mfma_f32_32x32x16_bf16 v[192:207], v[224:227], v[56:59], v[192:207]
    v_mfma_f32_32x32x16_bf16 v[208:223], v[228:231], v[56:59], v[208:223]
    buffer_load_dwordx4 v[24:27], v7, s[52:55], s71 offen sc1
    s_add_u32 s71, s71, 1024
    s_waitcnt vmcnt(9) lgkmcnt(1)
    v_mfma_f32_32x32x16_bf16 v[192:207], v[232:235], v[60:63], v[192:207]
    s_waitcnt lgkmcnt(0)
    v_mfma_f32_32x32x16_bf16 v[208:223], v[236:239], v[60:63], v[208:223]
    buffer_load_dwordx4 v[28:31], v7, s[52:55], s71 offen sc1
    s_mov_b32 s14, 3072
    s_cmp_eq_u32 s69, 5
    s_cselect_b32 s14, 4294941696, s14
    s_add_u32 s71, s71, s14
    s_waitcnt vmcnt(7)
    v_mfma_f32_32x32x16_bf16 v[192:207], v[240:243], v[64:67], v[192:207]
    v_mfma_f32_32x32x16_bf16 v[208:223], v[244:247], v[64:67], v[208:223]
    buffer_load_dwordx4 v[32:35], v7, s[52:55], s71 offen sc1
    s_add_u32 s71, s71, 1024
    s_waitcnt vmcnt(5)
    v_mfma_f32_32x32x16_bf16 v[192:207], v[248:251], v[68:71], v[192:207]
    v_mfma_f32_32x32x16_bf16 v[208:223], v[252:255], v[68:71], v[208:223]
    buffer_load_dwordx4 v[36:39], v7, s[52:55], s71 offen sc1
    s_mov_b32 s14, 3072
    s_cmp_eq_u32 s69, 4
    s_cselect_b32 s14, 4294941696, s14
    s_add_u32 s71, s71, s14
    s_waitcnt vmcnt(5)
    v_mfma_f32_32x32x16_bf16 v[224:239], v[80:83], v[16:19], 0
    v_mfma_f32_32x32x16_bf16 v[240:255], v[84:87], v[16:19], 0
    buffer_load_dwordx4 v[40:43], v7, s[52:55], s71 offen sc1
    s_add_u32 s71, s71, 1024
    s_waitcnt vmcnt(5)
    v_mfma_f32_32x32x16_bf16 v[224:239], v[88:91], v[20:23], v[224:239]
    v_mfma_f32_32x32x16_bf16 v[240:255], v[92:95], v[20:23], v[240:255]
    buffer_load_dwordx4 v[44:47], v7, s[52:55], s71 offen sc1
    s_mov_b32 s14, 3072
    s_cmp_eq_u32 s69, 3
    s_cselect_b32 s14, 4294941696, s14
    s_add_u32 s71, s71, s14
    v_mov_b32 v13, 163776
    s_mov_b32 s9, 400000
    s_waitcnt lgkmcnt(0)
L_cw_52:
    ds_read_b32 v14, v13
    s_waitcnt lgkmcnt(0)
    v_cmp_gt_u32 vcc, 8, v14
    s_cbranch_vccz L_cok_53
    s_sub_u32 s9, s9, 1
    s_cmp_lg_u32 s9, 0
    s_cbranch_scc1 L_cw_52
L_cok_53:
    v_lshlrev_b32 v6, 5, v3
    v_xor_b32 v6, v6, v15
    v_add_u32 v6, s35, v6
    ds_write_b128 v6, v[192:195] offset:0
    ds_write_b128 v6, v[208:211] offset:1024
    v_xor_b32 v6, 64, v6
    ds_write_b128 v6, v[196:199] offset:2048
    ds_write_b128 v6, v[212:215] offset:3072
    v_xor_b32 v6, 192, v6
    ds_write_b128 v6, v[200:203] offset:4096
    ds_write_b128 v6, v[216:219] offset:5120
    v_xor_b32 v6, 64, v6
    ds_write_b128 v6, v[204:207] offset:6144
    ds_write_b128 v6, v[220:223] offset:7168
    v_mov_b32 v13, 163792
    v_mov_b32 v14, 1
    s_mov_b64 exec, 1
    ds_add_u32 v13, v14
    s_mov_b64 exec, -1
    s_waitcnt vmcnt(5)
    v_mfma_f32_32x32x16_bf16 v[224:239], v[96:99], v[24:27], v[224:239]
    v_mfma_f32_32x32x16_bf16 v[240:255], v[100:103], v[24:27], v[240:255]
    buffer_load_dwordx4 v[48:51], v7, s[52:55], s71 offen sc1
    s_add_u32 s71, s71, 1024
    s_waitcnt vmcnt(5)
    v_mfma_f32_32x32x16_bf16 v[224:239], v[104:107], v[28:31], v[224:239]
    v_mfma_f32_32x32x16_bf16 v[240:255], v[108:111], v[28:31], v[240:255]
    buffer_load_dwordx4 v[52:55], v7, s[52:55], s71 offen sc1
    s_mov_b32 s14, 3072
    s_cmp_eq_u32 s69, 2
    s_cselect_b32 s14, 4294941696, s14
    s_add_u32 s71, s71, s14
    s_waitcnt vmcnt(5)
    v_mfma_f32_32x32x16_bf16 v[224:239], v[112:115], v[32:35], v[224:239]
    v_mfma_f32_32x32x16_bf16 v[240:255], v[116:119], v[32:35], v[240:255]
    buffer_load_dwordx4 v[56:59], v7, s[52:55], s71 offen sc1
    s_add_u32 s71, s71, 1024
    s_waitcnt vmcnt(5)
    v_mfma_f32_32x32x16_bf16 v[224:239], v[120:123], v[36:39], v[224:239]
    v_mfma_f32_32x32x16_bf16 v[240:255], v[124:127], v[36:39], v[240:255]
    buffer_load_dwordx4 v[60:63], v7, s[52:55], s71 offen sc1
    s_mov_b32 s14, 3072
    s_cmp_eq_u32 s69, 1
    s_cselect_b32 s14, 4294941696, s14
    s_add_u32 s71, s71, s14
    s_waitcnt vmcnt(5)
    v_mfma_f32_32x32x16_bf16 v[224:239], v[128:131], v[40:43], v[224:239]
    v_mfma_f32_32x32x16_bf16 v[240:255], v[132:135], v[40:43], v[240:255]
    buffer_load_dwordx4 v[64:67], v7, s[52:55], s71 offen sc1
    s_add_u32 s71, s71, 1024
    s_waitcnt vmcnt(5)
    v_mfma_f32_32x32x16_bf16 v[224:239], v[136:139], v[44:47], v[224:239]
    v_mfma_f32_32x32x16_bf16 v[240:255], v[140:143], v[44:47], v[240:255]
    buffer_load_dwordx4 v[68:71], v7, s[52:55], s71 offen sc1
    s_waitcnt vmcnt(5)
    v_mfma_f32_32x32x16_bf16 v[224:239], v[144:147], v[48:51], v[224:239]
    v_mfma_f32_32x32x16_bf16 v[240:255], v[148:151], v[48:51], v[240:255]
    s_waitcnt vmcnt(4)
    v_mfma_f32_32x32x16_bf16 v[224:239], v[152:155], v[52:55], v[224:239]
    v_mfma_f32_32x32x16_bf16 v[240:255], v[156:159], v[52:55], v[240:255]
    s_waitcnt vmcnt(3)
    v_mfma_f32_32x32x16_bf16 v[224:239], v[160:163], v[56:59], v[224:239]
    v_mfma_f32_32x32x16_bf16 v[240:255], v[164:167], v[56:59], v[240:255]
    s_waitcnt vmcnt(2)
    v_mfma_f32_32x32x16_bf16 v[224:239], v[168:171], v[60:63], v[224:239]
    v_mfma_f32_32x32x16_bf16 v[240:255], v[172:175], v[60:63], v[240:255]
    s_waitcnt vmcnt(1)
    v_mfma_f32_32x32x16_bf16 v[224:239], v[176:179], v[64:67], v[224:239]
    v_mfma_f32_32x32x16_bf16 v[240:255], v[180:183], v[64:67], v[240:255]
    s_waitcnt vmcnt(0)
    v_mfma_f32_32x32x16_bf16 v[224:239], v[184:187], v[68:71], v[224:239]
    v_mfma_f32_32x32x16_bf16 v[240:255], v[188:191], v[68:71], v[240:255]
    v_lshlrev_b32 v6, 5, v3
    v_xor_b32 v6, v6, v15
    v_add_u32 v6, s36, v6
    s_nop 7
    ds_write_b128 v6, v[224:227] offset:0
    ds_write_b128 v6, v[240:243] offset:1024
    v_xor_b32 v6, 64, v6
    ds_write_b128 v6, v[228:231] offset:2048
    ds_write_b128 v6, v[244:247] offset:3072
    v_xor_b32 v6, 192, v6
    ds_write_b128 v6, v[232:235] offset:4096
    ds_write_b128 v6, v[248:251] offset:5120
    v_xor_b32 v6, 64, v6
    ds_write_b128 v6, v[236:239] offset:6144
    ds_write_b128 v6, v[252:255] offset:7168
    v_mov_b32 v13, 163796
    v_mov_b32 v14, 1
    s_mov_b64 exec, 1
    ds_add_u32 v13, v14
    s_mov_b64 exec, -1
    s_branch L_fin
.p2align 12
L_stub6:
    s_setpc_b64 s[100:101]
    s_nop 0
L_pg6:
L_ffnB:
    s_barrier
    s_lshl_b32 s12, s67, 2
    s_add_u32 s12, s12, s3
    s_lshl_b32 s12, s12, 9
    s_add_u32 s12, s12, 4456448
    v_lshl_add_u32 v14, v2, 4, s12
    buffer_load_dword v80, v4, s[52:55], 0 offen offset:0 sc1
    buffer_load_dword v81, v4, s[52:55], 0 offen offset:1024 sc1
    buffer_load_dword v82, v4, s[52:55], 0 offen offset:2048 sc1
    buffer_load_dword v83, v4, s[52:55], 0 offen offset:3072 sc1
    v_add_u32 v4, 8192, v4
    buffer_load_dword v84, v4, s[52:55], 0 offen offset:0 sc1
    buffer_load_dword v85, v4, s[52:55], 0 offen offset:1024 sc1
    buffer_load_dword v86, v4, s[52:55], 0 offen offset:2048 sc1
    buffer_load_dword v87, v4, s[52:55], 0 offen offset:3072 sc1
    v_add_u32 v4, 8192, v4
    buffer_load_dword v88, v4, s[52:55], 0 offen offset:0 sc1
    buffer_load_dword v89, v4, s[52:55], 0 offen offset:1024 sc1
    buffer_load_dword v90, v4, s[52:55], 0 offen offset:2048 sc1
    buffer_load_dword v91, v4, s[52:55], 0 offen offset:3072 sc1
    v_add_u32 v4, 8192, v4
    buffer_load_dword v92, v4, s[52:55], 0 offen offset:0 sc1
    buffer_load_dword v93, v4, s[52:55], 0 offen offset:1024 sc1
    buffer_load_dword v94, v4, s[52:55], 0 offen offset:2048 sc1
    buffer_load_dword v95, v4, s[52:55], 0 offen offset:3072 sc1
    s_mov_b32 s14, 8192
    s_cmp_eq_u32 s38, 24
    s_cselect_b32 s14, 4294746112, s14
    v_add_u32 v4, s14, v4
    buffer_load_dword v96, v4, s[52:55], 0 offen offset:0 sc1
    buffer_load_dword v97, v4, s[52:55], 0 offen offset:1024 sc1
    buffer_load_dword v98, v4, s[52:55], 0 offen offset:2048 sc1
    buffer_load_dword v99, v4, s[52:55], 0 offen offset:3072 sc1
    v_add_u32 v4, 8192, v4
    buffer_load_dwordx4 v[240:243], v14, s[52:55], 0 offen sc1
    buffer_load_dword v100, v4, s[52:55], 0 offen offset:0 sc1
    buffer_load_dword v101, v4, s[52:55], 0 offen offset:1024 sc1
    buffer_load_dword v102, v4, s[52:55], 0 offen offset:2048 sc1
    buffer_load_dword v103, v4, s[52:55], 0 offen offset:3072 sc1
    v_add_u32 v4, 8192, v4
    buffer_load_dword v104, v4, s[52:55], 0 offen offset:0 sc1
    buffer_load_dword v105, v4, s[52:55], 0 offen offset:1024 sc1
    buffer_load_dword v106, v4, s[52:55], 0 offen offset:2048 sc1
    buffer_load_dword v107, v4, s[52:55], 0 offen offset:3072 sc1
    v_add_u32 v4, 8192, v4
    buffer_load_dword v108, v4, s[52:55], 0 offen offset:0 sc1
    buffer_load_dword v109, v4, s[52:55], 0 offen offset:1024 sc1
    buffer_load_dword v110, v4, s[52:55], 0 offen offset:2048 sc1
    buffer_load_dword v111, v4, s[52:55], 0 offen offset:3072 sc1
    s_mov_b32 s14, 8192
    s_cmp_eq_u32 s38, 20
    s_cselect_b32 s14, 4294746112, s14
    v_add_u32 v4, s14, v4
    buffer_load_dword v112, v4, s[52:55], 0 offen offset:0 sc1
    buffer_load_dword v113, v4, s[52:55], 0 offen offset:1024 sc1
    buffer_load_dword v114, v4, s[52:55], 0 offen offset:2048 sc1
    buffer_load_dword v115, v4, s[52:55], 0 offen offset:3072 sc1
    v_add_u32 v4, 8192, v4
    buffer_load_dword v116, v4, s[52:55], 0 offen offset:0 sc1
    buffer_load_dword v117, v4, s[52:55], 0 offen offset:1024 sc1
    buffer_load_dword v118, v4, s[52:55], 0 offen offset:2048 sc1
    buffer_load_dword v119, v4, s[52:55], 0 offen offset:3072 sc1
    v_add_u32 v4, 8192, v4
    buffer_load_dword v120, v4, s[52:55], 0 offen offset:0 sc1
    buffer_load_dword v121, v4, s[52:55], 0 offen offset:1024 sc1
    buffer_load_dword v122, v4, s[52:55], 0 offen offset:2048 sc1
    buffer_load_dword v123, v4, s[52:55], 0 offen offset:3072 sc1
    v_add_u32 v4, 8192, v4
    buffer_load_dword v124, v4, s[52:55], 0 offen offset:0 sc1
    buffer_load_dword v125, v4, s[52:55], 0 offen offset:1024 sc1
    buffer_load_dword v126, v4, s[52:55], 0 offen offset:2048 sc1
    buffer_load_dword v127, v4, s[52:55], 0 offen offset:3072 sc1
    s_mov_b32 s14, 8192
    s_cmp_eq_u32 s38, 16
    s_cselect_b32 s14, 4294746112, s14
    v_add_u32 v4, s14, v4
    buffer_load_dword v128, v4, s[52:55], 0 offen offset:0 sc1
    buffer_load_dword v129, v4, s[52:55], 0 offen offset:1024 sc1
    buffer_load_dword v130, v4, s[52:55], 0 offen offset:2048 sc1
    buffer_load_dword v131, v4, s[52:55], 0 offen offset:3072 sc1
    v_add_u32 v4, 8192, v4
    buffer_load_dword v132, v4, s[52:55], 0 offen offset:0 sc1
    buffer_load_dword v133, v4, s[52:55], 0 offen offset:1024 sc1
    buffer_load_dword v134, v4, s[52:55], 0 offen offset:2048 sc1
    buffer_load_dword v135, v4, s[52:55], 0 offen offset:3072 sc1
    v_add_u32 v4, 8192, v4
    buffer_load_dword v136, v4, s[52:55], 0 offen offset:0 sc1
    buffer_load_dword v137, v4, s[52:55], 0 offen offset:1024 sc1
    buffer_load_dword v138, v4, s[52:55], 0 offen offset:2048 sc1
    buffer_load_dword v139, v4, s[52:55], 0 offen offset:3072 sc1
    v_add_u32 v4, 8192, v4
    buffer_load_dword v140, v4, s[52:55], 0 offen offset:0 sc1
    buffer_load_dword v141, v4, s[52:55], 0 offen offset:1024 sc1
    buffer_load_dword v142, v4, s[52:55], 0 offen offset:2048 sc1
    buffer_load_dword v143, v4, s[52:55], 0 offen offset:3072 sc1
    s_mov_b32 s14, 8192
    s_cmp_eq_u32 s38, 12
    s_cselect_b32 s14, 4294746112, s14
    v_add_u32 v4, s14, v4
    buffer_load_dword v144, v4, s[52:55], 0 offen offset:0 sc1
    buffer_load_dword v145, v4, s[52:55], 0 offen offset:1024 sc1
    buffer_load_dword v146, v4, s[52:55], 0 offen offset:2048 sc1
    buffer_load_dword v147, v4, s[52:55], 0 offen offset:3072 sc1
    v_add_u32 v4, 8192, v4
    buffer_load_dword v148, v4, s[52:55], 0 offen offset:0 sc1
    buffer_load_dword v149, v4, s[52:55], 0 offen offset:1024 sc1
    buffer_load_dword v150, v4, s[52:55], 0 offen offset:2048 sc1
    buffer_load_dword v151, v4, s[52:55], 0 offen offset:3072 sc1
    v_add_u32 v4, 8192, v4
    buffer_load_dword v152, v4, s[52:55], 0 offen offset:0 sc1
    buffer_load_dword v153, v4, s[52:55], 0 offen offset:1024 sc1
    buffer_load_dword v154, v4, s[52:55], 0 offen offset:2048 sc1
    buffer_load_dword v155, v4, s[52:55], 0 offen offset:3072 sc1
    v_add_u32 v4, 8192, v4
    s_waitcnt vmcnt(56)
    v_bitop3_b32 v244, v241, v243, s8 bitop3:0x7e
    v_cmp_ne_u32 vcc, 0, v244
    s_cbranch_vccz L_ok_54
    s_mov_b32 s9, 20000
L_spin_55:
    buffer_load_dwordx4 v[240:243], v14, s[52:55], 0 offen sc1
    s_waitcnt vmcnt(0)
    v_bitop3_b32 v244, v241, v243, s8 bitop3:0x7e
    v_cmp_ne_u32 vcc, 0, v244
    s_cbranch_vccz L_out_56
    s_sleep 2
    s_sub_u32 s9, s9, 1
    s_cmp_lg_u32 s9, 0
    s_cbranch_scc1 L_spin_55
L_out_56:
L_ok_54:
    s_lshl_b32 s12, s3, 8
    v_add_u32 v14, s12, v8
    ds_write2_b32 v14, v240, v242 offset0:0 offset1:1
    v_mov_b32 v244, 163784
    v_mov_b32 v245, 1
    s_mov_b64 exec, 1
    ds_add_u32 v244, v245
    s_mov_b64 exec, -1
    buffer_load_dword v156, v4, s[52:55], 0 offen offset:0 sc1
    buffer_load_dword v157, v4, s[52:55], 0 offen offset:1024 sc1
    buffer_load_dword v158, v4, s[52:55], 0 offen offset:2048 sc1
    buffer_load_dword v159, v4, s[52:55], 0 offen offset:3072 sc1
    s_mov_b32 s14, 8192
    s_cmp_eq_u32 s38, 8
    s_cselect_b32 s14, 4294746112, s14
    v_add_u32 v4, s14, v4
    buffer_load_dword v160, v4, s[52:55], 0 offen offset:0 sc1
    buffer_load_dword v161, v4, s[52:55], 0 offen offset:1024 sc1
    buffer_load_dword v162, v4, s[52:55], 0 offen offset:2048 sc1
    buffer_load_dword v163, v4, s[52:55], 0 offen offset:3072 sc1
    v_add_u32 v4, 8192, v4
    buffer_load_dword v164, v4, s[52:55], 0 offen offset:0 sc1
    buffer_load_dword v165, v4, s[52:55], 0 offen offset:1024 sc1
    buffer_load_dword v166, v4, s[52:55], 0 offen offset:2048 sc1
    buffer_load_dword v167, v4, s[52:55], 0 offen offset:3072 sc1
    v_add_u32 v4, 8192, v4
    buffer_load_dword v168, v4, s[52:55], 0 offen offset:0 sc1
    buffer_load_dword v169, v4, s[52:55], 0 offen offset:1024 sc1
    buffer_load_dword v170, v4, s[52:55], 0 offen offset:2048 sc1
    buffer_load_dword v171, v4, s[52:55], 0 offen offset:3072 sc1
    v_add_u32 v4, 8192, v4
    buffer_load_dword v172, v4, s[52:55], 0 offen offset:0 sc1
    buffer_load_dword v173, v4, s[52:55], 0 offen offset:1024 sc1
    buffer_load_dword v174, v4, s[52:55], 0 offen offset:2048 sc1
    buffer_load_dword v175, v4, s[52:55], 0 offen offset:3072 sc1
    s_mov_b32 s14, 8192
    s_cmp_eq_u32 s38, 4
    s_cselect_b32 s14, 4294746112, s14
    v_add_u32 v4, s14, v4
    buffer_load_dword v176, v4, s[52:55], 0 offen offset:0 sc1
    buffer_load_dword v177, v4, s[52:55], 0 offen offset:1024 sc1
    buffer_load_dword v178, v4, s[52:55], 0 offen offset:2048 sc1
    buffer_load_dword v179, v4, s[52:55], 0 offen offset:3072 sc1
    v_add_u32 v4, 8192, v4
    buffer_load_dword v180, v4, s[52:55], 0 offen offset:0 sc1
    buffer_load_dword v181, v4, s[52:55], 0 offen offset:1024 sc1
    buffer_load_dword v182, v4, s[52:55], 0 offen offset:2048 sc1
    buffer_load_dword v183, v4, s[52:55], 0 offen offset:3072 sc1
    v_add_u32 v4, 8192, v4
    buffer_load_dword v184, v4, s[52:55], 0 offen offset:0 sc1
    buffer_load_dword v185, v4, s[52:55], 0 offen offset:1024 sc1
    buffer_load_dword v186, v4, s[52:55], 0 offen offset:2048 sc1
    buffer_load_dword v187, v4, s[52:55], 0 offen offset:3072 sc1
    v_add_u32 v4, 8192, v4
    buffer_load_dword v188, v4, s[52:55], 0 offen offset:0 sc1
    buffer_load_dword v189, v4, s[52:55], 0 offen offset:1024 sc1
    buffer_load_dword v190, v4, s[52:55], 0 offen offset:2048 sc1
    buffer_load_dword v191, v4, s[52:55], 0 offen offset:3072 sc1
    v_add_u32 v4, 8192, v4
    buffer_load_dwordx2 v[6:7], v9, s[52:55], 0 offen sc1
    s_setprio 3
    v_add_u32 v14, s34, v15
    s_add_u32 m0, s35, 0
    s_nop 0
    buffer_load_dwordx4 v14, s[52:55], 0 offen offset:0 sc1 lds
    buffer_load_dwordx4 v14, s[52:55], 0 offen offset:1024 sc1 lds
    buffer_load_dwordx4 v14, s[52:55], 0 offen offset:2048 sc1 lds
    buffer_load_dwordx4 v14, s[52:55], 0 offen offset:3072 sc1 lds
    v_add_u32 v14, s41, v14
    s_add_u32 m0, s35, 4096
    s_nop 0
    buffer_load_dwordx4 v14, s[52:55], 0 offen offset:0 sc1 lds
    buffer_load_dwordx4 v14, s[52:55], 0 offen offset:1024 sc1 lds
    buffer_load_dwordx4 v14, s[52:55], 0 offen offset:2048 sc1 lds
    buffer_load_dwordx4 v14, s[52:55], 0 offen offset:3072 sc1 lds
    v_add_u32 v14, s42, v14
    s_add_u32 m0, s35, 8192
    s_nop 0
    buffer_load_dwordx4 v14, s[52:55], 0 offen offset:0 sc1 lds
    buffer_load_dwordx4 v14, s[52:55], 0 offen offset:1024 sc1 lds
    s_setprio 1
    ds_read_b64_tr_b16 v[192:193], v10 offset:0
    ds_read_b64_tr_b16 v[194:195], v10 offset:256
    ds_read_b64_tr_b16 v[196:197], v11 offset:0
    ds_read_b64_tr_b16 v[198:199], v11 offset:256
    ds_read_b64_tr_b16 v[200:201], v10 offset:1024
    ds_read_b64_tr_b16 v[202:203], v10 offset:1280
    ds_read_b64_tr_b16 v[204:205], v11 offset:1024
    ds_read_b64_tr_b16 v[206:207], v11 offset:1280
    s_waitcnt lgkmcnt(6)
    v_mfma_f32_32x32x16_bf16 v[16:31], v[192:195], v[80:83], 0
    ds_read_b64_tr_b16 v[208:209], v10 offset:2048
    ds_read_b64_tr_b16 v[210:211], v10 offset:2304
    s_waitcnt lgkmcnt(6)
    v_mfma_f32_32x32x16_bf16 v[32:47], v[196:199], v[80:83], 0
    ds_read_b64_tr_b16 v[212:213], v11 offset:2048
    ds_read_b64_tr_b16 v[214:215], v11 offset:2304
    s_waitcnt lgkmcnt(6)
    v_mfma_f32_32x32x16_bf16 v[16:31], v[200:203], v[84:87], v[16:31]
    ds_read_b64_tr_b16 v[192:193], v10 offset:3072
    ds_read_b64_tr_b16 v[194:195], v10 offset:3328
    s_waitcnt lgkmcnt(6)
    v_mfma_f32_32x32x16_bf16 v[32:47], v[204:207], v[84:87], v[32:47]
    ds_read_b64_tr_b16 v[196:197], v11 offset:3072
    ds_read_b64_tr_b16 v[198:199], v11 offset:3328
    s_waitcnt lgkmcnt(6)
    v_mfma_f32_32x32x16_bf16 v[16:31], v[208:211], v[88:91], v[16:31]
    ds_read_b64_tr_b16 v[200:201], v10 offset:4096
    ds_read_b64_tr_b16 v[202:203], v10 offset:4352
    s_waitcnt lgkmcnt(6)
    v_mfma_f32_32x32x16_bf16 v[32:47], v[212:215], v[88:91], v[32:47]
    ds_read_b64_tr_b16 v[204:205], v11 offset:4096
    ds_read_b64_tr_b16 v[206:207], v11 offset:4352
    s_waitcnt lgkmcnt(6)
    v_mfma_f32_32x32x16_bf16 v[16:31], v[192:195], v[92:95], v[16:31]
    ds_read_b64_tr_b16 v[208:209], v10 offset:5120
    ds_read_b64_tr_b16 v[210:211], v10 offset:5376
    s_waitcnt lgkmcnt(6)
    v_mfma_f32_32x32x16_bf16 v[32:47], v[196:199], v[92:95], v[32:47]
    ds_read_b64_tr_b16 v[212:213], v11 offset:5120
    ds_read_b64_tr_b16 v[214:215], v11 offset:5376
    s_waitcnt lgkmcnt(6)
    v_mfma_f32_32x32x16_bf16 v[16:31], v[200:203], v[96:99], v[16:31]
    ds_read_b64_tr_b16 v[192:193], v10 offset:6144
    ds_read_b64_tr_b16 v[194:195], v10 offset:6400
    s_waitcnt lgkmcnt(6)
    v_mfma_f32_32x32x16_bf16 v[32:47], v[204:207], v[96:99], v[32:47]
    ds_read_b64_tr_b16 v[196:197], v11 offset:6144
    ds_read_b64_tr_b16 v[198:199], v11 offset:6400
    s_waitcnt vmcnt(63) lgkmcnt(6)
    v_mfma_f32_32x32x16_bf16 v[16:31], v[208:211], v[100:103], v[16:31]
    ds_read_b64_tr_b16 v[200:201], v10 offset:7168
    ds_read_b64_tr_b16 v[202:203], v10 offset:7424
    s_waitcnt lgkmcnt(6)
    v_mfma_f32_32x32x16_bf16 v[32:47], v[212:215], v[100:103], v[32:47]
    ds_read_b64_tr_b16 v[204:205], v11 offset:7168
    ds_read_b64_tr_b16 v[206:207], v11 offset:7424
    s_waitcnt lgkmcnt(6)
    v_mfma_f32_32x32x16_bf16 v[16:31], v[192:195], v[104:107], v[16:31]
    ds_read_b64_tr_b16 v[208:209], v10 offset:8192
    ds_read_b64_tr_b16 v[210:211], v10 offset:8448
    s_waitcnt lgkmcnt(6)
    v_mfma_f32_32x32x16_bf16 v[32:47], v[196:199], v[104:107], v[32:47]
    ds_read_b64_tr_b16 v[212:213], v11 offset:8192
    ds_read_b64_tr_b16 v[214:215], v11 offset:8448
    s_waitcnt lgkmcnt(6)
    v_mfma_f32_32x32x16_bf16 v[16:31], v[200:203], v[108:111], v[16:31]
    ds_read_b64_tr_b16 v[192:193], v10 offset:9216
    ds_read_b64_tr_b16 v[194:195], v10 offset:9472
    s_waitcnt lgkmcnt(6)
    v_mfma_f32_32x32x16_bf16 v[32:47], v[204:207], v[108:111], v[32:47]
    ds_read_b64_tr_b16 v[196:197], v11 offset:9216
    ds_read_b64_tr_b16 v[198:199], v11 offset:9472
    s_waitcnt lgkmcnt(6)
    v_mfma_f32_32x32x16_bf16 v[16:31], v[208:211], v[112:115], v[16:31]
    ds_read_b64_tr_b16 v[200:201], v10 offset:10240
    ds_read_b64_tr_b16 v[202:203], v10 offset:10496
    s_waitcnt lgkmcnt(6)
    v_mfma_f32_32x32x16_bf16 v[32:47], v[212:215], v[112:115], v[32:47]
    ds_read_b64_tr_b16 v[204:205], v11 offset:10240
    ds_read_b64_tr_b16 v[206:207], v11 offset:10496
    s_waitcnt lgkmcnt(6)
    v_mfma_f32_32x32x16_bf16 v[16:31], v[192:195], v[116:119], v[16:31]
    ds_read_b64_tr_b16 v[208:209], v10 offset:11264
    ds_read_b64_tr_b16 v[210:211], v10 offset:11520
    s_waitcnt lgkmcnt(6)
    v_mfma_f32_32x32x16_bf16 v[32:47], v[196:199], v[116:119], v[32:47]
    ds_read_b64_tr_b16 v[212:213], v11 offset:11264
    ds_read_b64_tr_b16 v[214:215], v11 offset:11520
    s_waitcnt lgkmcnt(6)
    v_mfma_f32_32x32x16_bf16 v[16:31], v[200:203], v[120:123], v[16:31]
    ds_read_b64_tr_b16 v[192:193], v10 offset:12288
    ds_read_b64_tr_b16 v[194:195], v10 offset:12544
    s_waitcnt lgkmcnt(6)
    v_mfma_f32_32x32x16_bf16 v[32:47], v[204:207], v[120:123], v[32:47]
    ds_read_b64_tr_b16 v[196:197], v11 offset:12288
    ds_read_b64_tr_b16 v[198:199], v11 offset:12544
    s_waitcnt lgkmcnt(6)
    v_mfma_f32_32x32x16_bf16 v[16:31], v[208:211], v[124:127], v[16:31]
    ds_read_b64_tr_b16 v[200:201], v10 offset:13312
    ds_read_b64_tr_b16 v[202:203], v10 offset:13568
    s_waitcnt lgkmcnt(6)
    v_mfma_f32_32x32x16_bf16 v[32:47], v[212:215], v[124:127], v[32:47]
    ds_read_b64_tr_b16 v[204:205], v11 offset:13312
    ds_read_b64_tr_b16 v[206:207], v11 offset:13568
    s_waitcnt lgkmcnt(6)
    v_mfma_f32_32x32x16_bf16 v[16:31], v[192:195], v[128:131], v[16:31]
    ds_read_b64_tr_b16 v[208:209], v10 offset:14336
    ds_read_b64_tr_b16 v[210:211], v10 offset:14592
    s_waitcnt lgkmcnt(6)
    v_mfma_f32_32x32x16_bf16 v[32:47], v[196:199], v[128:131], v[32:47]
    ds_read_b64_tr_b16 v[212:213], v11 offset:14336
    ds_read_b64_tr_b16 v[214:215], v11 offset:14592
    s_waitcnt lgkmcnt(6)
    v_mfma_f32_32x32x16_bf16 v[16:31], v[200:203], v[132:135], v[16:31]
    ds_read_b64_tr_b16 v[192:193], v10 offset:15360
    ds_read_b64_tr_b16 v[194:195], v10 offset:15616
    s_waitcnt lgkmcnt(6)
    v_mfma_f32_32x32x16_bf16 v[32:47], v[204:207], v[132:135], v[32:47]
    ds_read_b64_tr_b16 v[196:197], v11 offset:15360
    ds_read_b64_tr_b16 v[198:199], v11 offset:15616
    s_waitcnt lgkmcnt(6)
    v_mfma_f32_32x32x16_bf16 v[16:31], v[208:211], v[136:139], v[16:31]
    ds_read_b64_tr_b16 v[200:201], v10 offset:16384
    ds_read_b64_tr_b16 v[202:203], v10 offset:16640
    s_waitcnt lgkmcnt(6)
    v_mfma_f32_32x32x16_bf16 v[32:47], v[212:215], v[136:139], v[32:47]
    ds_read_b64_tr_b16 v[204:205], v11 offset:16384
    ds_read_b64_tr_b16 v[206:207], v11 offset:16640
    s_waitcnt vmcnt(59) lgkmcnt(6)
    v_mfma_f32_32x32x16_bf16 v[16:31], v[192:195], v[140:143], v[16:31]
    ds_read_b64_tr_b16 v[208:209], v10 offset:17408
    ds_read_b64_tr_b16 v[210:211], v10 offset:17664
    s_waitcnt lgkmcnt(6)
    v_mfma_f32_32x32x16_bf16 v[32:47], v[196:199], v[140:143], v[32:47]
    ds_read_b64_tr_b16 v[212:213], v11 offset:17408
    ds_read_b64_tr_b16 v[214:215], v11 offset:17664
    s_waitcnt vmcnt(55) lgkmcnt(6)
    v_mfma_f32_32x32x16_bf16 v[16:31], v[200:203], v[144:147], v[16:31]
    ds_read_b64_tr_b16 v[192:193], v10 offset:18432
    ds_read_b64_tr_b16 v[194:195], v10 offset:18688
    s_waitcnt lgkmcnt(6)
    v_mfma_f32_32x32x16_bf16 v[32:47], v[204:207], v[144:147], v[32:47]
    ds_read_b64_tr_b16 v[196:197], v11 offset:18432
    ds_read_b64_tr_b16 v[198:199], v11 offset:18688
    s_waitcnt vmcnt(51) lgkmcnt(6)
    v_mfma_f32_32x32x16_bf16 v[16:31], v[208:211], v[148:151], v[16:31]
    ds_read_b64_tr_b16 v[200:201], v10 offset:19456
    ds_read_b64_tr_b16 v[202:203], v10 offset:19712
    s_waitcnt lgkmcnt(6)
    v_mfma_f32_32x32x16_bf16 v[32:47], v[212:215], v[148:151], v[32:47]
    ds_read_b64_tr_b16 v[204:205], v11 offset:19456
    ds_read_b64_tr_b16 v[206:207], v11 offset:19712
    s_waitcnt vmcnt(47) lgkmcnt(6)
    v_mfma_f32_32x32x16_bf16 v[16:31], v[192:195], v[152:155], v[16:31]
    ds_read_b64_tr_b16 v[208:209], v10 offset:20480
    ds_read_b64_tr_b16 v[210:211], v10 offset:20736
    s_waitcnt lgkmcnt(6)
    v_mfma_f32_32x32x16_bf16 v[32:47], v[196:199], v[152:155], v[32:47]
    ds_read_b64_tr_b16 v[212:213], v11 offset:20480
    ds_read_b64_tr_b16 v[214:215], v11 offset:20736
    v_mov_b32 v216, 163784
    ds_read_b32 v217, v216
    s_waitcnt vmcnt(43) lgkmcnt(7)
    v_mfma_f32_32x32x16_bf16 v[16:31], v[200:203], v[156:159], v[16:31]
    ds_read_b64_tr_b16 v[192:193], v10 offset:21504
    ds_read_b64_tr_b16 v[194:195], v10 offset:21760
    s_waitcnt lgkmcnt(7)
    v_mfma_f32_32x32x16_bf16 v[32:47], v[204:207], v[156:159], v[32:47]
    ds_read_b64_tr_b16 v[196:197], v11 offset:21504
    ds_read_b64_tr_b16 v[198:199], v11 offset:21760
    s_waitcnt lgkmcnt(4)
    v_cmp_gt_u32 vcc, 8, v217
    s_cbranch_vccz L_pk_57
    v_mov_b32 v216, 163784
    s_mov_b32 s9, 400000
    s_waitcnt lgkmcnt(0)
L_cw_58:
    ds_read_b32 v217, v216
    s_waitcnt lgkmcnt(0)
    v_cmp_gt_u32 vcc, 8, v217
    s_cbranch_vccz L_cok_59
    s_sub_u32 s9, s9, 1
    s_cmp_lg_u32 s9, 0
    s_cbranch_scc1 L_cw_58
L_cok_59:
L_pk_57:
    ds_read_b64 v[240:241], v8 offset:0
    ds_read_b64 v[242:243], v8 offset:256
    ds_read_b64 v[244:245], v8 offset:512
    ds_read_b64 v[246:247], v8 offset:768
    s_waitcnt vmcnt(39)
    v_mfma_f32_32x32x16_bf16 v[16:31], v[208:211], v[160:163], v[16:31]
    ds_read_b64_tr_b16 v[200:201], v10 offset:22528
    ds_read_b64_tr_b16 v[202:203], v10 offset:22784
    v_mfma_f32_32x32x16_bf16 v[32:47], v[212:215], v[160:163], v[32:47]
    ds_read_b64_tr_b16 v[204:205], v11 offset:22528
    ds_read_b64_tr_b16 v[206:207], v11 offset:22784
    s_waitcnt vmcnt(10)
    v_xor_b32 v216, s8, v7
    v_cmp_ne_u32 vcc, 0, v216
    s_cbranch_vccz L_ok_60
    s_mov_b32 s9, 20000
L_spin_61:
    buffer_load_dwordx2 v[6:7], v9, s[52:55], 0 offen sc1
    s_waitcnt vmcnt(0)
    v_xor_b32 v216, s8, v7
    v_cmp_ne_u32 vcc, 0, v216
    s_cbranch_vccz L_out_62
    s_sleep 2
    s_sub_u32 s9, s9, 1
    s_cmp_lg_u32 s9, 0
    s_cbranch_scc1 L_spin_61
L_out_62:
L_ok_60:
    s_mov_b32 s12, 0x01000100
    s_mov_b32 s13, 0x03020302
    v_and_b32 v9, 0xffff0000, v6
    v_perm_b32 v4, v6, v6, s12
    v_rcp_f32 v216, v9
    v_perm_b32 v5, v6, v6, s13
    v_xor_b32 v4, 0x80008000, v4
    v_cmp_gt_u32 vcc, 32, v1
    v_mov_b32 v6, 0
    v_mov_b32 v7, 0
    v_mul_f32 v8, 0xbfb8aa3b, v216
    v_mul_f32 v9, v9, v9
    v_cndmask_b32 v4, 0, v4, vcc
    v_cndmask_b32 v5, 0, v5, vcc
    v_mov_b32 v248, 0
    v_mov_b32 v249, 0
    s_waitcnt lgkmcnt(10)
    v_mfma_f32_32x32x16_bf16 v[16:31], v[192:195], v[164:167], v[16:31]
    ds_read_b64_tr_b16 v[208:209], v10 offset:23552
    ds_read_b64_tr_b16 v[210:211], v10 offset:23808
    s_waitcnt lgkmcnt(10)
    v_mfma_f32_32x32x16_bf16 v[32:47], v[196:199], v[164:167], v[32:47]
    ds_read_b64_tr_b16 v[212:213], v11 offset:23552
    ds_read_b64_tr_b16 v[214:215], v11 offset:23808
    s_waitcnt lgkmcnt(6)
    v_mfma_f32_32x32x16_bf16 v[16:31], v[200:203], v[168:171], v[16:31]
    ds_read_b64_tr_b16 v[192:193], v10 offset:24576
    ds_read_b64_tr_b16 v[194:195], v10 offset:24832
    s_waitcnt lgkmcnt(6)
    v_mfma_f32_32x32x16_bf16 v[32:47], v[204:207], v[168:171], v[32:47]
    ds_read_b64_tr_b16 v[196:197], v11 offset:24576
    ds_read_b64_tr_b16 v[198:199], v11 offset:24832
    s_waitcnt lgkmcnt(6)
    v_mfma_f32_32x32x16_bf16 v[16:31], v[208:211], v[172:175], v[16:31]
    ds_read_b64_tr_b16 v[200:201], v10 offset:25600
    ds_read_b64_tr_b16 v[202:203], v10 offset:25856
    s_waitcnt lgkmcnt(6)
    v_mfma_f32_32x32x16_bf16 v[32:47], v[212:215], v[172:175], v[32:47]
    ds_read_b64_tr_b16 v[204:205], v11 offset:25600
    ds_read_b64_tr_b16 v[206:207], v11 offset:25856
    s_waitcnt lgkmcnt(6)
    v_mfma_f32_32x32x16_bf16 v[16:31], v[192:195], v[176:179], v[16:31]
    ds_read_b64_tr_b16 v[208:209], v10 offset:26624
    ds_read_b64_tr_b16 v[210:211], v10 offset:26880
    s_waitcnt lgkmcnt(6)
    v_mfma_f32_32x32x16_bf16 v[32:47], v[196:199], v[176:179], v[32:47]
    ds_read_b64_tr_b16 v[212:213], v11 offset:26624
    ds_read_b64_tr_b16 v[214:215], v11 offset:26880
    s_waitcnt lgkmcnt(6)
    v_mfma_f32_32x32x16_bf16 v[16:31], v[200:203], v[180:183], v[16:31]
    ds_read_b64_tr_b16 v[192:193], v10 offset:27648
    ds_read_b64_tr_b16 v[194:195], v10 offset:27904
    s_waitcnt lgkmcnt(6)
    v_mfma_f32_32x32x16_bf16 v[32:47], v[204:207], v[180:183], v[32:47]
    ds_read_b64_tr_b16 v[196:197], v11 offset:27648
    ds_read_b64_tr_b16 v[198:199], v11 offset:27904
    s_waitcnt lgkmcnt(6)
    v_mfma_f32_32x32x16_bf16 v[16:31], v[208:211], v[184:187], v[16:31]
    ds_read_b64_tr_b16 v[200:201], v12 offset:0
    ds_read_b64_tr_b16 v[202:203], v12 offset:256
    s_waitcnt lgkmcnt(6)
    v_mfma_f32_32x32x16_bf16 v[32:47], v[212:215], v[184:187], v[32:47]
    ds_read_b64_tr_b16 v[204:205], v13 offset:0
    ds_read_b64_tr_b16 v[206:207], v13 offset:256
    s_waitcnt lgkmcnt(6)
    v_mfma_f32_32x32x16_bf16 v[16:31], v[192:195], v[188:191], v[16:31]
    ds_read_b64_tr_b16 v[208:209], v12 offset:1024
    ds_read_b64_tr_b16 v[210:211], v12 offset:1280
    s_waitcnt lgkmcnt(6)
    v_mfma_f32_32x32x16_bf16 v[32:47], v[196:199], v[188:191], v[32:47]
    ds_read_b64_tr_b16 v[212:213], v13 offset:1024
    ds_read_b64_tr_b16 v[214:215], v13 offset:1280
    v_mfma_f32_32x32x16_bf16 v[16:31], v[240:243], v[4:7], v[16:31]
    v_mfma_f32_32x32x16_bf16 v[32:47], v[242:245], v[4:7], v[32:47]
    s_waitcnt lgkmcnt(6)
    v_mfma_f32_32x32x16_bf16 v[48:63], v[200:203], v[80:83], 0
    ds_read_b64_tr_b16 v[192:193], v12 offset:2048
    ds_read_b64_tr_b16 v[194:195], v12 offset:2304
    s_waitcnt lgkmcnt(6)
    v_mfma_f32_32x32x16_bf16 v[64:79], v[204:207], v[80:83], 0
    ds_read_b64_tr_b16 v[196:197], v13 offset:2048
    ds_read_b64_tr_b16 v[198:199], v13 offset:2304
    s_waitcnt vmcnt(0)
    v_mov_b32 v216, 163788
    v_mov_b32 v217, 1
    s_mov_b64 exec, 1
    ds_add_u32 v216, v217
    s_mov_b64 exec, -1
    s_waitcnt lgkmcnt(7)
    v_mfma_f32_32x32x16_bf16 v[48:63], v[208:211], v[84:87], v[48:63]
    ds_read_b64_tr_b16 v[200:201], v12 offset:3072
    ds_read_b64_tr_b16 v[202:203], v12 offset:3328
    s_waitcnt lgkmcnt(7)
    v_mfma_f32_32x32x16_bf16 v[64:79], v[212:215], v[84:87], v[64:79]
    ds_read_b64_tr_b16 v[204:205], v13 offset:3072
    ds_read_b64_tr_b16 v[206:207], v13 offset:3328
    s_waitcnt lgkmcnt(7)
    v_mfma_f32_32x32x16_bf16 v[48:63], v[192:195], v[88:91], v[48:63]
    ds_read_b64_tr_b16 v[208:209], v12 offset:4096
    ds_read_b64_tr_b16 v[210:211], v12 offset:4352
    v_mul_f32 v216, v8, v16
    v_mul_f32 v217, v8, v17
    s_waitcnt lgkmcnt(7)
    v_mfma_f32_32x32x16_bf16 v[64:79], v[196:199], v[88:91], v[64:79]
    ds_read_b64_tr_b16 v[212:213], v13 offset:4096
    ds_read_b64_tr_b16 v[214:215], v13 offset:4352
    v_mul_f32 v218, v8, v18
    v_mul_f32 v219, v8, v19
    s_waitcnt lgkmcnt(6)
    v_mfma_f32_32x32x16_bf16 v[48:63], v[200:203], v[92:95], v[48:63]
    ds_read_b64_tr_b16 v[192:193], v12 offset:5120
    ds_read_b64_tr_b16 v[194:195], v12 offset:5376
    v_mul_f32 v220, v8, v20
    v_mul_f32 v221, v8, v21
    v_mul_f32 v222, v8, v22
    s_waitcnt lgkmcnt(6)
    v_mfma_f32_32x32x16_bf16 v[64:79], v[204:207], v[92:95], v[64:79]
    ds_read_b64_tr_b16 v[196:197], v13 offset:5120
    ds_read_b64_tr_b16 v[198:199], v13 offset:5376
    v_mul_f32 v223, v8, v23
    v_exp_f32 v216, v216
    s_waitcnt lgkmcnt(6)
    v_mfma_f32_32x32x16_bf16 v[48:63], v[208:211], v[96:99], v[48:63]
    ds_read_b64_tr_b16 v[200:201], v12 offset:6144
    ds_read_b64_tr_b16 v[202:203], v12 offset:6400
    v_mul_f32 v16, v16, v24
    v_exp_f32 v217, v217
    s_waitcnt lgkmcnt(6)
    v_mfma_f32_32x32x16_bf16 v[64:79], v[212:215], v[96:99], v[64:79]
    ds_read_b64_tr_b16 v[204:205], v13 offset:6144
    ds_read_b64_tr_b16 v[206:207], v13 offset:6400
    v_mul_f32 v17, v17, v25
    v_exp_f32 v218, v218
    v_mul_f32 v18, v18, v26
    s_waitcnt lgkmcnt(6)
    v_mfma_f32_32x32x16_bf16 v[48:63], v[192:195], v[100:103], v[48:63]
    ds_read_b64_tr_b16 v[208:209], v12 offset:7168
    ds_read_b64_tr_b16 v[210:211], v12 offset:7424
    v_exp_f32 v219, v219
    v_mul_f32 v19, v19, v27
    s_waitcnt lgkmcnt(6)
    v_mfma_f32_32x32x16_bf16 v[64:79], v[196:199], v[100:103], v[64:79]
    ds_read_b64_tr_b16 v[212:213], v13 offset:7168
    ds_read_b64_tr_b16 v[214:215], v13 offset:7424
    v_exp_f32 v220, v220
    v_mul_f32 v20, v20, v28
    s_waitcnt lgkmcnt(6)
    v_mfma_f32_32x32x16_bf16 v[48:63], v[200:203], v[104:107], v[48:63]
    ds_read_b64_tr_b16 v[192:193], v12 offset:8192
    ds_read_b64_tr_b16 v[194:195], v12 offset:8448
    v_exp_f32 v221, v221
    v_mul_f32 v21, v21, v29
    v_exp_f32 v222, v222
    s_waitcnt lgkmcnt(6)
    v_mfma_f32_32x32x16_bf16 v[64:79], v[204:207], v[104:107], v[64:79]
    ds_read_b64_tr_b16 v[196:197], v13 offset:8192
    ds_read_b64_tr_b16 v[198:199], v13 offset:8448
    v_mul_f32 v22, v22, v30
    v_exp_f32 v223, v223
    s_waitcnt lgkmcnt(6)
    v_mfma_f32_32x32x16_bf16 v[48:63], v[208:211], v[108:111], v[48:63]
    ds_read_b64_tr_b16 v[200:201], v12 offset:9216
    ds_read_b64_tr_b16 v[202:203], v12 offset:9472
    v_mul_f32 v23, v23, v31
    v_fma_f32 v216, v216, v9, v9
    v_fma_f32 v217, v217, v9, v9
    s_waitcnt lgkmcnt(6)
    v_mfma_f32_32x32x16_bf16 v[64:79], v[212:215], v[108:111], v[64:79]
    ds_read_b64_tr_b16 v[204:205], v13 offset:9216
    ds_read_b64_tr_b16 v[206:207], v13 offset:9472
    v_fma_f32 v218, v218, v9, v9
    v_fma_f32 v219, v219, v9, v9
    s_waitcnt lgkmcnt(6)
    v_mfma_f32_32x32x16_bf16 v[48:63], v[192:195], v[112:115], v[48:63]
    ds_read_b64_tr_b16 v[208:209], v12 offset:10240
    ds_read_b64_tr_b16 v[210:211], v12 offset:10496
    v_fma_f32 v220, v220, v9, v9
    v_fma_f32 v221, v221, v9, v9
    s_waitcnt lgkmcnt(6)
    s_branch L_pg7
.p2align 12
L_stub7:
    s_setpc_b64 s[100:101]
    s_nop 0
L_pg7:
    v_mfma_f32_32x32x16_bf16 v[64:79], v[196:199], v[112:115], v[64:79]
    ds_read_b64_tr_b16 v[212:213], v13 offset:10240
    ds_read_b64_tr_b16 v[214:215], v13 offset:10496
    v_fma_f32 v222, v222, v9, v9
    v_fma_f32 v223, v223, v9, v9
    v_rcp_f32 v216, v216
    s_waitcnt lgkmcnt(6)
    v_mfma_f32_32x32x16_bf16 v[48:63], v[200:203], v[116:119], v[48:63]
    ds_read_b64_tr_b16 v[192:193], v12 offset:11264
    ds_read_b64_tr_b16 v[194:195], v12 offset:11520
    v_rcp_f32 v217, v217
    v_rcp_f32 v218, v218
    s_waitcnt lgkmcnt(6)
    v_mfma_f32_32x32x16_bf16 v[64:79], v[204:207], v[116:119], v[64:79]
    ds_read_b64_tr_b16 v[196:197], v13 offset:11264
    ds_read_b64_tr_b16 v[198:199], v13 offset:11520
    v_rcp_f32 v219, v219
    v_rcp_f32 v220, v220
    s_waitcnt lgkmcnt(6)
    v_mfma_f32_32x32x16_bf16 v[48:63], v[208:211], v[120:123], v[48:63]
    ds_read_b64_tr_b16 v[200:201], v12 offset:12288
    ds_read_b64_tr_b16 v[202:203], v12 offset:12544
    v_rcp_f32 v221, v221
    v_rcp_f32 v222, v222
    v_rcp_f32 v223, v223
    s_waitcnt lgkmcnt(6)
    v_mfma_f32_32x32x16_bf16 v[64:79], v[212:215], v[120:123], v[64:79]
    ds_read_b64_tr_b16 v[204:205], v13 offset:12288
    ds_read_b64_tr_b16 v[206:207], v13 offset:12544
    v_mul_f32 v16, v16, v216
    v_mul_f32 v17, v17, v217
    s_waitcnt lgkmcnt(6)
    v_mfma_f32_32x32x16_bf16 v[48:63], v[192:195], v[124:127], v[48:63]
    ds_read_b64_tr_b16 v[208:209], v12 offset:13312
    ds_read_b64_tr_b16 v[210:211], v12 offset:13568
    v_mul_f32 v18, v18, v218
    v_mul_f32 v19, v19, v219
    s_waitcnt lgkmcnt(6)
    v_mfma_f32_32x32x16_bf16 v[64:79], v[196:199], v[124:127], v[64:79]
    ds_read_b64_tr_b16 v[212:213], v13 offset:13312
    ds_read_b64_tr_b16 v[214:215], v13 offset:13568
    v_mul_f32 v20, v20, v220
    v_mul_f32 v21, v21, v221
    v_mul_f32 v22, v22, v222
    s_waitcnt lgkmcnt(6)
    v_mfma_f32_32x32x16_bf16 v[48:63], v[200:203], v[128:131], v[48:63]
    ds_read_b64_tr_b16 v[192:193], v12 offset:14336
    ds_read_b64_tr_b16 v[194:195], v12 offset:14592
    v_mul_f32 v23, v23, v223
    v_cvt_pk_bf16_f32 v224, v16, v17
    s_waitcnt lgkmcnt(6)
    v_mfma_f32_32x32x16_bf16 v[64:79], v[204:207], v[128:131], v[64:79]
    ds_read_b64_tr_b16 v[196:197], v13 offset:14336
    ds_read_b64_tr_b16 v[198:199], v13 offset:14592
    v_cvt_pk_bf16_f32 v225, v18, v19
    v_cvt_pk_bf16_f32 v226, v20, v21
    v_cvt_pk_bf16_f32 v227, v22, v23
    s_waitcnt lgkmcnt(6)
    v_mfma_f32_32x32x16_bf16 v[48:63], v[208:211], v[132:135], v[48:63]
    ds_read_b64_tr_b16 v[200:201], v12 offset:15360
    ds_read_b64_tr_b16 v[202:203], v12 offset:15616
    v_mul_f32 v216, v8, v32
    v_mul_f32 v217, v8, v33
    s_waitcnt lgkmcnt(6)
    v_mfma_f32_32x32x16_bf16 v[64:79], v[212:215], v[132:135], v[64:79]
    ds_read_b64_tr_b16 v[204:205], v13 offset:15360
    ds_read_b64_tr_b16 v[206:207], v13 offset:15616
    v_mul_f32 v218, v8, v34
    v_mul_f32 v219, v8, v35
    s_waitcnt lgkmcnt(6)
    v_mfma_f32_32x32x16_bf16 v[48:63], v[192:195], v[136:139], v[48:63]
    ds_read_b64_tr_b16 v[208:209], v12 offset:16384
    ds_read_b64_tr_b16 v[210:211], v12 offset:16640
    v_mul_f32 v220, v8, v36
    v_mul_f32 v221, v8, v37
    v_mul_f32 v222, v8, v38
    s_waitcnt lgkmcnt(6)
    v_mfma_f32_32x32x16_bf16 v[64:79], v[196:199], v[136:139], v[64:79]
    ds_read_b64_tr_b16 v[212:213], v13 offset:16384
    ds_read_b64_tr_b16 v[214:215], v13 offset:16640
    v_mul_f32 v223, v8, v39
    v_exp_f32 v216, v216
    s_waitcnt lgkmcnt(6)
    v_mfma_f32_32x32x16_bf16 v[48:63], v[200:203], v[140:143], v[48:63]
    ds_read_b64_tr_b16 v[192:193], v12 offset:17408
    ds_read_b64_tr_b16 v[194:195], v12 offset:17664
    v_mul_f32 v32, v32, v40
    v_exp_f32 v217, v217
    s_waitcnt lgkmcnt(6)
    v_mfma_f32_32x32x16_bf16 v[64:79], v[204:207], v[140:143], v[64:79]
    ds_read_b64_tr_b16 v[196:197], v13 offset:17408
    ds_read_b64_tr_b16 v[198:199], v13 offset:17664
    v_mul_f32 v33, v33, v41
    v_exp_f32 v218, v218
    v_mul_f32 v34, v34, v42
    s_waitcnt lgkmcnt(6)
    v_mfma_f32_32x32x16_bf16 v[48:63], v[208:211], v[144:147], v[48:63]
    ds_read_b64_tr_b16 v[200:201], v12 offset:18432
    ds_read_b64_tr_b16 v[202:203], v12 offset:18688
    v_exp_f32 v219, v219
    v_mul_f32 v35, v35, v43
    s_waitcnt lgkmcnt(6)
    v_mfma_f32_32x32x16_bf16 v[64:79], v[212:215], v[144:147], v[64:79]
    ds_read_b64_tr_b16 v[204:205], v13 offset:18432
    ds_read_b64_tr_b16 v[206:207], v13 offset:18688
    v_exp_f32 v220, v220
    v_mul_f32 v36, v36, v44
    s_waitcnt lgkmcnt(6)
    v_mfma_f32_32x32x16_bf16 v[48:63], v[192:195], v[148:151], v[48:63]
    ds_read_b64_tr_b16 v[208:209], v12 offset:19456
    ds_read_b64_tr_b16 v[210:211], v12 offset:19712
    v_exp_f32 v221, v221
    v_mul_f32 v37, v37, v45
    v_exp_f32 v222, v222
    s_waitcnt lgkmcnt(6)
    v_mfma_f32_32x32x16_bf16 v[64:79], v[196:199], v[148:151], v[64:79]
    ds_read_b64_tr_b16 v[212:213], v13 offset:19456
    ds_read_b64_tr_b16 v[214:215], v13 offset:19712
    v_mul_f32 v38, v38, v46
    v_exp_f32 v223, v223
    s_waitcnt lgkmcnt(6)
    v_mfma_f32_32x32x16_bf16 v[48:63], v[200:203], v[152:155], v[48:63]
    ds_read_b64_tr_b16 v[192:193], v12 offset:20480
    ds_read_b64_tr_b16 v[194:195], v12 offset:20736
    v_mul_f32 v39, v39, v47
    v_fma_f32 v216, v216, v9, v9
    v_fma_f32 v217, v217, v9, v9
    s_waitcnt lgkmcnt(6)
    v_mfma_f32_32x32x16_bf16 v[64:79], v[204:207], v[152:155], v[64:79]
    ds_read_b64_tr_b16 v[196:197], v13 offset:20480
    ds_read_b64_tr_b16 v[198:199], v13 offset:20736
    v_fma_f32 v218, v218, v9, v9
    v_fma_f32 v219, v219, v9, v9
    s_waitcnt lgkmcnt(6)
    v_mfma_f32_32x32x16_bf16 v[48:63], v[208:211], v[156:159], v[48:63]
    ds_read_b64_tr_b16 v[200:201], v12 offset:21504
    ds_read_b64_tr_b16 v[202:203], v12 offset:21760
    v_fma_f32 v220, v220, v9, v9
    v_fma_f32 v221, v221, v9, v9
    s_waitcnt lgkmcnt(6)
    v_mfma_f32_32x32x16_bf16 v[64:79], v[212:215], v[156:159], v[64:79]
    ds_read_b64_tr_b16 v[204:205], v13 offset:21504
    ds_read_b64_tr_b16 v[206:207], v13 offset:21760
    v_fma_f32 v222, v222, v9, v9
    v_fma_f32 v223, v223, v9, v9
    v_rcp_f32 v216, v216
    s_waitcnt lgkmcnt(6)
    v_mfma_f32_32x32x16_bf16 v[48:63], v[192:195], v[160:163], v[48:63]
    ds_read_b64_tr_b16 v[208:209], v12 offset:22528
    ds_read_b64_tr_b16 v[210:211], v12 offset:22784
    v_rcp_f32 v217, v217
    v_rcp_f32 v218, v218
    s_waitcnt lgkmcnt(6)
    v_mfma_f32_32x32x16_bf16 v[64:79], v[196:199], v[160:163], v[64:79]
    ds_read_b64_tr_b16 v[212:213], v13 offset:22528
    ds_read_b64_tr_b16 v[214:215], v13 offset:22784
    v_rcp_f32 v219, v219
    v_rcp_f32 v220, v220
    s_waitcnt lgkmcnt(6)
    v_mfma_f32_32x32x16_bf16 v[48:63], v[200:203], v[164:167], v[48:63]
    ds_read_b64_tr_b16 v[192:193], v12 offset:23552
    ds_read_b64_tr_b16 v[194:195], v12 offset:23808
    v_rcp_f32 v221, v221
    v_rcp_f32 v222, v222
    v_rcp_f32 v223, v223
    s_waitcnt lgkmcnt(6)
    v_mfma_f32_32x32x16_bf16 v[64:79], v[204:207], v[164:167], v[64:79]
    ds_read_b64_tr_b16 v[196:197], v13 offset:23552
    ds_read_b64_tr_b16 v[198:199], v13 offset:23808
    v_mul_f32 v32, v32, v216
    v_mul_f32 v33, v33, v217
    s_waitcnt lgkmcnt(6)
    v_mfma_f32_32x32x16_bf16 v[48:63], v[208:211], v[168:171], v[48:63]
    ds_read_b64_tr_b16 v[200:201], v12 offset:24576
    ds_read_b64_tr_b16 v[202:203], v12 offset:24832
    v_mul_f32 v34, v34, v218
    v_mul_f32 v35, v35, v219
    s_waitcnt lgkmcnt(6)
    v_mfma_f32_32x32x16_bf16 v[64:79], v[212:215], v[168:171], v[64:79]
    ds_read_b64_tr_b16 v[204:205], v13 offset:24576
    ds_read_b64_tr_b16 v[206:207], v13 offset:24832
    v_mul_f32 v36, v36, v220
    v_mul_f32 v37, v37, v221
    v_mul_f32 v38, v38, v222
    s_waitcnt lgkmcnt(6)
    v_mfma_f32_32x32x16_bf16 v[48:63], v[192:195], v[172:175], v[48:63]
    ds_read_b64_tr_b16 v[208:209], v12 offset:25600
    ds_read_b64_tr_b16 v[210:211], v12 offset:25856
    v_mul_f32 v39, v39, v223
    v_cvt_pk_bf16_f32 v228, v32, v33
    s_waitcnt lgkmcnt(6)
    v_mfma_f32_32x32x16_bf16 v[64:79], v[196:199], v[172:175], v[64:79]
    ds_read_b64_tr_b16 v[212:213], v13 offset:25600
    ds_read_b64_tr_b16 v[214:215], v13 offset:25856
    v_cvt_pk_bf16_f32 v229, v34, v35
    v_cvt_pk_bf16_f32 v230, v36, v37
    v_cvt_pk_bf16_f32 v231, v38, v39
    s_waitcnt lgkmcnt(6)
    v_mfma_f32_32x32x16_bf16 v[48:63], v[200:203], v[176:179], v[48:63]
    ds_read_b64_tr_b16 v[192:193], v12 offset:26624
    ds_read_b64_tr_b16 v[194:195], v12 offset:26880
    s_waitcnt lgkmcnt(6)
    v_mfma_f32_32x32x16_bf16 v[64:79], v[204:207], v[176:179], v[64:79]
    ds_read_b64_tr_b16 v[196:197], v13 offset:26624
    ds_read_b64_tr_b16 v[198:199], v13 offset:26880
    s_waitcnt lgkmcnt(6)
    v_mfma_f32_32x32x16_bf16 v[48:63], v[208:211], v[180:183], v[48:63]
    ds_read_b64_tr_b16 v[200:201], v12 offset:27648
    ds_read_b64_tr_b16 v[202:203], v12 offset:27904
    s_waitcnt lgkmcnt(6)
    v_mfma_f32_32x32x16_bf16 v[64:79], v[212:215], v[180:183], v[64:79]
    ds_read_b64_tr_b16 v[204:205], v13 offset:27648
    ds_read_b64_tr_b16 v[206:207], v13 offset:27904
    s_waitcnt lgkmcnt(6)
    v_mfma_f32_32x32x16_bf16 v[48:63], v[192:195], v[184:187], v[48:63]
    s_waitcnt lgkmcnt(4)
    v_mfma_f32_32x32x16_bf16 v[64:79], v[196:199], v[184:187], v[64:79]
    s_waitcnt lgkmcnt(2)
    v_mfma_f32_32x32x16_bf16 v[48:63], v[200:203], v[188:191], v[48:63]
    s_waitcnt lgkmcnt(0)
    v_mfma_f32_32x32x16_bf16 v[64:79], v[204:207], v[188:191], v[64:79]
    v_mfma_f32_32x32x16_bf16 v[48:63], v[244:247], v[4:7], v[48:63]
    v_mfma_f32_32x32x16_bf16 v[64:79], v[246:249], v[4:7], v[64:79]
    v_mov_b32 v216, 163776
    v_mov_b32 v217, 1
    s_mov_b64 exec, 1
    ds_add_u32 v216, v217
    s_mov_b64 exec, -1
    s_nop 5
    v_mul_f32 v216, v8, v48
    v_mul_f32 v217, v8, v49
    v_mul_f32 v218, v8, v50
    v_mul_f32 v219, v8, v51
    v_mul_f32 v220, v8, v52
    v_mul_f32 v221, v8, v53
    v_mul_f32 v222, v8, v54
    v_mul_f32 v223, v8, v55
    v_exp_f32 v216, v216
    v_mul_f32 v48, v48, v56
    v_exp_f32 v217, v217
    v_mul_f32 v49, v49, v57
    v_exp_f32 v218, v218
    v_mul_f32 v50, v50, v58
    v_exp_f32 v219, v219
    v_mul_f32 v51, v51, v59
    v_exp_f32 v220, v220
    v_mul_f32 v52, v52, v60
    v_exp_f32 v221, v221
    v_mul_f32 v53, v53, v61
    v_exp_f32 v222, v222
    v_mul_f32 v54, v54, v62
    v_exp_f32 v223, v223
    v_mul_f32 v55, v55, v63
    v_fma_f32 v216, v216, v9, v9
    v_fma_f32 v217, v217, v9, v9
    v_fma_f32 v218, v218, v9, v9
    v_fma_f32 v219, v219, v9, v9
    v_fma_f32 v220, v220, v9, v9
    v_fma_f32 v221, v221, v9, v9
    v_fma_f32 v222, v222, v9, v9
    v_fma_f32 v223, v223, v9, v9
    v_rcp_f32 v216, v216
    v_rcp_f32 v217, v217
    v_rcp_f32 v218, v218
    v_rcp_f32 v219, v219
    v_rcp_f32 v220, v220
    v_rcp_f32 v221, v221
    v_rcp_f32 v222, v222
    v_rcp_f32 v223, v223
    v_mul_f32 v48, v48, v216
    v_mul_f32 v49, v49, v217
    v_mul_f32 v50, v50, v218
    v_mul_f32 v51, v51, v219
    v_mul_f32 v52, v52, v220
    v_mul_f32 v53, v53, v221
    v_mul_f32 v54, v54, v222
    v_mul_f32 v55, v55, v223
    v_cvt_pk_bf16_f32 v232, v48, v49
    v_cvt_pk_bf16_f32 v233, v50, v51
    v_cvt_pk_bf16_f32 v234, v52, v53
    v_cvt_pk_bf16_f32 v235, v54, v55
    v_mul_f32 v216, v8, v64
    v_mul_f32 v217, v8, v65
    v_mul_f32 v218, v8, v66
    v_mul_f32 v219, v8, v67
    v_mul_f32 v220, v8, v68
    v_mul_f32 v221, v8, v69
    v_mul_f32 v222, v8, v70
    v_mul_f32 v223, v8, v71
    v_exp_f32 v216, v216
    v_mul_f32 v64, v64, v72
    v_exp_f32 v217, v217
    v_mul_f32 v65, v65, v73
    v_exp_f32 v218, v218
    v_mul_f32 v66, v66, v74
    v_exp_f32 v219, v219
    v_mul_f32 v67, v67, v75
    v_exp_f32 v220, v220
    v_mul_f32 v68, v68, v76
    v_exp_f32 v221, v221
    v_mul_f32 v69, v69, v77
    v_exp_f32 v222, v222
    v_mul_f32 v70, v70, v78
    v_exp_f32 v223, v223
    v_mul_f32 v71, v71, v79
    v_fma_f32 v216, v216, v9, v9
    v_fma_f32 v217, v217, v9, v9
    v_fma_f32 v218, v218, v9, v9
    v_fma_f32 v219, v219, v9, v9
    v_fma_f32 v220, v220, v9, v9
    v_fma_f32 v221, v221, v9, v9
    v_fma_f32 v222, v222, v9, v9
    v_fma_f32 v223, v223, v9, v9
    v_rcp_f32 v216, v216
    v_rcp_f32 v217, v217
    v_rcp_f32 v218, v218
    v_rcp_f32 v219, v219
    v_rcp_f32 v220, v220
    v_rcp_f32 v221, v221
    v_rcp_f32 v222, v222
    v_rcp_f32 v223, v223
    v_mul_f32 v64, v64, v216
    v_mul_f32 v65, v65, v217
    v_mul_f32 v66, v66, v218
    v_mul_f32 v67, v67, v219
    v_mul_f32 v68, v68, v220
    v_mul_f32 v69, v69, v221
    v_mul_f32 v70, v70, v222
    v_mul_f32 v71, v71, v223
    v_cvt_pk_bf16_f32 v236, v64, v65
    v_cvt_pk_bf16_f32 v237, v66, v67
    v_cvt_pk_bf16_f32 v238, v68, v69
    v_cvt_pk_bf16_f32 v239, v70, v71
    buffer_store_dwordx4 v[224:227], v15, s[52:55], s72 offen offset:0 sc1
    buffer_store_dwordx4 v[228:231], v15, s[52:55], s72 offen offset:1024 sc1
    buffer_store_dwordx4 v[232:235], v15, s[52:55], s72 offen offset:2048 sc1
    buffer_store_dwordx4 v[236:239], v15, s[52:55], s72 offen offset:3072 sc1
    v_add_u32 v7, 458752, v15
    s_cmp_eq_u32 s69, 0
    s_cselect_b32 s12, 7, 0
    s_sub_u32 s12, s12, 1
    s_mul_i32 s12, s12, 57344
    s_add_u32 s34, s34, s12
    v_add_u32 v12, s34, v15
    s_lshl_b32 s38, s3, 13
    s_add_u32 s38, s38, 57344
    v_mov_b32 v13, 163788
    s_mov_b32 s9, 400000
    s_waitcnt lgkmcnt(0)
L_cw_63:
    ds_read_b32 v14, v13
    s_waitcnt lgkmcnt(0)
    v_cmp_gt_u32 vcc, 12, v14
    s_cbranch_vccz L_cok_64
    s_sub_u32 s9, s9, 1
    s_cmp_lg_u32 s9, 0
    s_cbranch_scc1 L_cw_63
L_cok_64:
    v_add_u32 v10, s35, v15
    v_add_u32 v11, s36, v15
    ds_read_b128 v[80:83], v10 offset:0
    ds_read_b128 v[84:87], v10 offset:1024
    ds_read_b128 v[88:91], v10 offset:2048
    ds_read_b128 v[92:95], v10 offset:3072
    ds_read_b128 v[96:99], v10 offset:4096
    ds_read_b128 v[100:103], v10 offset:5120
    ds_read_b128 v[104:107], v10 offset:6144
    ds_read_b128 v[108:111], v10 offset:7168
    ds_read_b128 v[112:115], v10 offset:8192
    ds_read_b128 v[116:119], v10 offset:9216
    ds_read_b128 v[120:123], v11 offset:12288
    ds_read_b128 v[124:127], v11 offset:13312
    ds_read_b128 v[128:131], v11 offset:0
    ds_read_b128 v[132:135], v11 offset:1024
    ds_read_b128 v[136:139], v11 offset:2048
    ds_read_b128 v[140:143], v11 offset:3072
    ds_read_b128 v[144:147], v11 offset:4096
    ds_read_b128 v[148:151], v11 offset:5120
    ds_read_b128 v[152:155], v11 offset:6144
    ds_read_b128 v[156:159], v11 offset:7168
    ds_read_b128 v[160:163], v11 offset:8192
    ds_read_b128 v[164:167], v11 offset:9216
    ds_read_b128 v[168:171], v11 offset:10240
    ds_read_b128 v[172:175], v11 offset:11264
    v_mov_b32 v13, 163776
    v_mov_b32 v14, 1
    s_mov_b64 exec, 1
    ds_add_u32 v13, v14
    s_mov_b64 exec, -1
    s_waitcnt vmcnt(0)
    s_atomic_swap s8, s[50:51], s73
    s_add_u32 s39, s73, 16384
    s_atomic_swap s8, s[50:51], s39
    s_setprio 0
    buffer_load_dwordx4 v[176:179], v12, s[52:55], 0 offen offset:0 sc1
    buffer_load_dwordx4 v[180:183], v12, s[52:55], 0 offen offset:1024 sc1
    buffer_load_dwordx4 v[184:187], v12, s[52:55], 0 offen offset:2048 sc1
    buffer_load_dwordx4 v[188:191], v12, s[52:55], 0 offen offset:3072 sc1
    s_lshl_b32 s14, s64, 2
    s_add_u32 s14, s14, s3
    s_mul_i32 s12, s5, 229376
    s_lshl_b32 s13, s65, 15
    s_add_u32 s12, s12, s13
    s_lshl_b32 s13, s14, 5
    s_add_u32 s12, s12, s13
    s_add_u32 s12, s12, 5242880
    v_lshrrev_b32 v4, 1, v1
    v_lshlrev_b32 v4, 10, v4
    v_and_b32 v5, 1, v1
    v_lshl_add_u32 v4, v5, 4, v4
    v_add_u32 v4, s12, v4
    s_lshl_b32 s12, s65, 9
    s_add_u32 s12, s12, 4277760
    v_lshl_add_u32 v5, v1, 3, s12
    v_lshrrev_b32 v9, 3, v1
    v_and_b32 v8, 7, v1
    buffer_load_dwordx4 v[208:211], v4, s[52:55], 0 offen offset:0 sc1
    buffer_load_dwordx4 v[212:215], v4, s[52:55], 0 offen offset:512 sc1
    buffer_load_dwordx2 v[72:73], v5, s[52:55], 0 offen sc1
    s_mov_b32 s60, s46
    s_mov_b32 s61, s47
    s_mov_b32 s62, 1835008
    s_mov_b32 s63, 0x00020000
    s_mul_i32 s12, s3, 2816
    s_add_u32 s12, s12, 90112
    v_lshl_add_u32 v74, v9, 4, v15
    v_add_u32 v74, s12, v74
    v_lshl_add_u32 v75, v1, 2, s12
    v_mul_u32_u24 v76, 144, v8
    v_lshl_add_u32 v76, v9, 2, v76
    v_add_u32 v76, s12, v76
    v_add_u32 v78, 1280, v76
    v_lshl_add_u32 v77, v8, 5, s12
    s_lshl_b32 s12, s5, 5
    s_add_u32 s12, s12, s14
    s_mul_i32 s12, s12, 7168
    s_lshl_b32 s13, s65, 7
    s_add_u32 s66, s12, s13
    s_add_u32 s67, s66, 114688
    v_mul_u32_u24 v4, 896, v9
    v_lshl_add_u32 v4, v8, 4, v4
    s_lshl_b32 s12, s3, 3
    v_add_u32 v9, s12, v9
    v_lshlrev_b32 v6, 1, v8
    v_xor_b32 v9, v9, v6
    v_lshlrev_b32 v9, 4, v9
    v_and_b32 v6, 1, v8
    v_lshl_add_u32 v9, v6, 9, v9
    v_lshrrev_b32 v8, 1, v8
    v_lshl_add_u32 v8, v8, 11, v9
    v_add_u32 v9, 114688, v8
    v_add_u32 v10, 57344, v8
    s_load_dwordx8 s[24:31], s[50:51], s33 glc
    v_mov_b32 v13, 163776
    s_mov_b32 s9, 400000
    s_waitcnt lgkmcnt(0)
L_cw_65:
    ds_read_b32 v14, v13
    s_waitcnt lgkmcnt(0)
    v_cmp_gt_u32 vcc, 8, v14
    s_cbranch_vccz L_cok_66
    s_sub_u32 s9, s9, 1
    s_cmp_lg_u32 s9, 0
    s_cbranch_scc1 L_cw_65
L_cok_66:
    s_mov_b32 s9, 20000
    s_branch L_fc_68
L_fw_67:
    s_load_dwordx8 s[24:31], s[50:51], s33 glc
    s_waitcnt lgkmcnt(0)
L_fc_68:
    s_xor_b32 s24, s24, s8
    s_xor_b32 s25, s25, s8
    s_xor_b32 s26, s26, s8
    s_xor_b32 s27, s27, s8
    s_xor_b32 s28, s28, s8
    s_xor_b32 s29, s29, s8
    s_xor_b32 s30, s30, s8
    s_or_b32 s24, s24, s25
    s_or_b32 s24, s24, s26
    s_or_b32 s24, s24, s27
    s_or_b32 s24, s24, s28
    s_or_b32 s24, s24, s29
    s_or_b32 s24, s24, s30
    s_cbranch_scc0 L_fok_69
    s_sub_u32 s9, s9, 1
    s_cmp_lg_u32 s9, 0
    s_cbranch_scc1 L_fw_67
L_fok_69:
    s_setprio 0
    s_mov_b32 s71, s75
    buffer_load_dwordx4 v[16:19], v7, s[52:55], s71 offen sc1
    s_add_u32 s71, s71, 1024
    buffer_load_dwordx4 v[20:23], v7, s[52:55], s71 offen sc1
    s_mov_b32 s14, 3072
    s_cmp_eq_u32 s69, 6
    s_cselect_b32 s14, 4294941696, s14
    s_add_u32 s71, s71, s14
    buffer_load_dwordx4 v[24:27], v7, s[52:55], s71 offen sc1
    s_add_u32 s71, s71, 1024
    buffer_load_dwordx4 v[28:31], v7, s[52:55], s71 offen sc1
    s_mov_b32 s14, 3072
    s_cmp_eq_u32 s69, 5
    s_cselect_b32 s14, 4294941696, s14
    s_add_u32 s71, s71, s14
    buffer_load_dwordx4 v[32:35], v7, s[52:55], s71 offen sc1
    s_add_u32 s71, s71, 1024
    buffer_load_dwordx4 v[36:39], v7, s[52:55], s71 offen sc1
    s_mov_b32 s14, 3072
    s_cmp_eq_u32 s69, 4
    s_cselect_b32 s14, 4294941696, s14
    s_add_u32 s71, s71, s14
    buffer_load_dwordx4 v[40:43], v7, s[52:55], s71 offen sc1
    s_add_u32 s71, s71, 1024
    buffer_load_dwordx4 v[44:47], v7, s[52:55], s71 offen sc1
    s_mov_b32 s14, 3072
    s_cmp_eq_u32 s69, 3
    s_cselect_b32 s14, 4294941696, s14
    s_add_u32 s71, s71, s14
    s_waitcnt vmcnt(8)
    v_xor_b32 v79, s8, v73
    v_cmp_ne_u32 vcc, 0, v79
    s_cbranch_vccz L_ok_70
    s_mov_b32 s9, 20000
L_spin_71:
    buffer_load_dwordx2 v[72:73], v5, s[52:55], 0 offen sc1
    s_waitcnt vmcnt(0)
    v_xor_b32 v79, s8, v73
    v_cmp_ne_u32 vcc, 0, v79
    s_cbranch_vccz L_out_72
    s_sleep 2
    s_sub_u32 s9, s9, 1
    s_cmp_lg_u32 s9, 0
    s_cbranch_scc1 L_spin_71
L_out_72:
L_ok_70:
    ds_write_b128 v74, v[208:211]
    ds_write_b128 v74, v[212:215] offset:1280
    ds_write_b32 v75, v72 offset:2560
    ds_read2_b32 v[208:209], v76 offset0:0 offset1:8
    ds_read2_b32 v[210:211], v76 offset0:16 offset1:24
    ds_read2_b32 v[212:213], v78 offset0:0 offset1:8
    ds_read2_b32 v[214:215], v78 offset0:16 offset1:24
    ds_read_b128 v[216:219], v77 offset:2560
    ds_read_b128 v[220:223], v77 offset:2576
    s_waitcnt lgkmcnt(5)
    v_lshlrev_b32 v192, 16, v208
    v_and_b32 v193, 0xffff0000, v208
    v_lshlrev_b32 v194, 16, v209
    v_and_b32 v195, 0xffff0000, v209
    s_waitcnt lgkmcnt(4)
    v_lshlrev_b32 v196, 16, v210
    v_and_b32 v197, 0xffff0000, v210
    v_lshlrev_b32 v198, 16, v211
    v_and_b32 v199, 0xffff0000, v211
    s_waitcnt lgkmcnt(3)
    v_lshlrev_b32 v200, 16, v212
    v_and_b32 v201, 0xffff0000, v212
    v_lshlrev_b32 v202, 16, v213
    v_and_b32 v203, 0xffff0000, v213
    s_waitcnt lgkmcnt(2)
    v_lshlrev_b32 v204, 16, v214
    v_and_b32 v205, 0xffff0000, v214
    v_lshlrev_b32 v206, 16, v215
    v_and_b32 v207, 0xffff0000, v215
    s_waitcnt vmcnt(7)
    v_mfma_f32_32x32x16_bf16 v[224:239], v[80:83], v[16:19], 0
    v_mfma_f32_32x32x16_bf16 v[240:255], v[84:87], v[16:19], 0
    buffer_load_dwordx4 v[48:51], v7, s[52:55], s71 offen sc1
    s_add_u32 s71, s71, 1024
    s_waitcnt vmcnt(7)
    v_mfma_f32_32x32x16_bf16 v[224:239], v[88:91], v[20:23], v[224:239]
    v_mfma_f32_32x32x16_bf16 v[240:255], v[92:95], v[20:23], v[240:255]
    buffer_load_dwordx4 v[52:55], v7, s[52:55], s71 offen sc1
    s_mov_b32 s14, 3072
    s_cmp_eq_u32 s69, 2
    s_cselect_b32 s14, 4294941696, s14
    s_add_u32 s71, s71, s14
    s_waitcnt vmcnt(7)
    v_mfma_f32_32x32x16_bf16 v[224:239], v[96:99], v[24:27], v[224:239]
    v_mfma_f32_32x32x16_bf16 v[240:255], v[100:103], v[24:27], v[240:255]
    buffer_load_dwordx4 v[56:59], v7, s[52:55], s71 offen sc1
    s_add_u32 s71, s71, 1024
    s_waitcnt vmcnt(7)
    v_mfma_f32_32x32x16_bf16 v[224:239], v[104:107], v[28:31], v[224:239]
    v_mfma_f32_32x32x16_bf16 v[240:255], v[108:111], v[28:31], v[240:255]
    buffer_load_dwordx4 v[60:63], v7, s[52:55], s71 offen sc1
    s_mov_b32 s14, 3072
    s_cmp_eq_u32 s69, 1
    s_cselect_b32 s14, 4294941696, s14
    s_add_u32 s71, s71, s14
    s_waitcnt vmcnt(7)
    v_mfma_f32_32x32x16_bf16 v[224:239], v[112:115], v[32:35], v[224:239]
    v_mfma_f32_32x32x16_bf16 v[240:255], v[116:119], v[32:35], v[240:255]
    buffer_load_dwordx4 v[64:67], v7, s[52:55], s71 offen sc1
    s_add_u32 s71, s71, 1024
    s_waitcnt vmcnt(7)
    v_mfma_f32_32x32x16_bf16 v[224:239], v[120:123], v[36:39], v[224:239]
    v_mfma_f32_32x32x16_bf16 v[240:255], v[124:127], v[36:39], v[240:255]
    buffer_load_dwordx4 v[68:71], v7, s[52:55], s71 offen sc1
    s_waitcnt vmcnt(7)
    v_mfma_f32_32x32x16_bf16 v[224:239], v[128:131], v[40:43], v[224:239]
    v_mfma_f32_32x32x16_bf16 v[240:255], v[132:135], v[40:43], v[240:255]
    s_waitcnt vmcnt(6)
    v_mfma_f32_32x32x16_bf16 v[224:239], v[136:139], v[44:47], v[224:239]
    v_mfma_f32_32x32x16_bf16 v[240:255], v[140:143], v[44:47], v[240:255]
    s_waitcnt vmcnt(5)
    v_mfma_f32_32x32x16_bf16 v[224:239], v[144:147], v[48:51], v[224:239]
    v_mfma_f32_32x32x16_bf16 v[240:255], v[148:151], v[48:51], v[240:255]
    s_waitcnt vmcnt(4)
    v_mfma_f32_32x32x16_bf16 v[224:239], v[152:155], v[52:55], v[224:239]
    v_mfma_f32_32x32x16_bf16 v[240:255], v[156:159], v[52:55], v[240:255]
    s_waitcnt vmcnt(3)
    v_mfma_f32_32x32x16_bf16 v[224:239], v[160:163], v[56:59], v[224:239]
    v_mfma_f32_32x32x16_bf16 v[240:255], v[164:167], v[56:59], v[240:255]
    s_waitcnt vmcnt(2)
    v_mfma_f32_32x32x16_bf16 v[224:239], v[168:171], v[60:63], v[224:239]
    v_mfma_f32_32x32x16_bf16 v[240:255], v[172:175], v[60:63], v[240:255]
    s_waitcnt vmcnt(1)
    v_mfma_f32_32x32x16_bf16 v[224:239], v[176:179], v[64:67], v[224:239]
    v_mfma_f32_32x32x16_bf16 v[240:255], v[180:183], v[64:67], v[240:255]
    s_waitcnt vmcnt(0)
    v_mfma_f32_32x32x16_bf16 v[224:239], v[184:187], v[68:71], v[224:239]
    v_mfma_f32_32x32x16_bf16 v[240:255], v[188:191], v[68:71], v[240:255]
    s_setprio 0
    v_lshlrev_b32 v6, 5, v3
    v_xor_b32 v6, v6, v15
    v_add_u32 v6, s38, v6
    s_nop 6
    ds_write_b128 v6, v[224:227] offset:0
    ds_write_b128 v6, v[240:243] offset:1024
    v_xor_b32 v6, 64, v6
    ds_write_b128 v6, v[228:231] offset:2048
    ds_write_b128 v6, v[244:247] offset:3072
    v_xor_b32 v6, 192, v6
    ds_write_b128 v6, v[232:235] offset:4096
    ds_write_b128 v6, v[248:251] offset:5120
    v_xor_b32 v6, 64, v6
    ds_write_b128 v6, v[236:239] offset:6144
    ds_write_b128 v6, v[252:255] offset:7168
    v_mov_b32 v13, 163792
    v_mov_b32 v14, 1
    s_mov_b64 exec, 1
    ds_add_u32 v13, v14
    s_mov_b64 exec, -1
    v_mov_b32 v13, 163792
    s_mov_b32 s9, 400000
    s_waitcnt lgkmcnt(0)
L_cw_73:
    ds_read_b32 v14, v13
    s_waitcnt lgkmcnt(0)
    v_cmp_gt_u32 vcc, 8, v14
    s_cbranch_vccz L_cok_74
    s_sub_u32 s9, s9, 1
    s_cmp_lg_u32 s9, 0
    s_cbranch_scc1 L_cw_73
L_cok_74:
    ds_read_b128 v[16:19], v9 offset:0
    ds_read_b128 v[20:23], v9 offset:1024
    ds_read_b128 v[24:27], v9 offset:10240
    ds_read_b128 v[28:31], v9 offset:11264
    ds_read_b128 v[32:35], v9 offset:20480
    ds_read_b128 v[36:39], v9 offset:21504
    ds_read_b128 v[40:43], v9 offset:30720
    ds_read_b128 v[44:47], v9 offset:31744
    ds_read_b128 v[120:123], v10 offset:0
    ds_read_b128 v[124:127], v10 offset:1024
    ds_read_b128 v[128:131], v10 offset:8192
    ds_read_b128 v[132:135], v10 offset:9216
    ds_read_b128 v[136:139], v10 offset:16384
    ds_read_b128 v[140:143], v10 offset:17408
    ds_read_b128 v[144:147], v10 offset:24576
    ds_read_b128 v[148:151], v10 offset:25600
    s_waitcnt lgkmcnt(11)
    v_add_f32 v16, v16, v32
    v_add_f32 v17, v17, v33
    v_add_f32 v18, v18, v34
    v_add_f32 v19, v19, v35
    s_waitcnt lgkmcnt(10)
    v_add_f32 v20, v20, v36
    v_add_f32 v21, v21, v37
    v_add_f32 v22, v22, v38
    v_add_f32 v23, v23, v39
    s_waitcnt lgkmcnt(9)
    v_add_f32 v24, v24, v40
    v_add_f32 v25, v25, v41
    v_add_f32 v26, v26, v42
    v_add_f32 v27, v27, v43
    s_waitcnt lgkmcnt(8)
    v_add_f32 v28, v28, v44
    v_add_f32 v29, v29, v45
    v_add_f32 v30, v30, v46
    v_add_f32 v31, v31, v47
    s_branch L_pg8
.p2align 12
L_stub8:
    s_setpc_b64 s[100:101]
    s_nop 0
L_pg8:
    v_add_f32 v16, v16, v24
    v_add_f32 v17, v17, v25
    v_add_f32 v18, v18, v26
    v_add_f32 v19, v19, v27
    v_add_f32 v20, v20, v28
    v_add_f32 v21, v21, v29
    v_add_f32 v22, v22, v30
    v_add_f32 v23, v23, v31
    v_fmac_f32 v192, v216, v16
    v_fmac_f32 v193, v217, v20
    v_fmac_f32 v194, v218, v17
    v_fmac_f32 v195, v219, v21
    v_fmac_f32 v196, v220, v18
    v_fmac_f32 v197, v221, v22
    v_fmac_f32 v198, v222, v19
    v_fmac_f32 v199, v223, v23
    v_cvt_pk_bf16_f32 v160, v192, v193
    v_cvt_pk_bf16_f32 v161, v194, v195
    v_cvt_pk_bf16_f32 v162, v196, v197
    v_cvt_pk_bf16_f32 v163, v198, v199
    buffer_store_dwordx4 v[160:163], v4, s[60:63], s66 offen sc1
    s_waitcnt lgkmcnt(3)
    v_add_f32 v120, v120, v136
    v_add_f32 v121, v121, v137
    v_add_f32 v122, v122, v138
    v_add_f32 v123, v123, v139
    s_waitcnt lgkmcnt(2)
    v_add_f32 v124, v124, v140
    v_add_f32 v125, v125, v141
    v_add_f32 v126, v126, v142
    v_add_f32 v127, v127, v143
    s_waitcnt lgkmcnt(1)
    v_add_f32 v128, v128, v144
    v_add_f32 v129, v129, v145
    v_add_f32 v130, v130, v146
    v_add_f32 v131, v131, v147
    s_waitcnt lgkmcnt(0)
    v_add_f32 v132, v132, v148
    v_add_f32 v133, v133, v149
    v_add_f32 v134, v134, v150
    v_add_f32 v135, v135, v151
    v_add_f32 v120, v120, v128
    v_add_f32 v121, v121, v129
    v_add_f32 v122, v122, v130
    v_add_f32 v123, v123, v131
    v_add_f32 v124, v124, v132
    v_add_f32 v125, v125, v133
    v_add_f32 v126, v126, v134
    v_add_f32 v127, v127, v135
    v_fmac_f32 v200, v216, v120
    v_fmac_f32 v201, v217, v124
    v_fmac_f32 v202, v218, v121
    v_fmac_f32 v203, v219, v125
    v_fmac_f32 v204, v220, v122
    v_fmac_f32 v205, v221, v126
    v_fmac_f32 v206, v222, v123
    v_fmac_f32 v207, v223, v127
    v_mov_b32 v13, 163796
    s_mov_b32 s9, 400000
    s_waitcnt lgkmcnt(0)
L_cw_75:
    ds_read_b32 v14, v13
    s_waitcnt lgkmcnt(0)
    v_cmp_gt_u32 vcc, 4, v14
    s_cbranch_vccz L_cok_76
    s_sub_u32 s9, s9, 1
    s_cmp_lg_u32 s9, 0
    s_cbranch_scc1 L_cw_75
L_cok_76:
    ds_read_b128 v[16:19], v8 offset:0
    ds_read_b128 v[20:23], v8 offset:1024
    ds_read_b128 v[24:27], v8 offset:14336
    ds_read_b128 v[28:31], v8 offset:15360
    ds_read_b128 v[32:35], v8 offset:28672
    ds_read_b128 v[36:39], v8 offset:29696
    ds_read_b128 v[40:43], v8 offset:43008
    ds_read_b128 v[44:47], v8 offset:44032
    s_waitcnt lgkmcnt(3)
    v_add_f32 v16, v16, v32
    v_add_f32 v17, v17, v33
    v_add_f32 v18, v18, v34
    v_add_f32 v19, v19, v35
    s_waitcnt lgkmcnt(2)
    v_add_f32 v20, v20, v36
    v_add_f32 v21, v21, v37
    v_add_f32 v22, v22, v38
    v_add_f32 v23, v23, v39
    s_waitcnt lgkmcnt(1)
    v_add_f32 v24, v24, v40
    v_add_f32 v25, v25, v41
    v_add_f32 v26, v26, v42
    v_add_f32 v27, v27, v43
    s_waitcnt lgkmcnt(0)
    v_add_f32 v28, v28, v44
    v_add_f32 v29, v29, v45
    v_add_f32 v30, v30, v46
    v_add_f32 v31, v31, v47
    v_add_f32 v16, v16, v24
    v_add_f32 v17, v17, v25
    v_add_f32 v18, v18, v26
    v_add_f32 v19, v19, v27
    v_add_f32 v20, v20, v28
    v_add_f32 v21, v21, v29
    v_add_f32 v22, v22, v30
    v_add_f32 v23, v23, v31
    v_fmac_f32 v200, v216, v16
    v_fmac_f32 v201, v217, v20
    v_fmac_f32 v202, v218, v17
    v_fmac_f32 v203, v219, v21
    v_fmac_f32 v204, v220, v18
    v_fmac_f32 v205, v221, v22
    v_fmac_f32 v206, v222, v19
    v_fmac_f32 v207, v223, v23
    v_cvt_pk_bf16_f32 v164, v200, v201
    v_cvt_pk_bf16_f32 v165, v202, v203
    v_cvt_pk_bf16_f32 v166, v204, v205
    v_cvt_pk_bf16_f32 v167, v206, v207
    buffer_store_dwordx4 v[164:167], v4, s[60:63], s67 offen sc1
    s_branch L_fin
.p2align 12
L_stub9:
    s_setpc_b64 s[100:101]
    s_nop 0
L_pg9:
L_spare:
    s_mov_b32 s56, s42
    s_mov_b32 s57, s43
    s_mov_b32 s58, 896
    s_mov_b32 s59, 0x00020000
    v_lshlrev_b32 v39, 1, v0
    buffer_load_ushort v60, v39, s[56:59], 0 offen
    s_sub_u32 s67, 31, s6
    s_lshl_b32 s67, s67, 3
    s_add_u32 s67, s67, s5
    s_lshr_b32 s12, s4, 2
    s_lshl_b32 s12, s12, 5
    s_add_u32 s68, s67, s12
    s_add_u32 s14, s68, 22
    s_sub_u32 s15, s68, 10
    s_cmp_lt_u32 s68, 10
    s_cselect_b32 s14, s14, s15
    s_cmp_ge_u32 s68, 32
    s_cselect_b32 s14, s68, s14
    s_mul_i32 s12, s14, 37
    s_lshr_b32 s12, s12, 8
    s_mul_i32 s13, s12, 7
    s_sub_u32 s13, s14, s13
    s_lshl_b32 s12, s12, 2
    s_lshr_b32 s12, 0x534210, s12
    s_waitcnt lgkmcnt(0)
    s_and_b32 s65, s12, 15
    s_mul_i32 s64, s65, 7
    s_add_u32 s64, s64, s13
    s_lshl_b32 s69, s64, 7
    s_waitcnt vmcnt(12)
    v_lshrrev_b32 v36, 3, v1
    s_waitcnt vmcnt(11)
    v_and_b32 v37, 2, v36
    v_and_b32 v38, 7, v1
    v_xor_b32 v37, v37, v38
    s_and_b32 s12, s3, 1
    s_lshl_b32 s12, s12, 2
    v_xor_b32 v37, s12, v37
    v_lshrrev_b32 v42, 4, v1
    v_bfe_u32 v43, v1, 2, 2
    v_lshl_add_u32 v40, v42, 3, v43
    v_lshlrev_b32 v40, 7, v40
    v_lshrrev_b32 v43, 1, v43
    v_and_b32 v44, 1, v42
    v_lshl_add_u32 v43, v44, 1, v43
    v_xor_b32 v43, s3, v43
    v_lshl_add_u32 v40, v43, 5, v40
    v_and_b32 v43, 3, v1
    v_lshl_add_u32 v40, v43, 3, v40
    s_lshr_b32 s12, s4, 2
    s_mul_i32 s12, s12, 57344
    v_add_u32 v40, s12, v40
    v_and_b32 v43, 1, v1
    v_mul_u32_u24 v43, 1088, v43
    v_lshl_add_u32 v41, v42, 4, v43
    v_add_u32 v41, 114688, v41
    v_add_u32 v39, 114688, v39
    s_mov_b32 s60, s44
    s_mov_b32 s61, s45
    s_mov_b32 s62, 2408448
    s_mov_b32 s63, 0x00020000
    s_cmp_ge_u32 s4, 4
    s_cbranch_scc1 L_spB_77
    s_barrier
    s_cmp_ge_u32 s68, 42
    s_cbranch_scc1 L_nodma_79
    v_mul_u32_u24 v10, 5376, v36
    v_lshl_add_u32 v10, v37, 4, v10
    s_mul_i32 s12, s3, 43008
    s_add_u32 s12, s69, s12
    v_add_u32 v10, s12, v10
    s_lshr_b32 s12, s4, 2
    s_mul_i32 s12, s12, 57344
    s_lshl_b32 s13, s3, 10
    s_add_u32 s12, s12, s13
    s_mov_b32 s13, 0
    s_lshl_b32 s14, s13, 12
    s_add_u32 m0, s14, s12
    s_mul_i32 s14, s13, 172032
    s_add_u32 s13, s13, 1
    buffer_load_dwordx4 v10, s[60:63], s14 offen lds
    s_lshl_b32 s14, s13, 12
    s_add_u32 m0, s14, s12
    s_mul_i32 s14, s13, 172032
    s_add_u32 s13, s13, 1
    buffer_load_dwordx4 v10, s[60:63], s14 offen lds
    s_lshl_b32 s14, s13, 12
    s_add_u32 m0, s14, s12
    s_mul_i32 s14, s13, 172032
    s_add_u32 s13, s13, 1
    buffer_load_dwordx4 v10, s[60:63], s14 offen lds
    s_lshl_b32 s14, s13, 12
    s_add_u32 m0, s14, s12
    s_mul_i32 s14, s13, 172032
    s_add_u32 s13, s13, 1
    buffer_load_dwordx4 v10, s[60:63], s14 offen lds
    s_lshl_b32 s14, s13, 12
    s_add_u32 m0, s14, s12
    s_mul_i32 s14, s13, 172032
    s_add_u32 s13, s13, 1
    buffer_load_dwordx4 v10, s[60:63], s14 offen lds
    s_lshl_b32 s14, s13, 12
    s_add_u32 m0, s14, s12
    s_mul_i32 s14, s13, 172032
    s_add_u32 s13, s13, 1
    buffer_load_dwordx4 v10, s[60:63], s14 offen lds
    s_lshl_b32 s14, s13, 12
    s_add_u32 m0, s14, s12
    s_mul_i32 s14, s13, 172032
    s_add_u32 s13, s13, 1
    buffer_load_dwordx4 v10, s[60:63], s14 offen lds
    s_lshl_b32 s14, s13, 12
    s_add_u32 m0, s14, s12
    s_mul_i32 s14, s13, 172032
    s_add_u32 s13, s13, 1
    buffer_load_dwordx4 v10, s[60:63], s14 offen lds
    s_lshl_b32 s14, s13, 12
    s_add_u32 m0, s14, s12
    s_mul_i32 s14, s13, 172032
    s_add_u32 s13, s13, 1
    buffer_load_dwordx4 v10, s[60:63], s14 offen lds
    s_lshl_b32 s14, s13, 12
    s_add_u32 m0, s14, s12
    s_mul_i32 s14, s13, 172032
    s_add_u32 s13, s13, 1
    buffer_load_dwordx4 v10, s[60:63], s14 offen lds
    s_lshl_b32 s14, s13, 12
    s_add_u32 m0, s14, s12
    s_mul_i32 s14, s13, 172032
    s_add_u32 s13, s13, 1
    buffer_load_dwordx4 v10, s[60:63], s14 offen lds
    s_lshl_b32 s14, s13, 12
    s_add_u32 m0, s14, s12
    s_mul_i32 s14, s13, 172032
    s_add_u32 s13, s13, 1
    buffer_load_dwordx4 v10, s[60:63], s14 offen lds
    s_lshl_b32 s14, s13, 12
    s_add_u32 m0, s14, s12
    s_mul_i32 s14, s13, 172032
    s_add_u32 s13, s13, 1
    buffer_load_dwordx4 v10, s[60:63], s14 offen lds
    s_lshl_b32 s14, s13, 12
    s_add_u32 m0, s14, s12
    s_mul_i32 s14, s13, 172032
    s_add_u32 s13, s13, 1
    buffer_load_dwordx4 v10, s[60:63], s14 offen lds
L_nodma_79:
    s_waitcnt vmcnt(14)
    v_lshlrev_b32 v60, 16, v60
    v_mul_f32 v62, 0xbfb8aa3b, v60
    v_exp_f32 v62, v62
    s_nop 0
    v_add_f32 v62, 1.0, v62
    v_rcp_f32 v62, v62
    s_nop 0
    v_mul_f32 v60, v60, v62
    v_cvt_pk_bf16_f32 v60, v60, v60
    ds_write_b16 v39, v60
    ds_write_b16 v39, v60 offset:1088
    s_waitcnt lgkmcnt(0)
    s_sub_u32 s73, s6, 28
    s_lshl_b32 s73, s73, 1
    s_lshr_b32 s12, s4, 2
    s_add_u32 s73, s73, s12
    s_lshr_b32 s70, s5, 1
    s_mul_i32 s70, s70, 7
    s_add_u32 s70, s70, s73
    s_lshl_b32 s72, s70, 7
    s_and_b32 s71, s5, 1
    s_cselect_b32 s56, s38, s36
    s_cselect_b32 s57, s39, s37
    s_mov_b32 s58, 1605632
    s_mov_b32 s59, 0x00020000
    s_setprio 1
    s_branch L_spJ_78
L_spB_77:
    s_setprio 2
    s_mov_b32 s13, 0x3f803f80
    s_waitcnt vmcnt(10)
    v_dot2_f32_bf16 v58, v12, s13, 0
    v_dot2_f32_bf16 v59, v12, v12, 0
    v_dot2_f32_bf16 v58, v13, s13, v58
    v_dot2_f32_bf16 v59, v13, v13, v59
    v_dot2_f32_bf16 v58, v14, s13, v58
    v_dot2_f32_bf16 v59, v14, v14, v59
    v_dot2_f32_bf16 v58, v15, s13, v58
    v_dot2_f32_bf16 v59, v15, v15, v59
    s_waitcnt vmcnt(9)
    v_dot2_f32_bf16 v58, v16, s13, v58
    v_dot2_f32_bf16 v59, v16, v16, v59
    v_dot2_f32_bf16 v58, v17, s13, v58
    v_dot2_f32_bf16 v59, v17, v17, v59
    v_dot2_f32_bf16 v58, v18, s13, v58
    v_dot2_f32_bf16 v59, v18, v18, v59
    v_dot2_f32_bf16 v58, v19, s13, v58
    v_dot2_f32_bf16 v59, v19, v19, v59
    s_nop 1
    v_add_f32_dpp v58, v58, v58 row_shr:1 row_mask:0xf bank_mask:0xf bound_ctrl:0
    v_add_f32_dpp v59, v59, v59 row_shr:1 row_mask:0xf bank_mask:0xf bound_ctrl:0
    s_nop 0
    v_add_f32_dpp v58, v58, v58 row_shr:2 row_mask:0xf bank_mask:0xf bound_ctrl:0
    v_add_f32_dpp v59, v59, v59 row_shr:2 row_mask:0xf bank_mask:0xf bound_ctrl:0
    s_nop 0
    v_add_f32_dpp v58, v58, v58 row_shr:4 row_mask:0xf bank_mask:0xf bound_ctrl:0
    v_add_f32_dpp v59, v59, v59 row_shr:4 row_mask:0xf bank_mask:0xf bound_ctrl:0
    s_nop 0
    v_add_f32_dpp v58, v58, v58 row_shr:8 row_mask:0xf bank_mask:0xf bound_ctrl:0
    v_add_f32_dpp v59, v59, v59 row_shr:8 row_mask:0xf bank_mask:0xf bound_ctrl:0
    s_nop 0
    v_add_f32_dpp v58, v58, v58 row_bcast:15 row_mask:0xa bank_mask:0xf
    v_add_f32_dpp v59, v59, v59 row_bcast:15 row_mask:0xa bank_mask:0xf
    s_waitcnt lgkmcnt(0)
    s_load_dword s8, s[48:49], 0
    v_mul_f32 v58, 0x3b124925, v58
    v_mul_f32 v59, 0x3b124925, v59
    v_fma_f32 v59, -v58, v58, v59
    v_max_f32 v59, 0, v59
    v_cvt_pk_bf16_f32 v59, v59, v59
    v_and_b32 v59, 0xffff0000, v59
    v_add_f32 v59, 0x3727c5ac, v59
    v_cvt_pk_bf16_f32 v59, v59, v59
    v_and_b32 v59, 0xffff0000, v59
    v_sqrt_f32 v59, v59
    s_nop 0
    v_cvt_pk_bf16_f32 v58, v58, v59
    s_waitcnt lgkmcnt(0)
    s_cmp_lg_u32 s8, 0
    s_cbranch_scc1 L_nonce_ok_80
    s_mov_b32 s9, 20000
    s_mov_b32 s96, s48
    s_mov_b32 s97, s49
    s_mov_b32 s98, 256
    s_mov_b32 s99, 0x00020000
L_nonce_poll_81:
    buffer_load_dword v8, v7, s[96:99], 0 offen offset:128 sc1
    s_waitcnt vmcnt(0)
    v_readfirstlane_b32 s8, v8
    s_sub_u32 s9, s9, 1
    s_cmp_eq_u32 s9, 0
    s_cbranch_scc1 L_nonce_ok_80
    s_cmp_eq_u32 s8, 0
    s_cbranch_scc1 L_nonce_poll_81
L_nonce_ok_80:
    s_nop 1
    v_mov_b32 v21, s8
    v_mov_b32 v23, s8
    s_waitcnt vmcnt(7)
    buffer_store_dwordx4 v[20:23], v5, s[52:55], s70 offen sc1
    v_mov_b32 v25, s8
    v_mov_b32 v27, s8
    s_waitcnt vmcnt(6)
    buffer_store_dwordx4 v[24:27], v6, s[52:55], s70 offen sc1
    v_mov_b32 v29, s8
    v_mov_b32 v31, s8
    s_waitcnt vmcnt(5)
    buffer_store_dwordx4 v[28:31], v56, s[52:55], s70 offen sc1
    v_mov_b32 v33, s8
    v_mov_b32 v35, s8
    s_waitcnt vmcnt(4)
    buffer_store_dwordx4 v[32:35], v57, s[52:55], s70 offen sc1
    v_mov_b32 v59, s8
    s_mov_b32 exec_lo, 0x80000000
    s_mov_b32 exec_hi, 0x80000000
    buffer_store_dwordx2 v[58:59], v4, s[52:55], s71 offen sc1
    s_mov_b64 exec, -1
    s_setprio 0
    v_mov_b32 v2, 116992
    ds_write_b32 v2, v59
    s_barrier
    s_waitcnt vmcnt(5)
    v_lshlrev_b32 v60, 16, v60
    v_mul_f32 v62, 0xbfb8aa3b, v60
    v_exp_f32 v62, v62
    s_nop 0
    v_add_f32 v62, 1.0, v62
    v_rcp_f32 v62, v62
    s_nop 0
    v_mul_f32 v60, v60, v62
    v_cvt_pk_bf16_f32 v60, v60, v60
    ds_write_b16 v39, v60
    ds_write_b16 v39, v60 offset:1088
    s_waitcnt lgkmcnt(0)
    s_barrier
    s_cmp_ge_u32 s68, 42
    s_cbranch_scc1 L_nodma_82
    v_mul_u32_u24 v10, 5376, v36
    v_lshl_add_u32 v10, v37, 4, v10
    s_mul_i32 s12, s3, 43008
    s_add_u32 s12, s69, s12
    v_add_u32 v10, s12, v10
    s_lshr_b32 s12, s4, 2
    s_mul_i32 s12, s12, 57344
    s_lshl_b32 s13, s3, 10
    s_add_u32 s12, s12, s13
    s_mov_b32 s13, 0
    s_lshl_b32 s14, s13, 12
    s_add_u32 m0, s14, s12
    s_mul_i32 s14, s13, 172032
    s_add_u32 s13, s13, 1
    buffer_load_dwordx4 v10, s[60:63], s14 offen lds
    s_lshl_b32 s14, s13, 12
    s_add_u32 m0, s14, s12
    s_mul_i32 s14, s13, 172032
    s_add_u32 s13, s13, 1
    buffer_load_dwordx4 v10, s[60:63], s14 offen lds
    s_lshl_b32 s14, s13, 12
    s_add_u32 m0, s14, s12
    s_mul_i32 s14, s13, 172032
    s_add_u32 s13, s13, 1
    buffer_load_dwordx4 v10, s[60:63], s14 offen lds
    s_lshl_b32 s14, s13, 12
    s_add_u32 m0, s14, s12
    s_mul_i32 s14, s13, 172032
    s_add_u32 s13, s13, 1
    buffer_load_dwordx4 v10, s[60:63], s14 offen lds
    s_lshl_b32 s14, s13, 12
    s_add_u32 m0, s14, s12
    s_mul_i32 s14, s13, 172032
    s_add_u32 s13, s13, 1
    buffer_load_dwordx4 v10, s[60:63], s14 offen lds
    s_lshl_b32 s14, s13, 12
    s_add_u32 m0, s14, s12
    s_mul_i32 s14, s13, 172032
    s_add_u32 s13, s13, 1
    buffer_load_dwordx4 v10, s[60:63], s14 offen lds
    s_lshl_b32 s14, s13, 12
    s_add_u32 m0, s14, s12
    s_mul_i32 s14, s13, 172032
    s_add_u32 s13, s13, 1
    buffer_load_dwordx4 v10, s[60:63], s14 offen lds
    s_lshl_b32 s14, s13, 12
    s_add_u32 m0, s14, s12
    s_mul_i32 s14, s13, 172032
    s_add_u32 s13, s13, 1
    buffer_load_dwordx4 v10, s[60:63], s14 offen lds
    s_lshl_b32 s14, s13, 12
    s_add_u32 m0, s14, s12
    s_mul_i32 s14, s13, 172032
    s_add_u32 s13, s13, 1
    buffer_load_dwordx4 v10, s[60:63], s14 offen lds
    s_lshl_b32 s14, s13, 12
    s_add_u32 m0, s14, s12
    s_mul_i32 s14, s13, 172032
    s_add_u32 s13, s13, 1
    buffer_load_dwordx4 v10, s[60:63], s14 offen lds
    s_lshl_b32 s14, s13, 12
    s_add_u32 m0, s14, s12
    s_mul_i32 s14, s13, 172032
    s_add_u32 s13, s13, 1
    buffer_load_dwordx4 v10, s[60:63], s14 offen lds
    s_lshl_b32 s14, s13, 12
    s_add_u32 m0, s14, s12
    s_mul_i32 s14, s13, 172032
    s_add_u32 s13, s13, 1
    buffer_load_dwordx4 v10, s[60:63], s14 offen lds
    s_lshl_b32 s14, s13, 12
    s_add_u32 m0, s14, s12
    s_mul_i32 s14, s13, 172032
    s_add_u32 s13, s13, 1
    buffer_load_dwordx4 v10, s[60:63], s14 offen lds
    s_lshl_b32 s14, s13, 12
    s_add_u32 m0, s14, s12
    s_mul_i32 s14, s13, 172032
    s_add_u32 s13, s13, 1
    buffer_load_dwordx4 v10, s[60:63], s14 offen lds
L_nodma_82:
    s_sub_u32 s73, s6, 28
    s_lshl_b32 s73, s73, 1
    s_lshr_b32 s12, s4, 2
    s_add_u32 s73, s73, s12
    s_lshr_b32 s70, s5, 1
    s_mul_i32 s70, s70, 7
    s_add_u32 s70, s70, s73
    s_lshl_b32 s72, s70, 7
    s_and_b32 s71, s5, 1
    s_cselect_b32 s56, s38, s36
    s_cselect_b32 s57, s39, s37
    s_mov_b32 s58, 1605632
    s_mov_b32 s59, 0x00020000
    s_cmp_lt_u32 s68, 42
    s_cbranch_scc1 L_spJ_78
    s_mov_b32 s74, s68
    s_mov_b32 s68, s73
    s_cmp_ge_u32 s68, 7
    s_cbranch_scc1 L_nodma_84
    v_mul_u32_u24 v10, 3584, v36
    v_lshl_add_u32 v10, v37, 4, v10
    s_mul_i32 s12, s3, 28672
    s_add_u32 s12, s72, s12
    v_add_u32 v10, s12, v10
    s_lshr_b32 s12, s4, 2
    s_mul_i32 s12, s12, 57344
    s_lshl_b32 s13, s3, 10
    s_add_u32 s12, s12, s13
    s_lshl_b32 s13, s68, 1
    s_add_u32 s13, s13, 6
    s_sub_u32 s14, s13, 14
    s_min_u32 s13, s13, s14
    s_lshl_b32 s14, s13, 12
    s_add_u32 m0, s14, s12
    s_mul_i32 s14, s13, 114688
    s_add_u32 s13, s13, 1
    buffer_load_dwordx4 v10, s[56:59], s14 offen lds
    s_cmp_eq_u32 s13, 14
    s_cselect_b32 s13, 0, s13
    s_lshl_b32 s14, s13, 12
    s_add_u32 m0, s14, s12
    s_mul_i32 s14, s13, 114688
    s_add_u32 s13, s13, 1
    buffer_load_dwordx4 v10, s[56:59], s14 offen lds
    s_cmp_eq_u32 s13, 14
    s_cselect_b32 s13, 0, s13
    s_lshl_b32 s14, s13, 12
    s_add_u32 m0, s14, s12
    s_mul_i32 s14, s13, 114688
    s_add_u32 s13, s13, 1
    buffer_load_dwordx4 v10, s[56:59], s14 offen lds
    s_cmp_eq_u32 s13, 14
    s_cselect_b32 s13, 0, s13
    s_lshl_b32 s14, s13, 12
    s_add_u32 m0, s14, s12
    s_mul_i32 s14, s13, 114688
    s_add_u32 s13, s13, 1
    buffer_load_dwordx4 v10, s[56:59], s14 offen lds
    s_cmp_eq_u32 s13, 14
    s_cselect_b32 s13, 0, s13
    s_lshl_b32 s14, s13, 12
    s_add_u32 m0, s14, s12
    s_mul_i32 s14, s13, 114688
    s_add_u32 s13, s13, 1
    buffer_load_dwordx4 v10, s[56:59], s14 offen lds
    s_cmp_eq_u32 s13, 14
    s_cselect_b32 s13, 0, s13
    s_lshl_b32 s14, s13, 12
    s_add_u32 m0, s14, s12
    s_mul_i32 s14, s13, 114688
    s_add_u32 s13, s13, 1
    buffer_load_dwordx4 v10, s[56:59], s14 offen lds
    s_cmp_eq_u32 s13, 14
    s_cselect_b32 s13, 0, s13
    s_lshl_b32 s14, s13, 12
    s_add_u32 m0, s14, s12
    s_mul_i32 s14, s13, 114688
    s_add_u32 s13, s13, 1
    buffer_load_dwordx4 v10, s[56:59], s14 offen lds
    s_cmp_eq_u32 s13, 14
    s_cselect_b32 s13, 0, s13
    s_lshl_b32 s14, s13, 12
    s_add_u32 m0, s14, s12
    s_mul_i32 s14, s13, 114688
    s_add_u32 s13, s13, 1
    buffer_load_dwordx4 v10, s[56:59], s14 offen lds
    s_cmp_eq_u32 s13, 14
    s_cselect_b32 s13, 0, s13
    s_lshl_b32 s14, s13, 12
    s_add_u32 m0, s14, s12
    s_mul_i32 s14, s13, 114688
    s_add_u32 s13, s13, 1
    buffer_load_dwordx4 v10, s[56:59], s14 offen lds
    s_cmp_eq_u32 s13, 14
    s_cselect_b32 s13, 0, s13
    s_lshl_b32 s14, s13, 12
    s_add_u32 m0, s14, s12
    s_mul_i32 s14, s13, 114688
    s_add_u32 s13, s13, 1
    buffer_load_dwordx4 v10, s[56:59], s14 offen lds
    s_cmp_eq_u32 s13, 14
    s_cselect_b32 s13, 0, s13
    s_lshl_b32 s14, s13, 12
    s_add_u32 m0, s14, s12
    s_mul_i32 s14, s13, 114688
    s_add_u32 s13, s13, 1
    buffer_load_dwordx4 v10, s[56:59], s14 offen lds
    s_cmp_eq_u32 s13, 14
    s_cselect_b32 s13, 0, s13
    s_lshl_b32 s14, s13, 12
    s_add_u32 m0, s14, s12
    s_mul_i32 s14, s13, 114688
    s_add_u32 s13, s13, 1
    buffer_load_dwordx4 v10, s[56:59], s14 offen lds
    s_cmp_eq_u32 s13, 14
    s_cselect_b32 s13, 0, s13
    s_lshl_b32 s14, s13, 12
    s_add_u32 m0, s14, s12
    s_mul_i32 s14, s13, 114688
    s_add_u32 s13, s13, 1
    buffer_load_dwordx4 v10, s[56:59], s14 offen lds
    s_cmp_eq_u32 s13, 14
    s_cselect_b32 s13, 0, s13
    s_lshl_b32 s14, s13, 12
    s_add_u32 m0, s14, s12
    s_mul_i32 s14, s13, 114688
    s_add_u32 s13, s13, 1
    buffer_load_dwordx4 v10, s[56:59], s14 offen lds
    s_cmp_eq_u32 s13, 14
    s_cselect_b32 s13, 0, s13
L_nodma_84:
    s_mov_b32 s68, s74
    s_branch L_spJ_78_n
L_spJ_78:
    s_waitcnt vmcnt(0)
L_spJ_78_n:
    s_barrier
    v_mov_b32 v4, 116992
    ds_read_b32 v8, v4
    s_waitcnt lgkmcnt(0)
    v_readfirstlane_b32 s8, v8
    s_cmp_ge_u32 s68, 42
    s_cbranch_scc1 L_nomod_85
    ds_read_b64_tr_b16 v[64:65], v40 offset:0
    ds_read_b64_tr_b16 v[66:67], v40 offset:512
    ds_read_b128 v[68:71], v41 offset:0
    ds_read_b64_tr_b16 v[72:73], v40 offset:4096
    ds_read_b64_tr_b16 v[74:75], v40 offset:4608
    ds_read_b128 v[76:79], v41 offset:64
    ds_read_b64_tr_b16 v[80:81], v40 offset:8192
    ds_read_b64_tr_b16 v[82:83], v40 offset:8704
    ds_read_b128 v[84:87], v41 offset:128
    ds_read_b64_tr_b16 v[88:89], v40 offset:12288
    ds_read_b64_tr_b16 v[90:91], v40 offset:12800
    ds_read_b128 v[92:95], v41 offset:192
    s_waitcnt lgkmcnt(9)
    v_mfma_f32_16x16x32_bf16 v[32:35], v[64:67], v[68:71], 0
    ds_read_b64_tr_b16 v[96:97], v40 offset:16384
    ds_read_b64_tr_b16 v[98:99], v40 offset:16896
    ds_read_b128 v[100:103], v41 offset:256
    s_waitcnt lgkmcnt(9)
    v_mfma_f32_16x16x32_bf16 v[32:35], v[72:75], v[76:79], v[32:35]
    ds_read_b64_tr_b16 v[104:105], v40 offset:20480
    ds_read_b64_tr_b16 v[106:107], v40 offset:20992
    ds_read_b128 v[108:111], v41 offset:320
    s_waitcnt lgkmcnt(9)
    v_mfma_f32_16x16x32_bf16 v[32:35], v[80:83], v[84:87], v[32:35]
    ds_read_b64_tr_b16 v[112:113], v40 offset:24576
    ds_read_b64_tr_b16 v[114:115], v40 offset:25088
    ds_read_b128 v[116:119], v41 offset:384
    s_waitcnt lgkmcnt(9)
    v_mfma_f32_16x16x32_bf16 v[32:35], v[88:91], v[92:95], v[32:35]
    ds_read_b64_tr_b16 v[120:121], v40 offset:28672
    ds_read_b64_tr_b16 v[122:123], v40 offset:29184
    ds_read_b128 v[124:127], v41 offset:448
    s_waitcnt lgkmcnt(9)
    v_mfma_f32_16x16x32_bf16 v[32:35], v[96:99], v[100:103], v[32:35]
    ds_read_b64_tr_b16 v[128:129], v40 offset:32768
    ds_read_b64_tr_b16 v[130:131], v40 offset:33280
    ds_read_b128 v[132:135], v41 offset:512
    s_waitcnt lgkmcnt(9)
    v_mfma_f32_16x16x32_bf16 v[32:35], v[104:107], v[108:111], v[32:35]
    ds_read_b64_tr_b16 v[136:137], v40 offset:36864
    ds_read_b64_tr_b16 v[138:139], v40 offset:37376
    ds_read_b128 v[140:143], v41 offset:576
    s_waitcnt lgkmcnt(9)
    v_mfma_f32_16x16x32_bf16 v[32:35], v[112:115], v[116:119], v[32:35]
    ds_read_b64_tr_b16 v[144:145], v40 offset:40960
    ds_read_b64_tr_b16 v[146:147], v40 offset:41472
    ds_read_b128 v[148:151], v41 offset:640
    s_waitcnt lgkmcnt(9)
    v_mfma_f32_16x16x32_bf16 v[32:35], v[120:123], v[124:127], v[32:35]
    ds_read_b64_tr_b16 v[152:153], v40 offset:45056
    ds_read_b64_tr_b16 v[154:155], v40 offset:45568
    ds_read_b128 v[156:159], v41 offset:704
    s_waitcnt lgkmcnt(9)
    v_mfma_f32_16x16x32_bf16 v[32:35], v[128:131], v[132:135], v[32:35]
    ds_read_b64_tr_b16 v[160:161], v40 offset:49152
    ds_read_b64_tr_b16 v[162:163], v40 offset:49664
    ds_read_b128 v[164:167], v41 offset:768
    s_waitcnt lgkmcnt(9)
    v_mfma_f32_16x16x32_bf16 v[32:35], v[136:139], v[140:143], v[32:35]
    ds_read_b64_tr_b16 v[168:169], v40 offset:53248
    ds_read_b64_tr_b16 v[170:171], v40 offset:53760
    ds_read_b128 v[172:175], v41 offset:832
    s_waitcnt lgkmcnt(9)
    v_mfma_f32_16x16x32_bf16 v[32:35], v[144:147], v[148:151], v[32:35]
    s_waitcnt lgkmcnt(6)
    v_mfma_f32_16x16x32_bf16 v[32:35], v[152:155], v[156:159], v[32:35]
    s_waitcnt lgkmcnt(3)
    v_mfma_f32_16x16x32_bf16 v[32:35], v[160:163], v[164:167], v[32:35]
    s_waitcnt lgkmcnt(0)
    v_mfma_f32_16x16x32_bf16 v[32:35], v[168:171], v[172:175], v[32:35]
    s_cmp_eq_u32 s65, 1
    s_cselect_b32 s12, 1.0, 0
    s_cmp_eq_u32 s65, 4
    s_cselect_b32 s12, 1.0, s12
    s_nop 3
    v_cvt_pk_bf16_f32 v32, v32, v32
    v_and_b32 v32, 0xffff0000, v32
    v_add_f32 v32, s12, v32
    v_cvt_pk_bf16_f32 v48, v32, v32
    v_and_b32 v48, 0xffff0000, v48
    v_mov_b32 v49, s8
    v_cvt_pk_bf16_f32 v33, v33, v33
    v_and_b32 v33, 0xffff0000, v33
    v_add_f32 v33, s12, v33
    v_cvt_pk_bf16_f32 v50, v33, v33
    v_and_b32 v50, 0xffff0000, v50
    v_mov_b32 v51, s8
    v_cvt_pk_bf16_f32 v34, v34, v34
    v_and_b32 v34, 0xffff0000, v34
    v_add_f32 v34, s12, v34
    v_cvt_pk_bf16_f32 v52, v34, v34
    v_and_b32 v52, 0xffff0000, v52
    v_mov_b32 v53, s8
    v_cvt_pk_bf16_f32 v35, v35, v35
    v_and_b32 v35, 0xffff0000, v35
    v_add_f32 v35, s12, v35
    v_cvt_pk_bf16_f32 v54, v35, v35
    v_and_b32 v54, 0xffff0000, v54
    v_mov_b32 v55, s8
    v_lshlrev_b32 v45, 5, v42
    s_lshl_b32 s12, s64, 9
    s_lshl_b32 s13, s3, 7
    s_add_u32 s12, s12, s13
    s_add_u32 s12, s12, 4259840
    s_mov_b32 exec_lo, 0x00010001
    s_mov_b32 exec_hi, 0x00010001
    buffer_store_dwordx4 v[48:51], v45, s[52:55], s12 offen sc1
    buffer_store_dwordx4 v[52:55], v45, s[52:55], s12 offen offset:16 sc1
    s_mov_b64 exec, -1
L_nomod_85:
    s_cmp_ge_u32 s4, 4
    s_cbranch_scc1 L_gb_86
    s_barrier
L_gb_86:
    s_barrier
    s_cmp_ge_u32 s68, 42
    s_mov_b32 s68, s73
    s_cbranch_scc1 L_cdone_87
    s_cmp_ge_u32 s68, 7
    s_cbranch_scc1 L_nodma_88
    v_mul_u32_u24 v10, 3584, v36
    v_lshl_add_u32 v10, v37, 4, v10
    s_mul_i32 s12, s3, 28672
    s_add_u32 s12, s72, s12
    v_add_u32 v10, s12, v10
    s_lshr_b32 s12, s4, 2
    s_mul_i32 s12, s12, 57344
    s_lshl_b32 s13, s3, 10
    s_add_u32 s12, s12, s13
    s_lshl_b32 s13, s68, 1
    s_add_u32 s13, s13, 6
    s_sub_u32 s14, s13, 14
    s_min_u32 s13, s13, s14
    s_lshl_b32 s14, s13, 12
    s_add_u32 m0, s14, s12
    s_mul_i32 s14, s13, 114688
    s_add_u32 s13, s13, 1
    buffer_load_dwordx4 v10, s[56:59], s14 offen lds
    s_cmp_eq_u32 s13, 14
    s_cselect_b32 s13, 0, s13
    s_lshl_b32 s14, s13, 12
    s_add_u32 m0, s14, s12
    s_mul_i32 s14, s13, 114688
    s_add_u32 s13, s13, 1
    buffer_load_dwordx4 v10, s[56:59], s14 offen lds
    s_cmp_eq_u32 s13, 14
    s_cselect_b32 s13, 0, s13
    s_lshl_b32 s14, s13, 12
    s_add_u32 m0, s14, s12
    s_mul_i32 s14, s13, 114688
    s_add_u32 s13, s13, 1
    buffer_load_dwordx4 v10, s[56:59], s14 offen lds
    s_cmp_eq_u32 s13, 14
    s_cselect_b32 s13, 0, s13
    s_lshl_b32 s14, s13, 12
    s_add_u32 m0, s14, s12
    s_mul_i32 s14, s13, 114688
    s_add_u32 s13, s13, 1
    buffer_load_dwordx4 v10, s[56:59], s14 offen lds
    s_cmp_eq_u32 s13, 14
    s_cselect_b32 s13, 0, s13
    s_lshl_b32 s14, s13, 12
    s_add_u32 m0, s14, s12
    s_mul_i32 s14, s13, 114688
    s_add_u32 s13, s13, 1
    buffer_load_dwordx4 v10, s[56:59], s14 offen lds
    s_cmp_eq_u32 s13, 14
    s_cselect_b32 s13, 0, s13
    s_lshl_b32 s14, s13, 12
    s_add_u32 m0, s14, s12
    s_mul_i32 s14, s13, 114688
    s_add_u32 s13, s13, 1
    buffer_load_dwordx4 v10, s[56:59], s14 offen lds
    s_cmp_eq_u32 s13, 14
    s_cselect_b32 s13, 0, s13
    s_lshl_b32 s14, s13, 12
    s_add_u32 m0, s14, s12
    s_mul_i32 s14, s13, 114688
    s_add_u32 s13, s13, 1
    buffer_load_dwordx4 v10, s[56:59], s14 offen lds
    s_cmp_eq_u32 s13, 14
    s_cselect_b32 s13, 0, s13
    s_lshl_b32 s14, s13, 12
    s_add_u32 m0, s14, s12
    s_mul_i32 s14, s13, 114688
    s_add_u32 s13, s13, 1
    buffer_load_dwordx4 v10, s[56:59], s14 offen lds
    s_cmp_eq_u32 s13, 14
    s_cselect_b32 s13, 0, s13
    s_lshl_b32 s14, s13, 12
    s_add_u32 m0, s14, s12
    s_mul_i32 s14, s13, 114688
    s_add_u32 s13, s13, 1
    buffer_load_dwordx4 v10, s[56:59], s14 offen lds
    s_cmp_eq_u32 s13, 14
    s_cselect_b32 s13, 0, s13
    s_lshl_b32 s14, s13, 12
    s_add_u32 m0, s14, s12
    s_mul_i32 s14, s13, 114688
    s_add_u32 s13, s13, 1
    buffer_load_dwordx4 v10, s[56:59], s14 offen lds
    s_cmp_eq_u32 s13, 14
    s_cselect_b32 s13, 0, s13
    s_lshl_b32 s14, s13, 12
    s_add_u32 m0, s14, s12
    s_mul_i32 s14, s13, 114688
    s_add_u32 s13, s13, 1
    buffer_load_dwordx4 v10, s[56:59], s14 offen lds
    s_cmp_eq_u32 s13, 14
    s_cselect_b32 s13, 0, s13
    s_lshl_b32 s14, s13, 12
    s_add_u32 m0, s14, s12
    s_mul_i32 s14, s13, 114688
    s_add_u32 s13, s13, 1
    buffer_load_dwordx4 v10, s[56:59], s14 offen lds
    s_cmp_eq_u32 s13, 14
    s_cselect_b32 s13, 0, s13
    s_lshl_b32 s14, s13, 12
    s_add_u32 m0, s14, s12
    s_mul_i32 s14, s13, 114688
    s_add_u32 s13, s13, 1
    buffer_load_dwordx4 v10, s[56:59], s14 offen lds
    s_cmp_eq_u32 s13, 14
    s_cselect_b32 s13, 0, s13
    s_lshl_b32 s14, s13, 12
    s_add_u32 m0, s14, s12
    s_mul_i32 s14, s13, 114688
    s_add_u32 s13, s13, 1
    buffer_load_dwordx4 v10, s[56:59], s14 offen lds
    s_cmp_eq_u32 s13, 14
    s_cselect_b32 s13, 0, s13
L_nodma_88:
L_cdone_87:
    s_and_b32 s66, s5, 1
    s_lshl_b32 s66, s66, 2
    s_lshr_b32 s12, s5, 1
    s_add_u32 s66, s66, s12
    s_mul_i32 s12, s66, 229376
    s_branch L_pg10
.p2align 12
L_stub10:
    s_setpc_b64 s[100:101]
    s_nop 0
L_pg10:
    s_mul_i32 s13, s4, 28672
    s_add_u32 s12, s12, s13
    s_sub_u32 s14, s6, 28
    s_lshl_b32 s13, s14, 8
    s_add_u32 s12, s12, s13
    s_add_u32 s12, s12, 5242880
    v_lshl_add_u32 v4, v1, 2, s12
    s_lshl_b32 s13, s66, 2
    s_add_u32 s13, s13, s14
    s_lshl_b32 s13, s13, 9
    s_add_u32 s13, s13, 4227072
    v_lshl_add_u32 v5, v1, 3, s13
    v_lshlrev_b32 v6, 3, v0
    v_add_u32 v6, 118784, v6
    v_lshlrev_b32 v13, 3, v1
    v_add_u32 v13, 118784, v13
    s_and_b32 s12, s66, 3
    s_lshl_b32 s12, s12, 15
    s_add_u32 s12, s12, 4718592
    v_and_b32 v62, 255, v0
    v_min_u32 v62, 223, v62
    v_lshl_add_u32 v62, v62, 7, s12
    s_mul_i32 s75, s67, 7
    s_add_u32 s75, s75, s3
    s_lshl_b32 s75, s75, 7
    s_add_u32 s75, s75, s12
    v_mov_b32 v63, 0
    v_min_u32 v46, 447, v0
    v_lshlrev_b32 v46, 3, v46
    v_add_u32 v46, 4270592, v46
    s_mov_b64 vcc, -1
    s_mov_b32 s9, 20000
L_spin_90:
    s_mov_b64 exec, vcc
    buffer_load_dwordx2 v[56:57], v46, s[52:55], 0 offen offset:0 sc1
    buffer_load_dwordx2 v[58:59], v46, s[52:55], 0 offen offset:3584 sc1
    s_waitcnt vmcnt(0)
    v_bitop3_b32 v47, v57, v59, s8 bitop3:0x7e
    v_cmp_ne_u32 vcc, 0, v47
    s_cbranch_vccz L_out_91
    s_sleep 2
    s_sub_u32 s9, s9, 1
    s_cmp_lg_u32 s9, 0
    s_cbranch_scc1 L_spin_90
L_out_91:
    s_mov_b64 exec, -1
L_ok_89:
    ds_write_b16_d16_hi v39, v58
    ds_write_b16_d16_hi v39, v56 offset:1088
    s_waitcnt vmcnt(0) lgkmcnt(0)
    s_load_dword s16, s[50:51], s75 glc
    s_barrier
    s_cmp_ge_u32 s68, 7
    s_cbranch_scc1 L_noc_92
    ds_read_b64_tr_b16 v[64:65], v40 offset:0
    ds_read_b64_tr_b16 v[66:67], v40 offset:512
    ds_read_b128 v[68:71], v41 offset:0
    ds_read_b64_tr_b16 v[72:73], v40 offset:4096
    ds_read_b64_tr_b16 v[74:75], v40 offset:4608
    ds_read_b128 v[76:79], v41 offset:64
    ds_read_b64_tr_b16 v[80:81], v40 offset:8192
    ds_read_b64_tr_b16 v[82:83], v40 offset:8704
    ds_read_b128 v[84:87], v41 offset:128
    ds_read_b64_tr_b16 v[88:89], v40 offset:12288
    ds_read_b64_tr_b16 v[90:91], v40 offset:12800
    ds_read_b128 v[92:95], v41 offset:192
    s_waitcnt lgkmcnt(9)
    v_mfma_f32_16x16x32_bf16 v[32:35], v[64:67], v[68:71], 0
    ds_read_b64_tr_b16 v[96:97], v40 offset:16384
    ds_read_b64_tr_b16 v[98:99], v40 offset:16896
    ds_read_b128 v[100:103], v41 offset:256
    s_waitcnt lgkmcnt(9)
    v_mfma_f32_16x16x32_bf16 v[32:35], v[72:75], v[76:79], v[32:35]
    ds_read_b64_tr_b16 v[104:105], v40 offset:20480
    ds_read_b64_tr_b16 v[106:107], v40 offset:20992
    ds_read_b128 v[108:111], v41 offset:320
    s_waitcnt lgkmcnt(9)
    v_mfma_f32_16x16x32_bf16 v[32:35], v[80:83], v[84:87], v[32:35]
    ds_read_b64_tr_b16 v[112:113], v40 offset:24576
    ds_read_b64_tr_b16 v[114:115], v40 offset:25088
    ds_read_b128 v[116:119], v41 offset:384
    s_waitcnt lgkmcnt(9)
    v_mfma_f32_16x16x32_bf16 v[32:35], v[88:91], v[92:95], v[32:35]
    ds_read_b64_tr_b16 v[120:121], v40 offset:28672
    ds_read_b64_tr_b16 v[122:123], v40 offset:29184
    ds_read_b128 v[124:127], v41 offset:448
    s_waitcnt lgkmcnt(9)
    v_mfma_f32_16x16x32_bf16 v[32:35], v[96:99], v[100:103], v[32:35]
    ds_read_b64_tr_b16 v[128:129], v40 offset:32768
    ds_read_b64_tr_b16 v[130:131], v40 offset:33280
    ds_read_b128 v[132:135], v41 offset:512
    s_waitcnt lgkmcnt(9)
    v_mfma_f32_16x16x32_bf16 v[32:35], v[104:107], v[108:111], v[32:35]
    ds_read_b64_tr_b16 v[136:137], v40 offset:36864
    ds_read_b64_tr_b16 v[138:139], v40 offset:37376
    ds_read_b128 v[140:143], v41 offset:576
    s_waitcnt lgkmcnt(9)
    v_mfma_f32_16x16x32_bf16 v[32:35], v[112:115], v[116:119], v[32:35]
    ds_read_b64_tr_b16 v[144:145], v40 offset:40960
    ds_read_b64_tr_b16 v[146:147], v40 offset:41472
    ds_read_b128 v[148:151], v41 offset:640
    s_waitcnt lgkmcnt(9)
    v_mfma_f32_16x16x32_bf16 v[32:35], v[120:123], v[124:127], v[32:35]
    ds_read_b64_tr_b16 v[152:153], v40 offset:45056
    ds_read_b64_tr_b16 v[154:155], v40 offset:45568
    ds_read_b128 v[156:159], v41 offset:704
    s_waitcnt lgkmcnt(9)
    v_mfma_f32_16x16x32_bf16 v[32:35], v[128:131], v[132:135], v[32:35]
    ds_read_b64_tr_b16 v[160:161], v40 offset:49152
    ds_read_b64_tr_b16 v[162:163], v40 offset:49664
    ds_read_b128 v[164:167], v41 offset:768
    s_waitcnt lgkmcnt(9)
    v_mfma_f32_16x16x32_bf16 v[32:35], v[136:139], v[140:143], v[32:35]
    ds_read_b64_tr_b16 v[168:169], v40 offset:53248
    ds_read_b64_tr_b16 v[170:171], v40 offset:53760
    ds_read_b128 v[172:175], v41 offset:832
    s_waitcnt lgkmcnt(9)
    v_mfma_f32_16x16x32_bf16 v[32:35], v[144:147], v[148:151], v[32:35]
    s_waitcnt lgkmcnt(6)
    v_mfma_f32_16x16x32_bf16 v[32:35], v[152:155], v[156:159], v[32:35]
    s_waitcnt lgkmcnt(3)
    v_mfma_f32_16x16x32_bf16 v[32:35], v[160:163], v[164:167], v[32:35]
    s_waitcnt lgkmcnt(0)
    v_mfma_f32_16x16x32_bf16 v[32:35], v[168:171], v[172:175], v[32:35]
    s_nop 7
    v_cvt_pk_bf16_f32 v47, v32, v32
    v_and_b32 v47, 0xffff0000, v47
    v_sub_f32 v46, v32, v47
    v_cvt_pk_bf16_f32 v48, v47, v46
    v_mov_b32 v49, s8
    v_cvt_pk_bf16_f32 v47, v33, v33
    v_and_b32 v47, 0xffff0000, v47
    v_sub_f32 v46, v33, v47
    v_cvt_pk_bf16_f32 v50, v47, v46
    v_mov_b32 v51, s8
    v_cvt_pk_bf16_f32 v47, v34, v34
    v_and_b32 v47, 0xffff0000, v47
    v_sub_f32 v46, v34, v47
    v_cvt_pk_bf16_f32 v52, v47, v46
    v_mov_b32 v53, s8
    v_cvt_pk_bf16_f32 v47, v35, v35
    v_and_b32 v47, 0xffff0000, v47
    v_sub_f32 v46, v35, v47
    v_cvt_pk_bf16_f32 v54, v47, v46
    v_mov_b32 v55, s8
    s_waitcnt lgkmcnt(0)
    s_cmp_lg_u32 s16, s8
    s_cbranch_scc1 L_ne_93
    s_cmp_ge_u32 s4, 4
    s_cbranch_scc1 L_ne_93
    buffer_load_dword v63, v62, s[52:55], 0 offen sc1
L_ne_93:
    v_lshlrev_b32 v45, 6, v42
    v_and_b32 v46, 1, v1
    v_lshl_add_u32 v45, v46, 3, v45
    s_lshl_b32 s12, s70, 11
    s_lshl_b32 s13, s71, 8
    s_add_u32 s12, s12, s13
    s_lshl_b32 s13, s3, 9
    s_add_u32 s12, s12, s13
    s_add_u32 s12, s12, 4456448
    s_mov_b32 exec_lo, 0x00030003
    s_mov_b32 exec_hi, 0x00030003
    buffer_store_dwordx2 v[48:49], v45, s[52:55], s12 offen offset:0 sc1
    buffer_store_dwordx2 v[50:51], v45, s[52:55], s12 offen offset:16 sc1
    buffer_store_dwordx2 v[52:53], v45, s[52:55], s12 offen offset:32 sc1
    buffer_store_dwordx2 v[54:55], v45, s[52:55], s12 offen offset:48 sc1
    s_mov_b64 exec, -1
L_noc_92:
    s_waitcnt lgkmcnt(0)
    s_cmp_ge_u32 s4, 4
    s_cbranch_scc1 L_nopoll_94
    s_cmp_eq_u32 s16, s8
    s_cbranch_scc1 L_go_96
    s_mov_b32 s9, 20000
L_gt_95:
    s_load_dword s16, s[50:51], s75 glc
    s_waitcnt lgkmcnt(0)
    s_cmp_eq_u32 s16, s8
    s_cbranch_scc1 L_go_96
    s_sub_u32 s9, s9, 1
    s_cmp_lg_u32 s9, 0
    s_cbranch_scc1 L_gt_95
L_go_96:
    s_waitcnt vmcnt(4)
    v_xor_b32 v61, s8, v63
    v_cmp_ne_u32 vcc, 0, v61
    s_cbranch_vccz L_ok_97
    s_mov_b32 s9, 20000
L_spin_98:
    s_mov_b64 exec, vcc
    buffer_load_dword v63, v62, s[52:55], 0 offen sc1
    s_waitcnt vmcnt(0)
    v_xor_b32 v61, s8, v63
    v_cmp_ne_u32 vcc, 0, v61
    s_cbranch_vccz L_out_99
    s_sleep 6
    s_sub_u32 s9, s9, 1
    s_cmp_lg_u32 s9, 0
    s_cbranch_scc1 L_spin_98
L_out_99:
    s_mov_b64 exec, -1
L_ok_97:
L_nopoll_94:
    s_barrier
    buffer_load_dword v64, v4, s[52:55], 0 offen offset:0 sc1
    buffer_load_dword v65, v4, s[52:55], 0 offen offset:1024 sc1
    buffer_load_dword v66, v4, s[52:55], 0 offen offset:2048 sc1
    buffer_load_dword v67, v4, s[52:55], 0 offen offset:3072 sc1
    v_add_u32 v4, 4096, v4
    buffer_load_dword v68, v4, s[52:55], 0 offen offset:0 sc1
    buffer_load_dword v69, v4, s[52:55], 0 offen offset:1024 sc1
    buffer_load_dword v70, v4, s[52:55], 0 offen offset:2048 sc1
    buffer_load_dword v71, v4, s[52:55], 0 offen offset:3072 sc1
    v_add_u32 v4, 4096, v4
    buffer_load_dword v72, v4, s[52:55], 0 offen offset:0 sc1
    buffer_load_dword v73, v4, s[52:55], 0 offen offset:1024 sc1
    buffer_load_dword v74, v4, s[52:55], 0 offen offset:2048 sc1
    buffer_load_dword v75, v4, s[52:55], 0 offen offset:3072 sc1
    v_add_u32 v4, 4096, v4
    buffer_load_dword v76, v4, s[52:55], 0 offen offset:0 sc1
    buffer_load_dword v77, v4, s[52:55], 0 offen offset:1024 sc1
    buffer_load_dword v78, v4, s[52:55], 0 offen offset:2048 sc1
    buffer_load_dword v79, v4, s[52:55], 0 offen offset:3072 sc1
    v_add_u32 v4, 4096, v4
    buffer_load_dword v80, v4, s[52:55], 0 offen offset:0 sc1
    buffer_load_dword v81, v4, s[52:55], 0 offen offset:1024 sc1
    buffer_load_dword v82, v4, s[52:55], 0 offen offset:2048 sc1
    buffer_load_dword v83, v4, s[52:55], 0 offen offset:3072 sc1
    v_add_u32 v4, 4096, v4
    buffer_load_dword v84, v4, s[52:55], 0 offen offset:0 sc1
    buffer_load_dword v85, v4, s[52:55], 0 offen offset:1024 sc1
    buffer_load_dword v86, v4, s[52:55], 0 offen offset:2048 sc1
    buffer_load_dword v87, v4, s[52:55], 0 offen offset:3072 sc1
    v_add_u32 v4, 4096, v4
    buffer_load_dword v88, v4, s[52:55], 0 offen offset:0 sc1
    buffer_load_dword v89, v4, s[52:55], 0 offen offset:1024 sc1
    buffer_load_dword v90, v4, s[52:55], 0 offen offset:2048 sc1
    buffer_load_dword v91, v4, s[52:55], 0 offen offset:3072 sc1
    v_add_u32 v4, 4096, v4
    s_mov_b32 s13, 0x3f803f80
    s_waitcnt vmcnt(27)
    v_dot2_f32_bf16 v2, v64, s13, 0
    v_dot2_f32_bf16 v3, v64, v64, 0
    s_waitcnt vmcnt(26)
    v_dot2_f32_bf16 v2, v65, s13, v2
    v_dot2_f32_bf16 v3, v65, v65, v3
    s_waitcnt vmcnt(25)
    v_dot2_f32_bf16 v2, v66, s13, v2
    v_dot2_f32_bf16 v3, v66, v66, v3
    s_waitcnt vmcnt(24)
    v_dot2_f32_bf16 v2, v67, s13, v2
    v_dot2_f32_bf16 v3, v67, v67, v3
    s_waitcnt vmcnt(23)
    v_dot2_f32_bf16 v2, v68, s13, v2
    v_dot2_f32_bf16 v3, v68, v68, v3
    s_waitcnt vmcnt(22)
    v_dot2_f32_bf16 v2, v69, s13, v2
    v_dot2_f32_bf16 v3, v69, v69, v3
    s_waitcnt vmcnt(21)
    v_dot2_f32_bf16 v2, v70, s13, v2
    v_dot2_f32_bf16 v3, v70, v70, v3
    s_waitcnt vmcnt(20)
    v_dot2_f32_bf16 v2, v71, s13, v2
    v_dot2_f32_bf16 v3, v71, v71, v3
    s_waitcnt vmcnt(19)
    v_dot2_f32_bf16 v2, v72, s13, v2
    v_dot2_f32_bf16 v3, v72, v72, v3
    s_waitcnt vmcnt(18)
    v_dot2_f32_bf16 v2, v73, s13, v2
    v_dot2_f32_bf16 v3, v73, v73, v3
    s_waitcnt vmcnt(17)
    v_dot2_f32_bf16 v2, v74, s13, v2
    v_dot2_f32_bf16 v3, v74, v74, v3
    s_waitcnt vmcnt(16)
    v_dot2_f32_bf16 v2, v75, s13, v2
    v_dot2_f32_bf16 v3, v75, v75, v3
    s_waitcnt vmcnt(15)
    v_dot2_f32_bf16 v2, v76, s13, v2
    v_dot2_f32_bf16 v3, v76, v76, v3
    s_waitcnt vmcnt(14)
    v_dot2_f32_bf16 v2, v77, s13, v2
    v_dot2_f32_bf16 v3, v77, v77, v3
    s_waitcnt vmcnt(13)
    v_dot2_f32_bf16 v2, v78, s13, v2
    v_dot2_f32_bf16 v3, v78, v78, v3
    s_waitcnt vmcnt(12)
    v_dot2_f32_bf16 v2, v79, s13, v2
    v_dot2_f32_bf16 v3, v79, v79, v3
    s_waitcnt vmcnt(11)
    v_dot2_f32_bf16 v2, v80, s13, v2
    v_dot2_f32_bf16 v3, v80, v80, v3
    s_waitcnt vmcnt(10)
    v_dot2_f32_bf16 v2, v81, s13, v2
    v_dot2_f32_bf16 v3, v81, v81, v3
    s_waitcnt vmcnt(9)
    v_dot2_f32_bf16 v2, v82, s13, v2
    v_dot2_f32_bf16 v3, v82, v82, v3
    s_waitcnt vmcnt(8)
    v_dot2_f32_bf16 v2, v83, s13, v2
    v_dot2_f32_bf16 v3, v83, v83, v3
    s_waitcnt vmcnt(7)
    v_dot2_f32_bf16 v2, v84, s13, v2
    v_dot2_f32_bf16 v3, v84, v84, v3
    s_waitcnt vmcnt(6)
    v_dot2_f32_bf16 v2, v85, s13, v2
    v_dot2_f32_bf16 v3, v85, v85, v3
    s_waitcnt vmcnt(5)
    v_dot2_f32_bf16 v2, v86, s13, v2
    v_dot2_f32_bf16 v3, v86, v86, v3
    s_waitcnt vmcnt(4)
    v_dot2_f32_bf16 v2, v87, s13, v2
    v_dot2_f32_bf16 v3, v87, v87, v3
    s_waitcnt vmcnt(3)
    v_dot2_f32_bf16 v2, v88, s13, v2
    v_dot2_f32_bf16 v3, v88, v88, v3
    s_waitcnt vmcnt(2)
    v_dot2_f32_bf16 v2, v89, s13, v2
    v_dot2_f32_bf16 v3, v89, v89, v3
    s_waitcnt vmcnt(1)
    v_dot2_f32_bf16 v2, v90, s13, v2
    v_dot2_f32_bf16 v3, v90, v90, v3
    s_waitcnt vmcnt(0)
    v_dot2_f32_bf16 v2, v91, s13, v2
    v_dot2_f32_bf16 v3, v91, v91, v3
    s_nop 2
    ds_write_b64 v6, v[2:3]
    s_waitcnt lgkmcnt(0)
    s_barrier
    s_cmp_lg_u32 s4, 7
    s_cbranch_scc1 L_st0_100
    ds_read_b64 v[16:17], v13 offset:0
    ds_read_b64 v[18:19], v13 offset:512
    ds_read_b64 v[20:21], v13 offset:1024
    ds_read_b64 v[22:23], v13 offset:1536
    ds_read_b64 v[24:25], v13 offset:2048
    ds_read_b64 v[26:27], v13 offset:2560
    ds_read_b64 v[28:29], v13 offset:3072
    ds_read_b64 v[30:31], v13 offset:3584
    s_waitcnt lgkmcnt(3)
    v_add_f32 v16, v16, v24
    v_add_f32 v17, v17, v25
    s_waitcnt lgkmcnt(2)
    v_add_f32 v18, v18, v26
    v_add_f32 v19, v19, v27
    s_waitcnt lgkmcnt(1)
    v_add_f32 v20, v20, v28
    v_add_f32 v21, v21, v29
    s_waitcnt lgkmcnt(0)
    v_add_f32 v22, v22, v30
    v_add_f32 v23, v23, v31
    v_add_f32 v16, v16, v20
    v_add_f32 v17, v17, v21
    v_add_f32 v18, v18, v22
    v_add_f32 v19, v19, v23
    v_add_f32 v16, v16, v18
    v_add_f32 v17, v17, v19
    v_mul_f32 v16, 0x3b124925, v16
    v_mul_f32 v17, 0x3b124925, v17
    v_fma_f32 v17, -v16, v16, v17
    v_max_f32 v17, 0, v17
    v_cvt_pk_bf16_f32 v17, v17, v17
    v_and_b32 v17, 0xffff0000, v17
    v_add_f32 v17, 0x3727c5ac, v17
    v_cvt_pk_bf16_f32 v17, v17, v17
    v_and_b32 v17, 0xffff0000, v17
    v_sqrt_f32 v17, v17
    s_nop 0
    v_cvt_pk_bf16_f32 v16, v16, v17
    v_mov_b32 v17, s8
    buffer_store_dwordx2 v[16:17], v5, s[52:55], 0 offen sc1
L_st0_100:
    s_barrier
    s_cmp_eq_u32 s4, 7
    s_cbranch_scc1 L_fin
    s_sub_u32 s14, s6, 28
    s_mul_i32 s13, s14, 7
    s_add_u32 s13, s13, s4
    s_mul_i32 s13, s13, 57344
    s_add_u32 s13, s13, 16777216
    v_min_u32 v99, 55, v1
    v_lshl_add_u32 v99, v99, 7, s13
    v_add_u32 v98, 28672, v99
    buffer_load_dword v100, v98, s[52:55], 0 offen sc1
    s_waitcnt vmcnt(0)
    v_add_u32 v98, 35840, v99
    buffer_load_dword v101, v98, s[52:55], 0 offen sc1
    s_waitcnt vmcnt(0)
    v_add_u32 v98, 43008, v99
    buffer_load_dword v102, v98, s[52:55], 0 offen sc1
    s_waitcnt vmcnt(0)
    v_add_u32 v98, 50176, v99
    buffer_load_dword v103, v98, s[52:55], 0 offen sc1
    s_waitcnt vmcnt(0)
    v_add_u32 v98, 0, v99
    buffer_load_dword v104, v98, s[52:55], 0 offen sc1
    s_waitcnt vmcnt(0)
    v_add_u32 v98, 7168, v99
    buffer_load_dword v105, v98, s[52:55], 0 offen sc1
    s_waitcnt vmcnt(0)
    v_add_u32 v98, 14336, v99
    buffer_load_dword v106, v98, s[52:55], 0 offen sc1
    s_waitcnt vmcnt(0)
    v_add_u32 v98, 21504, v99
    buffer_load_dword v107, v98, s[52:55], 0 offen sc1
    s_waitcnt vmcnt(0)
L_fin:
L_exit:
    s_endpgm
.p2align 7
.type L_lagtab,@object
L_lagtab:
.short 16384, 16384, 16384, 16384, 14584, 14584, 14584, 14584, 14584, 14584, 14584, 14576, 14576, 14576, 14576, 14576
.short 14576, 14576, 14576, 14576, 14568, 14568, 14568, 14568, 14568, 14568, 14568, 14560, 14560, 14560, 14560, 14560
.short 14560, 14560, 14560, 14560, 14552, 14552, 14552, 14552, 14552, 14552, 14552, 14544, 14544, 14544, 14544, 14544
.short 14544, 14544, 14544, 14544, 14536, 14536, 14536, 14536, 14536, 14536, 14536, 14528, 14528, 14528, 14528, 14528
.short 14528, 14528, 14528, 14528, 14520, 14520, 14520, 14520, 14520, 14520, 14520, 14512, 14512, 14512, 14512, 14512
.short 14512, 14512, 14512, 14512, 14504, 14504, 14504, 14504, 14504, 14504, 14504, 14496, 14496, 14496, 14496, 14496
.short 14496, 14496, 14496, 14496, 14488, 14488, 14488, 14488, 14488, 14488, 14488, 14480, 14480, 14480, 14480, 14480
.short 14480, 14480, 14480, 14480, 14472, 14472, 14472, 14472, 14472, 14472, 14472, 14464, 14464, 14464, 14464, 14464
.short 14464, 14464, 14464, 14464, 14456, 14456, 14456, 14456, 14456, 14456, 14456, 14448, 14448, 14448, 14448, 14448
.short 14448, 14448, 14448, 14448, 14440, 14440, 14440, 14440, 14440, 14440, 14440, 14432, 14432, 14432, 14432, 14432
.short 14432, 14432, 14432, 14432, 14424, 14424, 14424, 14424, 14424, 14424, 14424, 14416, 14416, 14416, 14416, 14416
.short 14416, 14416, 14416, 14416, 14408, 14408, 14408, 14408, 14408, 14408, 14408, 14400, 14400, 14400, 14400, 14400
.short 14400, 14400, 14400, 14400, 14392, 14392, 14392, 14392, 14392, 14392, 14392, 14384, 14384, 14384, 14384, 14384
.short 14384, 14384, 14384, 14384, 14376, 14376, 14376, 14376, 14376, 14376, 14376, 14368, 14368, 14368, 14368, 14368
.short 14368, 14368, 14368, 14368, 14360, 14360, 14360, 14360, 14360, 14360, 14360, 14352, 14352, 14352, 14352, 14352
.short 14352, 14352, 14352, 14352, 14344, 14344, 14344, 14344, 14344, 14344, 14344, 14336, 14336, 14336, 14336, 14336
.short 14336, 14336, 14336, 14336, 12536, 12536, 12536, 12536, 12536, 12536, 12536, 12528, 12528, 12528, 12528, 12528
.short 12528, 12528, 12528, 12528, 12520, 12520, 12520, 12520, 12520, 12520, 12520, 12512, 12512, 12512, 12512, 12512
.short 12512, 12512, 12512, 12512, 12504, 12504, 12504, 12504, 12504, 12504, 12504, 12496, 12496, 12496, 12496, 12496
.short 12496, 12496, 12496, 12496, 12488, 12488, 12488, 12488, 12488, 12488, 12488, 12480, 12480, 12480, 12480, 12480
.short 12480, 12480, 12480, 12480, 12472, 12472, 12472, 12472, 12472, 12472, 12472, 12464, 12464, 12464, 12464, 12464
.short 12464, 12464, 12464, 12464, 12456, 12456, 12456, 12456, 12456, 12456, 12456, 12448, 12448, 12448, 12448, 12448
.short 12448, 12448, 12448, 12448, 12440, 12440, 12440, 12440, 12440, 12440, 12440, 12432, 12432, 12432, 12432, 12432
.short 12432, 12432, 12432, 12432, 12424, 12424, 12424, 12424, 12424, 12424, 12424, 12416, 12416, 12416, 12416, 12416
.short 12416, 12416, 12416, 12416, 12408, 12408, 12408, 12408, 12408, 12408, 12408, 12400, 12400, 12400, 12400, 12400
.short 12400, 12400, 12400, 12400, 12392, 12392, 12392, 12392, 12392, 12392, 12392, 12384, 12384, 12384, 12384, 12384
.short 12384, 12384, 12384, 12384, 12376, 12376, 12376, 12376, 12376, 12376, 12376, 12368, 12368, 12368, 12368, 12368
.short 12368, 12368, 12368, 12368, 12360, 12360, 12360, 12360, 12360, 12360, 12360, 12352, 12352, 12352, 12352, 12352
.short 12352, 12352, 12352, 12352, 12344, 12344, 12344, 12344, 12344, 12344, 12344, 12336, 12336, 12336, 12336, 12336
.short 12336, 12336, 12336, 12336, 12328, 12328, 12328, 12328, 12328, 12328, 12328, 12320, 12320, 12320, 12320, 12320
.short 12320, 12320, 12320, 12320, 12312, 12312, 12312, 12312, 12312, 12312, 12312, 12304, 12304, 12304, 12304, 12304
.short 12304, 12304, 12304, 12304, 12296, 12296, 12296, 12296, 12296, 12296, 12296, 12288, 12288, 12288, 12288, 12288
.short 12288, 12288, 12288, 12288, 10488, 10488, 10488, 10488, 10488, 10488, 10488, 10480, 10480, 10480, 10480, 10480
.short 10480, 10480, 10480, 10480, 10472, 10472, 10472, 10472, 10472, 10472, 10472, 10464, 10464, 10464, 10464, 10464
.short 10464, 10464, 10464, 10464, 10456, 10456, 10456, 10456, 10456, 10456, 10456, 10448, 10448, 10448, 10448, 10448
.short 10448, 10448, 10448, 10448, 10440, 10440, 10440, 10440, 10440, 10440, 10440, 10432, 10432, 10432, 10432, 10432
.short 10432, 10432, 10432, 10432, 10424, 10424, 10424, 10424, 10424, 10424, 10424, 10416, 10416, 10416, 10416, 10416
.short 10416, 10416, 10416, 10416, 10408, 10408, 10408, 10408, 10408, 10408, 10408, 10400, 10400, 10400, 10400, 10400
.short 10400, 10400, 10400, 10400, 10392, 10392, 10392, 10392, 10392, 10392, 10392, 10384, 10384, 10384, 10384, 10384
.short 10384, 10384, 10384, 10384, 10376, 10376, 10376, 10376, 10376, 10376, 10376, 10368, 10368, 10368, 10368, 10368
.short 10368, 10368, 10368, 10368, 10360, 10360, 10360, 10360, 10360, 10360, 10360, 10352, 10352, 10352, 10352, 10352
.short 10352, 10352, 10352, 10352, 10344, 10344, 10344, 10344, 10344, 10344, 10344, 10336, 10336, 10336, 10336, 10336
.short 10336, 10336, 10336, 10336, 10328, 10328, 10328, 10328, 10328, 10328, 10328, 10320, 10320, 10320, 10320, 10320
.short 10320, 10320, 10320, 10320, 10312, 10312, 10312, 10312, 10312, 10312, 10312, 10304, 10304, 10304, 10304, 10304
.short 10304, 10304, 10304, 10304, 10296, 10296, 10296, 10296, 10296, 10296, 10296, 10288, 10288, 10288, 10288, 10288
.short 10288, 10288, 10288, 10288, 10280, 10280, 10280, 10280, 10280, 10280, 10280, 10272, 10272, 10272, 10272, 10272
.short 10272, 10272, 10272, 10272, 10264, 10264, 10264, 10264, 10264, 10264, 10264, 10256, 10256, 10256, 10256, 10256
.short 10256, 10256, 10256, 10256, 10248, 10248, 10248, 10248, 10248, 10248, 10248, 10240, 10240, 10240, 10240, 10240
.short 10240, 10240, 10240, 10240, 8440, 8440, 8440, 8440, 8440, 8440, 8440, 8432, 8432, 8432, 8432, 8432
.short 8432, 8432, 8432, 8432, 8424, 8424, 8424, 8424, 8424, 8424, 8424, 8416, 8416, 8416, 8416, 8416
.short 8416, 8416, 8416, 8416, 8408, 8408, 8408, 8408, 8408, 8408, 8408, 8400, 8400, 8400, 8400, 8400
.short 8400, 8400, 8400, 8400, 8392, 8392, 8392, 8392, 8392, 8392, 8392, 8384, 8384, 8384, 8384, 8384
.short 8384, 8384, 8384, 8384, 8376, 8376, 8376, 8376, 8376, 8376, 8376, 8368, 8368, 8368, 8368, 8368
.short 8368, 8368, 8368, 8368, 8360, 8360, 8360, 8360, 8360, 8360, 8360, 8352, 8352, 8352, 8352, 8352
.short 8352, 8352, 8352, 8352, 8344, 8344, 8344, 8344, 8344, 8344, 8344, 8336, 8336, 8336, 8336, 8336
.short 8336, 8336, 8336, 8336, 8328, 8328, 8328, 8328, 8328, 8328, 8328, 8320, 8320, 8320, 8320, 8320
.short 8320, 8320, 8320, 8320, 8312, 8312, 8312, 8312, 8312, 8312, 8312, 8304, 8304, 8304, 8304, 8304
.short 8304, 8304, 8304, 8304, 8296, 8296, 8296, 8296, 8296, 8296, 8296, 8288, 8288, 8288, 8288, 8288
.short 8288, 8288, 8288, 8288, 8280, 8280, 8280, 8280, 8280, 8280, 8280, 8272, 8272, 8272, 8272, 8272
.short 8272, 8272, 8272, 8272, 8264, 8264, 8264, 8264, 8264, 8264, 8264, 8256, 8256, 8256, 8256, 8256
.short 8256, 8256, 8256, 8256, 8248, 8248, 8248, 8248, 8248, 8248, 8248, 8240, 8240, 8240, 8240, 8240
.short 8240, 8240, 8240, 8240, 8232, 8232, 8232, 8232, 8232, 8232, 8232, 8224, 8224, 8224, 8224, 8224
.short 8224, 8224, 8224, 8224, 8216, 8216, 8216, 8216, 8216, 8216, 8216, 8208, 8208, 8208, 8208, 8208
.short 8208, 8208, 8208, 8208, 8200, 8200, 8200, 8200, 8200, 8200, 8200, 8192, 8192, 8192, 8192, 8192
.short 8192, 8192, 7416, 7416, 7416, 6392, 6392, 6392, 6392, 6392, 7408, 7408, 7408, 6384, 6384, 6384
.short 6384, 6384, 7400, 7400, 7400, 6376, 6376, 6376, 6376, 6376, 7392, 7392, 7392, 6368, 6368, 6368
.short 6368, 6368, 7384, 7384, 7384, 6360, 6360, 6360, 6360, 6360, 7376, 7376, 7376, 6352, 6352, 6352
.short 6352, 6352, 7368, 7368, 7368, 6344, 6344, 6344, 6344, 6344, 7360, 7360, 7360, 6336, 6336, 6336
.short 6336, 6336, 7352, 7352, 7352, 6328, 6328, 6328, 6328, 6328, 7344, 7344, 7344, 6320, 6320, 6320
.short 6320, 6320, 7336, 7336, 7336, 6312, 6312, 6312, 6312, 6312, 7328, 7328, 7328, 6304, 6304, 6304
.short 6304, 6304, 7320, 7320, 7320, 6296, 6296, 6296, 6296, 6296, 7312, 7312, 7312, 6288, 6288, 6288
.short 6288, 6288, 7304, 7304, 7304, 6280, 6280, 6280, 6280, 6280, 7296, 7296, 7296, 6272, 6272, 6272
.short 6272, 6272, 7288, 7288, 7288, 6264, 6264, 6264, 6264, 6264, 7280, 7280, 7280, 6256, 6256, 6256
.short 6256, 6256, 7272, 7272, 7272, 6248, 6248, 6248, 6248, 6248, 7264, 7264, 7264, 6240, 6240, 6240
.short 6240, 6240, 7256, 7256, 7256, 6232, 6232, 6232, 6232, 6232, 7248, 7248, 7248, 6224, 6224, 6224
.short 6224, 6224, 7240, 7240, 7240, 6216, 6216, 6216, 6216, 6216, 7232, 7232, 7232, 6208, 6208, 6208
.short 6208, 6208, 7224, 7224, 7224, 6200, 6200, 6200, 6200, 6200, 7216, 7216, 7216, 6192, 6192, 6192
.short 6192, 6192, 7208, 7208, 7208, 6184, 6184, 6184, 6184, 6184, 7200, 7200, 7200, 6176, 6176, 6176
.short 6176, 6176, 7192, 7192, 7192, 6168, 6168, 6168, 6168, 6168, 7184, 7184, 7184, 6160, 6160, 6160
.short 6160, 6160, 7176, 7176, 7176, 6152, 6152, 6152, 6152, 6152, 7168, 7168, 7168, 6144, 6144, 6144
.short 6144, 6144, 5368, 5368, 5368, 4344, 4344, 4344, 4344, 4344, 5360, 5360, 5360, 4336, 4336, 4336
.short 4336, 4336, 5352, 5352, 5352, 4328, 4328, 4328, 4328, 4328, 5344, 5344, 5344, 4320, 4320, 4320
.short 4320, 4320, 5336, 5336, 5336, 4312, 4312, 4312, 4312, 4312, 5328, 5328, 5328, 4304, 4304, 4304
.short 4304, 4304, 5320, 5320, 5320, 4296, 4296, 4296, 4296, 4296, 5312, 5312, 5312, 4288, 4288, 4288
.short 4288, 4288, 5304, 5304, 5304, 4280, 4280, 4280, 4280, 4280, 5296, 5296, 5296, 4272, 4272, 4272
.short 4272, 4272, 5288, 5288, 5288, 4264, 4264, 4264, 4264, 4264, 5280, 5280, 5280, 4256, 4256, 4256
.short 4256, 4256, 5272, 5272, 5272, 4248, 4248, 4248, 4248, 4248, 5264, 5264, 5264, 4240, 4240, 4240
.short 4240, 4240, 5256, 5256, 5256, 4232, 4232, 4232, 4232, 4232, 5248, 5248, 5248, 4224, 4224, 4224
.short 4224, 4224, 5240, 5240, 5240, 4216, 4216, 4216, 4216, 4216, 5232, 5232, 5232, 4208, 4208, 4208
.short 4208, 4208, 5224, 5224, 5224, 4200, 4200, 4200, 4200, 4200, 5216, 5216, 5216, 4192, 4192, 4192
.short 4192, 4192, 5208, 5208, 5208, 4184, 4184, 4184, 4184, 4184, 5200, 5200, 5200, 4176, 4176, 4176
.short 4176, 4176, 5192, 5192, 5192, 4168, 4168, 4168, 4168, 4168, 5184, 5184, 5184, 4160, 4160, 4160
.short 4160, 4160, 5176, 5176, 5176, 4152, 4152, 4152, 4152, 4152, 5168, 5168, 5168, 4144, 4144, 4144
.short 4144, 4144, 5160, 5160, 5160, 4136, 4136, 4136, 4136, 4136, 5152, 5152, 5152, 4128, 4128, 4128
.short 4128, 4128, 5144, 5144, 5144, 4120, 4120, 4120, 4120, 4120, 5136, 5136, 5136, 4112, 4112, 4112
.short 4112, 4112, 5128, 5128, 5128, 4104, 4104, 4104, 4104, 4104, 5120, 5120, 5120, 4096, 4096, 4096
.short 4096, 3832, 3320, 3320, 3320, 2808, 2296, 2296, 2296, 3824, 3312, 3312, 3312, 2800, 2288, 2288
.short 2288, 3816, 3304, 3304, 3304, 2792, 2280, 2280, 2280, 3808, 3296, 3296, 3296, 2784, 2272, 2272
.short 2272, 3800, 3288, 3288, 3288, 2776, 2264, 2264, 2264, 3792, 3280, 3280, 3280, 2768, 2256, 2256
.short 2256, 3784, 3272, 3272, 3272, 2760, 2248, 2248, 2248, 3776, 3264, 3264, 3264, 2752, 2240, 2240
.short 2240, 3768, 3256, 3256, 3256, 2744, 2232, 2232, 2232, 3760, 3248, 3248, 3248, 2736, 2224, 2224
.short 2224, 3752, 3240, 3240, 3240, 2728, 2216, 2216, 2216, 3744, 3232, 3232, 3232, 2720, 2208, 2208
.short 2208, 3736, 3224, 3224, 3224, 2712, 2200, 2200, 2200, 3728, 3216, 3216, 3216, 2704, 2192, 2192
.short 2192, 3720, 3208, 3208, 3208, 2696, 2184, 2184, 2184, 3712, 3200, 3200, 3200, 2688, 2176, 2176
.short 2176, 3704, 3192, 3192, 3192, 2680, 2168, 2168, 2168, 3696, 3184, 3184, 3184, 2672, 2160, 2160
.short 2160, 3688, 3176, 3176, 3176, 2664, 2152, 2152, 2152, 3680, 3168, 3168, 3168, 2656, 2144, 2144
.short 2144, 3672, 3160, 3160, 3160, 2648, 2136, 2136, 2136, 3664, 3152, 3152, 3152, 2640, 2128, 2128
.short 2128, 3656, 3144, 3144, 3144, 2632, 2120, 2120, 2120, 3648, 3136, 3136, 3136, 2624, 2112, 2112
.short 2112, 3640, 3128, 3128, 3128, 2616, 2104, 2104, 2104, 3632, 3120, 3120, 3120, 2608, 2096, 2096
.short 2096, 3624, 3112, 3112, 3112, 2600, 2088, 2088, 2088, 3616, 3104, 3104, 3104, 2592, 2080, 2080
.short 2080, 3608, 3096, 3096, 3096, 2584, 2072, 2072, 2072, 3600, 3088, 3088, 3088, 2576, 2064, 2064
.short 2064, 3592, 3080, 3080, 3080, 2568, 2056, 2056, 2056, 3584, 3072, 3072, 3072, 2560, 2048, 2048
.short 2040, 1784, 1528, 1272, 1016, 760, 504, 248, 2032, 1776, 1520, 1264, 1008, 752, 496, 240
.short 2024, 1768, 1512, 1256, 1000, 744, 488, 232, 2016, 1760, 1504, 1248, 992, 736, 480, 224
.short 2008, 1752, 1496, 1240, 984, 728, 472, 216, 2000, 1744, 1488, 1232, 976, 720, 464, 208
.short 1992, 1736, 1480, 1224, 968, 712, 456, 200, 1984, 1728, 1472, 1216, 960, 704, 448, 192
.short 1976, 1720, 1464, 1208, 952, 696, 440, 184, 1968, 1712, 1456, 1200, 944, 688, 432, 176
.short 1960, 1704, 1448, 1192, 936, 680, 424, 168, 1952, 1696, 1440, 1184, 928, 672, 416, 160
.short 1944, 1688, 1432, 1176, 920, 664, 408, 152, 1936, 1680, 1424, 1168, 912, 656, 400, 144
.short 1928, 1672, 1416, 1160, 904, 648, 392, 136, 1920, 1664, 1408, 1152, 896, 640, 384, 128
.short 1912, 1656, 1400, 1144, 888, 632, 376, 120, 1904, 1648, 1392, 1136, 880, 624, 368, 112
.short 1896, 1640, 1384, 1128, 872, 616, 360, 104, 1888, 1632, 1376, 1120, 864, 608, 352, 96
.short 1880, 1624, 1368, 1112, 856, 600, 344, 88, 1872, 1616, 1360, 1104, 848, 592, 336, 80
.short 1864, 1608, 1352, 1096, 840, 584, 328, 72, 1856, 1600, 1344, 1088, 832, 576, 320, 64
.short 1848, 1592, 1336, 1080, 824, 568, 312, 56, 1840, 1584, 1328, 1072, 816, 560, 304, 48
.short 1832, 1576, 1320, 1064, 808, 552, 296, 40, 1824, 1568, 1312, 1056, 800, 544, 288, 32
.short 1816, 1560, 1304, 1048, 792, 536, 280, 24, 1808, 1552, 1296, 1040, 784, 528, 272, 16
.short 1800, 1544, 1288, 1032, 776, 520, 264, 8, 1792, 1536, 1280, 1024, 768, 512, 256, 0
.short 2304, 2304, 2304, 2304, 2304, 2304, 2304, 2304, 2304, 2304, 2304, 2304, 2304, 2304, 2304, 2304
.size L_lagtab, 4128
.section .rodata,"a"
.p2align 6
.amdhsa_kernel adaLN_cond__ssm_conv_s4__swiglu_ffn__prompt_kernel
  .amdhsa_next_free_vgpr 256
  .amdhsa_next_free_sgpr 102
  .amdhsa_accum_offset 256
  .amdhsa_group_segment_fixed_size 0
  .amdhsa_kernarg_size 144
  .amdhsa_user_sgpr_count 2
  .amdhsa_user_sgpr_kernarg_segment_ptr 1
  .amdhsa_system_sgpr_workgroup_id_x 1
.end_amdhsa_kernel
```
